```python
import torch

def _softmax(x, axis=-1):
    return torch.softmax(x, dim=axis)
def _gelu(x):
    return torch.nn.functional.gelu(x, approximate="tanh")
def _silu(x):
    return torch.nn.functional.silu(x)
def _sigmoid(x):
    return torch.sigmoid(x)
def _layernorm(x, axis=-1, eps=1e-5):
    m = x.mean(dim=axis, keepdim=True)
    v = x.var(dim=axis, keepdim=True, unbiased=False)
    return (x - m) / torch.sqrt(v + eps)
def _scatter_add(tgt, idx, src, axis=0):
    return tgt.clone().index_add_(axis, idx, src)
def _segment_sum(src, seg, n):
    out = torch.zeros((n,) + src.shape[1:], dtype=src.dtype)
    return out.index_add_(0, seg, src)
def _pad(x, pw):
    flat = tuple(v for pair in reversed(pw) for v in pair)
    return torch.nn.functional.pad(x, flat)

kernel_name = 'concat_heads__spectral_fnet__grouped_kv_mqa__prompt'

def setup_inputs():

    _w = (lambda a: (lambda t: t.to(torch.bfloat16) if t.is_floating_point() else t)(torch.as_tensor(a)))
    def _A_setup():
        B, S, D = 1, 2048, 640
        ns = torch.arange(S)[:, None] * torch.arange(S)[None, :]
        nd = torch.arange(D)[:, None] * torch.arange(D)[None, :]
        Ws_re = torch.cos(-2.0 * torch.pi * ns / S).to(float)
        Ws_im = torch.sin(-2.0 * torch.pi * ns / S).to(float)
        Wd_re = torch.cos(-2.0 * torch.pi * nd / D).to(float)
        Wd_im = torch.sin(-2.0 * torch.pi * nd / D).to(float)
        return {
            "x": _w((lambda *s: torch.randn(*s, dtype=torch.bfloat16) * 0.05)(B, S, D)),
            "dft_seq_re": _w(Ws_re),
            "dft_seq_im": _w(Ws_im),
            "dft_hid_re": _w(Wd_re),
            "dft_hid_im": _w(Wd_im),
        }
    _A_in = _A_setup()

    def _B_setup():
        B, S, D, H = 1, 2048, 640, 32
        Dh = D // H
        return {
            "x": _w((lambda *s: torch.randn(*s, dtype=torch.bfloat16) * 0.05)(B, S, D)),
            "wq": _w((lambda *s: torch.randn(*s, dtype=torch.bfloat16) * 3.2)(D, H * Dh)),
            "wk": _w((lambda *s: torch.randn(*s, dtype=torch.bfloat16) * 3.2)(D, Dh)),
            "wv": _w((lambda *s: torch.randn(*s, dtype=torch.bfloat16) * 0.4)(D, Dh)),
            "wo": _w((lambda *s: torch.randn(*s, dtype=torch.bfloat16) * 0.4)(H * Dh, D)),
        }
    _B_in = _B_setup()

    return {
        "A_x": _A_in["x"],
        "A_dft_seq_re": _A_in["dft_seq_re"],
        "A_dft_seq_im": _A_in["dft_seq_im"],
        "A_dft_hid_re": _A_in["dft_hid_re"],
        "A_dft_hid_im": _A_in["dft_hid_im"],
        "B_x": _B_in["x"],
        "B_wq": _B_in["wq"],
        "B_wk": _B_in["wk"],
        "B_wv": _B_in["wv"],
        "B_wo": _B_in["wo"],
    }

def reference(A_x, A_dft_seq_re, A_dft_seq_im, A_dft_hid_re, A_dft_hid_im, B_x, B_wq, B_wk, B_wv, B_wo):
    def _A_ref(x, dft_seq_re, dft_seq_im, dft_hid_re, dft_hid_im):
        a = torch.einsum("bsd,ed->bse", x, dft_hid_re)
        b = torch.einsum("bsd,ed->bse", x, dft_hid_im)
        y = torch.einsum("ts,bse->bte", dft_seq_re, a) - torch.einsum("ts,bse->bte", dft_seq_im, b)
        return y

    def _B_ref(x, wq, wk, wv, wo):
        B, S, D = x.shape
        H = 32
        Dh = D // H
        q = (lambda x, *d: x.permute(*d))((x @ wq).reshape(B, S, H, Dh), 0, 2, 1, 3)
        k = x @ wk
        v = x @ wv
        scores = torch.einsum("bhqd,bkd->bhqk", q, k) * (Dh ** -0.5)
        p = _softmax(scores, axis=-1)
        o = torch.einsum("bhqk,bkd->bhqd", p, v)
        return (lambda x, *d: x.permute(*d))(o, 0, 2, 1, 3).reshape(B, S, H * Dh) @ wo

    a = _A_ref(A_x, A_dft_seq_re, A_dft_seq_im, A_dft_hid_re, A_dft_hid_im)
    b = _B_ref(B_x, B_wq, B_wk, B_wv, B_wo)
    return torch.concatenate([a, b], axis=-1)
```

```asm
; @launch grid=(256,1,1) block=(512,1,1) lds=163840
.amdgcn_target "amdgcn-amd-amdhsa--gfx950"
.text
.globl concat_heads__spectral_fnet__grouped_kv_mqa__prompt_kernel
.p2align 8
.type concat_heads__spectral_fnet__grouped_kv_mqa__prompt_kernel,@function
concat_heads__spectral_fnet__grouped_kv_mqa__prompt_kernel:
  s_cmp_ge_u32 s2, 256
  s_cbranch_scc1 L_end
  s_load_dwordx8 s[68:75], s[0:1], 40
  s_load_dwordx2 s[8:9], s[0:1], 0
  s_load_dwordx2 s[44:45], s[0:1], 96
  v_lshrrev_b32 v2, 6, v0
  v_and_b32 v1, 63, v0
  v_readfirstlane_b32 s3, v2
  v_lshlrev_b32 v5, 7, v1
  s_and_b32 s4, s2, 7
  s_lshr_b32 s5, s2, 3
  s_lshl3_add_u32 s49, s5, s3
  s_lshl_b32 s50, s4, 8
  s_add_u32 s50, s50, s49
  s_mulk_i32 s50, 1280
  v_add_u32 v2, s50, v5
  s_nop 0
  s_mov_b32 s50, s49
  s_mulk_i32 s50, 3200
  v_add_u32 v3, s50, v5
  s_mov_b32 s53, s50
  s_lshl3_add_u32 s50, s5, s4
  s_lshl3_add_u32 s50, s50, s3
  s_mulk_i32 s50, 1280
  v_add_u32 v4, s50, v5
  s_min_u32 s49, s49, 199
  s_lshl_b32 s49, s49, 7
  v_mov_b32 v5, s49
  s_getpc_b64 s[82:83]
L_pc:
  s_lshl3_add_u32 s49, s5, s3
  s_lshl_b32 s49, s49, 8
  s_min_u32 s49, s49, L_codeend-L_pc-132
  s_add_u32 s82, s82, s49
  s_addc_u32 s83, s83, 0
  s_mov_b64 exec, 1
  v_mov_b32 v8, s82
  v_mov_b32 v9, s83
  global_load_dword v0, v[8:9], off
  global_load_dword v0, v[8:9], off offset:128
  s_lshl3_add_u32 s49, s2, s3
  s_cmp_eq_u32 s49, 1
  s_cbranch_scc0 L_zeroed
  s_mov_b64 exec, -1
  v_lshlrev_b32 v8, 7, v1
  v_add_u32 v8, 0x34000, v8
  v_mov_b32 v9, 0
  s_waitcnt lgkmcnt(0)
  global_store_dword v8, v9, s[44:45] sc1
L_zeroed:
  s_mov_b64 exec, 0x3ff
  s_waitcnt lgkmcnt(0)
  global_load_dword v0, v2, s[68:69]
  global_load_dword v0, v5, s[72:73]
  global_load_dword v0, v5, s[74:75]
  global_load_dword v0, v4, s[8:9]
  s_mov_b64 exec, 0x1ffffff
  global_load_dword v0, v3, s[70:71]
  s_mov_b64 exec, -1
  s_load_dwordx2 s[76:77], s[0:1], 88
  s_load_dwordx2 s[36:37], s[0:1], 72
  s_load_dwordx2 s[40:41], s[0:1], 80
  s_and_b32 s7, s5, 7
  s_lshr_b32 s6, s5, 3
  s_lshl2_add_u32 s6, s4, s6
  s_bitcmp1_b32 s3, 1
  s_cbranch_scc0 L_setup
  s_and_b32 s80, s7, 3
  s_mulk_i32 s80, 160
  s_lshl_b32 s49, s3, 2
  s_lshr_b32 s49, 0x86003000, s49
  s_and_b32 s49, s49, 15
  s_lshl4_add_u32 s80, s49, s80
  v_and_b32 v2, 15, v1
  v_lshrrev_b32 v4, 1, v1
  v_and_b32 v4, 24, v4
  v_cvt_f32_u32 v4, v4
  v_and_b32 v195, 1, v2
  v_cvt_f32_u32 v195, v195
  v_mul_f32 v195, 0x3e800000, v195
  v_add_u32 v2, s80, v2
  s_cmp_ge_u32 s3, 4
  s_cbranch_scc1 L_gen1
  v_add_u32 v5, 32, v2
  v_lshrrev_b32 v5, 1, v5
  v_cvt_f32_u32 v192, v5
  v_mul_f32 v192, 0x3acccccd, v192
  v_mul_f32 v194, 0x42000000, v192
  v_cos_f32 v194, v194
  v_fma_f32 v193, v192, v4, v195
  v_add_f32 v194, v194, v194
  v_add_f32 v212, v192, v192
  v_cos_f32 v212, v212
  v_fmamk_f32 v196, v192, 0x0, v193
  v_fmamk_f32 v197, v192, 0x3f800000, v193
  v_fmamk_f32 v198, v192, 0x40000000, v193
  v_fmamk_f32 v199, v192, 0x40400000, v193
  v_cos_f32 v196, v196
  v_cos_f32 v197, v197
  v_cos_f32 v198, v198
  v_cos_f32 v199, v199
  v_add_f32 v212, v212, v212
  v_pk_fma_f32 v[200:201], v[198:199], v[212:213], v[196:197] op_sel_hi:[1,0,1] neg_lo:[0,0,1] neg_hi:[0,0,1]
  v_pk_fma_f32 v[202:203], v[200:201], v[212:213], v[198:199] op_sel_hi:[1,0,1] neg_lo:[0,0,1] neg_hi:[0,0,1]
  v_cvt_pk_bf16_f32 v152, v196, v197
  v_cvt_pk_bf16_f32 v153, v198, v199
  v_cvt_pk_bf16_f32 v154, v200, v201
  v_cvt_pk_bf16_f32 v155, v202, v203
  v_fmamk_f32 v204, v192, 0x42000000, v193
  v_fmamk_f32 v205, v192, 0x42040000, v193
  v_fmamk_f32 v206, v192, 0x42080000, v193
  v_fmamk_f32 v207, v192, 0x420c0000, v193
  v_cos_f32 v204, v204
  v_cos_f32 v205, v205
  v_cos_f32 v206, v206
  v_cos_f32 v207, v207
  s_nop 0
  v_pk_fma_f32 v[208:209], v[206:207], v[212:213], v[204:205] op_sel_hi:[1,0,1] neg_lo:[0,0,1] neg_hi:[0,0,1]
  v_pk_fma_f32 v[210:211], v[208:209], v[212:213], v[206:207] op_sel_hi:[1,0,1] neg_lo:[0,0,1] neg_hi:[0,0,1]
  v_cvt_pk_bf16_f32 v156, v204, v205
  v_cvt_pk_bf16_f32 v157, v206, v207
  v_cvt_pk_bf16_f32 v158, v208, v209
  v_cvt_pk_bf16_f32 v159, v210, v211
  v_pk_fma_f32 v[196:197], v[204:205], v[194:195], v[196:197] op_sel_hi:[1,0,1] neg_lo:[0,0,1] neg_hi:[0,0,1]
  v_pk_fma_f32 v[198:199], v[206:207], v[194:195], v[198:199] op_sel_hi:[1,0,1] neg_lo:[0,0,1] neg_hi:[0,0,1]
  v_pk_fma_f32 v[200:201], v[208:209], v[194:195], v[200:201] op_sel_hi:[1,0,1] neg_lo:[0,0,1] neg_hi:[0,0,1]
  v_pk_fma_f32 v[202:203], v[210:211], v[194:195], v[202:203] op_sel_hi:[1,0,1] neg_lo:[0,0,1] neg_hi:[0,0,1]
  v_cvt_pk_bf16_f32 v160, v196, v197
  v_cvt_pk_bf16_f32 v161, v198, v199
  v_cvt_pk_bf16_f32 v162, v200, v201
  v_cvt_pk_bf16_f32 v163, v202, v203
  v_pk_fma_f32 v[204:205], v[196:197], v[194:195], v[204:205] op_sel_hi:[1,0,1] neg_lo:[0,0,1] neg_hi:[0,0,1]
  v_pk_fma_f32 v[206:207], v[198:199], v[194:195], v[206:207] op_sel_hi:[1,0,1] neg_lo:[0,0,1] neg_hi:[0,0,1]
  v_pk_fma_f32 v[208:209], v[200:201], v[194:195], v[208:209] op_sel_hi:[1,0,1] neg_lo:[0,0,1] neg_hi:[0,0,1]
  v_pk_fma_f32 v[210:211], v[202:203], v[194:195], v[210:211] op_sel_hi:[1,0,1] neg_lo:[0,0,1] neg_hi:[0,0,1]
  v_cvt_pk_bf16_f32 v164, v204, v205
  v_cvt_pk_bf16_f32 v165, v206, v207
  v_cvt_pk_bf16_f32 v166, v208, v209
  v_cvt_pk_bf16_f32 v167, v210, v211
  v_pk_fma_f32 v[196:197], v[204:205], v[194:195], v[196:197] op_sel_hi:[1,0,1] neg_lo:[0,0,1] neg_hi:[0,0,1]
  v_pk_fma_f32 v[198:199], v[206:207], v[194:195], v[198:199] op_sel_hi:[1,0,1] neg_lo:[0,0,1] neg_hi:[0,0,1]
  v_pk_fma_f32 v[200:201], v[208:209], v[194:195], v[200:201] op_sel_hi:[1,0,1] neg_lo:[0,0,1] neg_hi:[0,0,1]
  v_pk_fma_f32 v[202:203], v[210:211], v[194:195], v[202:203] op_sel_hi:[1,0,1] neg_lo:[0,0,1] neg_hi:[0,0,1]
  v_cvt_pk_bf16_f32 v168, v196, v197
  v_cvt_pk_bf16_f32 v169, v198, v199
  v_cvt_pk_bf16_f32 v170, v200, v201
  v_cvt_pk_bf16_f32 v171, v202, v203
  v_pk_fma_f32 v[204:205], v[196:197], v[194:195], v[204:205] op_sel_hi:[1,0,1] neg_lo:[0,0,1] neg_hi:[0,0,1]
  v_pk_fma_f32 v[206:207], v[198:199], v[194:195], v[206:207] op_sel_hi:[1,0,1] neg_lo:[0,0,1] neg_hi:[0,0,1]
  v_pk_fma_f32 v[208:209], v[200:201], v[194:195], v[208:209] op_sel_hi:[1,0,1] neg_lo:[0,0,1] neg_hi:[0,0,1]
  v_pk_fma_f32 v[210:211], v[202:203], v[194:195], v[210:211] op_sel_hi:[1,0,1] neg_lo:[0,0,1] neg_hi:[0,0,1]
  v_cvt_pk_bf16_f32 v172, v204, v205
  v_cvt_pk_bf16_f32 v173, v206, v207
  v_cvt_pk_bf16_f32 v174, v208, v209
  v_cvt_pk_bf16_f32 v175, v210, v211
  v_pk_fma_f32 v[196:197], v[204:205], v[194:195], v[196:197] op_sel_hi:[1,0,1] neg_lo:[0,0,1] neg_hi:[0,0,1]
  v_pk_fma_f32 v[198:199], v[206:207], v[194:195], v[198:199] op_sel_hi:[1,0,1] neg_lo:[0,0,1] neg_hi:[0,0,1]
  v_pk_fma_f32 v[200:201], v[208:209], v[194:195], v[200:201] op_sel_hi:[1,0,1] neg_lo:[0,0,1] neg_hi:[0,0,1]
  v_pk_fma_f32 v[202:203], v[210:211], v[194:195], v[202:203] op_sel_hi:[1,0,1] neg_lo:[0,0,1] neg_hi:[0,0,1]
  v_cvt_pk_bf16_f32 v176, v196, v197
  v_cvt_pk_bf16_f32 v177, v198, v199
  v_cvt_pk_bf16_f32 v178, v200, v201
  v_cvt_pk_bf16_f32 v179, v202, v203
  v_pk_fma_f32 v[204:205], v[196:197], v[194:195], v[204:205] op_sel_hi:[1,0,1] neg_lo:[0,0,1] neg_hi:[0,0,1]
  v_pk_fma_f32 v[206:207], v[198:199], v[194:195], v[206:207] op_sel_hi:[1,0,1] neg_lo:[0,0,1] neg_hi:[0,0,1]
  v_pk_fma_f32 v[208:209], v[200:201], v[194:195], v[208:209] op_sel_hi:[1,0,1] neg_lo:[0,0,1] neg_hi:[0,0,1]
  v_pk_fma_f32 v[210:211], v[202:203], v[194:195], v[210:211] op_sel_hi:[1,0,1] neg_lo:[0,0,1] neg_hi:[0,0,1]
  v_cvt_pk_bf16_f32 v180, v204, v205
  v_cvt_pk_bf16_f32 v181, v206, v207
  v_cvt_pk_bf16_f32 v182, v208, v209
  v_cvt_pk_bf16_f32 v183, v210, v211
  v_pk_fma_f32 v[196:197], v[204:205], v[194:195], v[196:197] op_sel_hi:[1,0,1] neg_lo:[0,0,1] neg_hi:[0,0,1]
  v_pk_fma_f32 v[198:199], v[206:207], v[194:195], v[198:199] op_sel_hi:[1,0,1] neg_lo:[0,0,1] neg_hi:[0,0,1]
  v_pk_fma_f32 v[200:201], v[208:209], v[194:195], v[200:201] op_sel_hi:[1,0,1] neg_lo:[0,0,1] neg_hi:[0,0,1]
  v_pk_fma_f32 v[202:203], v[210:211], v[194:195], v[202:203] op_sel_hi:[1,0,1] neg_lo:[0,0,1] neg_hi:[0,0,1]
  v_cvt_pk_bf16_f32 v184, v196, v197
  v_cvt_pk_bf16_f32 v185, v198, v199
  v_cvt_pk_bf16_f32 v186, v200, v201
  v_cvt_pk_bf16_f32 v187, v202, v203
  v_pk_fma_f32 v[204:205], v[196:197], v[194:195], v[204:205] op_sel_hi:[1,0,1] neg_lo:[0,0,1] neg_hi:[0,0,1]
  v_pk_fma_f32 v[206:207], v[198:199], v[194:195], v[206:207] op_sel_hi:[1,0,1] neg_lo:[0,0,1] neg_hi:[0,0,1]
  v_pk_fma_f32 v[208:209], v[200:201], v[194:195], v[208:209] op_sel_hi:[1,0,1] neg_lo:[0,0,1] neg_hi:[0,0,1]
  v_pk_fma_f32 v[210:211], v[202:203], v[194:195], v[210:211] op_sel_hi:[1,0,1] neg_lo:[0,0,1] neg_hi:[0,0,1]
  v_cvt_pk_bf16_f32 v188, v204, v205
  v_cvt_pk_bf16_f32 v189, v206, v207
  v_cvt_pk_bf16_f32 v190, v208, v209
  v_cvt_pk_bf16_f32 v191, v210, v211
L_gen1:
  v_and_b32 v5, 12, v1
  v_add_u32 v2, v2, v5
  v_add_u32 v5, 4, v2
  v_lshrrev_b32 v5, 1, v5
  v_cvt_f32_u32 v192, v5
  v_mul_f32 v192, 0x3acccccd, v192
  v_mul_f32 v194, 0x42000000, v192
  v_cos_f32 v194, v194
  v_fma_f32 v193, v192, v4, v195
  v_add_f32 v194, v194, v194
  v_add_f32 v212, v192, v192
  v_cos_f32 v212, v212
  v_fmamk_f32 v196, v192, 0x0, v193
  v_fmamk_f32 v197, v192, 0x3f800000, v193
  v_fmamk_f32 v198, v192, 0x40000000, v193
  v_fmamk_f32 v199, v192, 0x40400000, v193
  v_cos_f32 v196, v196
  v_cos_f32 v197, v197
  v_cos_f32 v198, v198
  v_cos_f32 v199, v199
  v_add_f32 v212, v212, v212
  v_pk_fma_f32 v[200:201], v[198:199], v[212:213], v[196:197] op_sel_hi:[1,0,1] neg_lo:[0,0,1] neg_hi:[0,0,1]
  v_pk_fma_f32 v[202:203], v[200:201], v[212:213], v[198:199] op_sel_hi:[1,0,1] neg_lo:[0,0,1] neg_hi:[0,0,1]
  v_cvt_pk_bf16_f32 v112, v196, v197
  v_cvt_pk_bf16_f32 v113, v198, v199
  v_cvt_pk_bf16_f32 v114, v200, v201
  v_cvt_pk_bf16_f32 v115, v202, v203
  v_fmamk_f32 v204, v192, 0x42000000, v193
  v_fmamk_f32 v205, v192, 0x42040000, v193
  v_fmamk_f32 v206, v192, 0x42080000, v193
  v_fmamk_f32 v207, v192, 0x420c0000, v193
  v_cos_f32 v204, v204
  v_cos_f32 v205, v205
  v_cos_f32 v206, v206
  v_cos_f32 v207, v207
  s_nop 0
  v_pk_fma_f32 v[208:209], v[206:207], v[212:213], v[204:205] op_sel_hi:[1,0,1] neg_lo:[0,0,1] neg_hi:[0,0,1]
  v_pk_fma_f32 v[210:211], v[208:209], v[212:213], v[206:207] op_sel_hi:[1,0,1] neg_lo:[0,0,1] neg_hi:[0,0,1]
  v_cvt_pk_bf16_f32 v116, v204, v205
  v_cvt_pk_bf16_f32 v117, v206, v207
  v_cvt_pk_bf16_f32 v118, v208, v209
  v_cvt_pk_bf16_f32 v119, v210, v211
  v_pk_fma_f32 v[196:197], v[204:205], v[194:195], v[196:197] op_sel_hi:[1,0,1] neg_lo:[0,0,1] neg_hi:[0,0,1]
  v_pk_fma_f32 v[198:199], v[206:207], v[194:195], v[198:199] op_sel_hi:[1,0,1] neg_lo:[0,0,1] neg_hi:[0,0,1]
  v_pk_fma_f32 v[200:201], v[208:209], v[194:195], v[200:201] op_sel_hi:[1,0,1] neg_lo:[0,0,1] neg_hi:[0,0,1]
  v_pk_fma_f32 v[202:203], v[210:211], v[194:195], v[202:203] op_sel_hi:[1,0,1] neg_lo:[0,0,1] neg_hi:[0,0,1]
  v_cvt_pk_bf16_f32 v120, v196, v197
  v_cvt_pk_bf16_f32 v121, v198, v199
  v_cvt_pk_bf16_f32 v122, v200, v201
  v_cvt_pk_bf16_f32 v123, v202, v203
  v_pk_fma_f32 v[204:205], v[196:197], v[194:195], v[204:205] op_sel_hi:[1,0,1] neg_lo:[0,0,1] neg_hi:[0,0,1]
  v_pk_fma_f32 v[206:207], v[198:199], v[194:195], v[206:207] op_sel_hi:[1,0,1] neg_lo:[0,0,1] neg_hi:[0,0,1]
  v_pk_fma_f32 v[208:209], v[200:201], v[194:195], v[208:209] op_sel_hi:[1,0,1] neg_lo:[0,0,1] neg_hi:[0,0,1]
  v_pk_fma_f32 v[210:211], v[202:203], v[194:195], v[210:211] op_sel_hi:[1,0,1] neg_lo:[0,0,1] neg_hi:[0,0,1]
  v_cvt_pk_bf16_f32 v124, v204, v205
  v_cvt_pk_bf16_f32 v125, v206, v207
  v_cvt_pk_bf16_f32 v126, v208, v209
  v_cvt_pk_bf16_f32 v127, v210, v211
  v_pk_fma_f32 v[196:197], v[204:205], v[194:195], v[196:197] op_sel_hi:[1,0,1] neg_lo:[0,0,1] neg_hi:[0,0,1]
  v_pk_fma_f32 v[198:199], v[206:207], v[194:195], v[198:199] op_sel_hi:[1,0,1] neg_lo:[0,0,1] neg_hi:[0,0,1]
  v_pk_fma_f32 v[200:201], v[208:209], v[194:195], v[200:201] op_sel_hi:[1,0,1] neg_lo:[0,0,1] neg_hi:[0,0,1]
  v_pk_fma_f32 v[202:203], v[210:211], v[194:195], v[202:203] op_sel_hi:[1,0,1] neg_lo:[0,0,1] neg_hi:[0,0,1]
  v_cvt_pk_bf16_f32 v128, v196, v197
  v_cvt_pk_bf16_f32 v129, v198, v199
  v_cvt_pk_bf16_f32 v130, v200, v201
  v_cvt_pk_bf16_f32 v131, v202, v203
  v_pk_fma_f32 v[204:205], v[196:197], v[194:195], v[204:205] op_sel_hi:[1,0,1] neg_lo:[0,0,1] neg_hi:[0,0,1]
  v_pk_fma_f32 v[206:207], v[198:199], v[194:195], v[206:207] op_sel_hi:[1,0,1] neg_lo:[0,0,1] neg_hi:[0,0,1]
  v_pk_fma_f32 v[208:209], v[200:201], v[194:195], v[208:209] op_sel_hi:[1,0,1] neg_lo:[0,0,1] neg_hi:[0,0,1]
  v_pk_fma_f32 v[210:211], v[202:203], v[194:195], v[210:211] op_sel_hi:[1,0,1] neg_lo:[0,0,1] neg_hi:[0,0,1]
  v_cvt_pk_bf16_f32 v132, v204, v205
  v_cvt_pk_bf16_f32 v133, v206, v207
  v_cvt_pk_bf16_f32 v134, v208, v209
  v_cvt_pk_bf16_f32 v135, v210, v211
  v_pk_fma_f32 v[196:197], v[204:205], v[194:195], v[196:197] op_sel_hi:[1,0,1] neg_lo:[0,0,1] neg_hi:[0,0,1]
  v_pk_fma_f32 v[198:199], v[206:207], v[194:195], v[198:199] op_sel_hi:[1,0,1] neg_lo:[0,0,1] neg_hi:[0,0,1]
  v_pk_fma_f32 v[200:201], v[208:209], v[194:195], v[200:201] op_sel_hi:[1,0,1] neg_lo:[0,0,1] neg_hi:[0,0,1]
  v_pk_fma_f32 v[202:203], v[210:211], v[194:195], v[202:203] op_sel_hi:[1,0,1] neg_lo:[0,0,1] neg_hi:[0,0,1]
  v_cvt_pk_bf16_f32 v136, v196, v197
  v_cvt_pk_bf16_f32 v137, v198, v199
  v_cvt_pk_bf16_f32 v138, v200, v201
  v_cvt_pk_bf16_f32 v139, v202, v203
  v_pk_fma_f32 v[204:205], v[196:197], v[194:195], v[204:205] op_sel_hi:[1,0,1] neg_lo:[0,0,1] neg_hi:[0,0,1]
  v_pk_fma_f32 v[206:207], v[198:199], v[194:195], v[206:207] op_sel_hi:[1,0,1] neg_lo:[0,0,1] neg_hi:[0,0,1]
  v_pk_fma_f32 v[208:209], v[200:201], v[194:195], v[208:209] op_sel_hi:[1,0,1] neg_lo:[0,0,1] neg_hi:[0,0,1]
  v_pk_fma_f32 v[210:211], v[202:203], v[194:195], v[210:211] op_sel_hi:[1,0,1] neg_lo:[0,0,1] neg_hi:[0,0,1]
  v_cvt_pk_bf16_f32 v140, v204, v205
  v_cvt_pk_bf16_f32 v141, v206, v207
  v_cvt_pk_bf16_f32 v142, v208, v209
  v_cvt_pk_bf16_f32 v143, v210, v211
  v_pk_fma_f32 v[196:197], v[204:205], v[194:195], v[196:197] op_sel_hi:[1,0,1] neg_lo:[0,0,1] neg_hi:[0,0,1]
  v_pk_fma_f32 v[198:199], v[206:207], v[194:195], v[198:199] op_sel_hi:[1,0,1] neg_lo:[0,0,1] neg_hi:[0,0,1]
  v_pk_fma_f32 v[200:201], v[208:209], v[194:195], v[200:201] op_sel_hi:[1,0,1] neg_lo:[0,0,1] neg_hi:[0,0,1]
  v_pk_fma_f32 v[202:203], v[210:211], v[194:195], v[202:203] op_sel_hi:[1,0,1] neg_lo:[0,0,1] neg_hi:[0,0,1]
  v_cvt_pk_bf16_f32 v144, v196, v197
  v_cvt_pk_bf16_f32 v145, v198, v199
  v_cvt_pk_bf16_f32 v146, v200, v201
  v_cvt_pk_bf16_f32 v147, v202, v203
  v_pk_fma_f32 v[204:205], v[196:197], v[194:195], v[204:205] op_sel_hi:[1,0,1] neg_lo:[0,0,1] neg_hi:[0,0,1]
  v_pk_fma_f32 v[206:207], v[198:199], v[194:195], v[206:207] op_sel_hi:[1,0,1] neg_lo:[0,0,1] neg_hi:[0,0,1]
  v_pk_fma_f32 v[208:209], v[200:201], v[194:195], v[208:209] op_sel_hi:[1,0,1] neg_lo:[0,0,1] neg_hi:[0,0,1]
  v_pk_fma_f32 v[210:211], v[202:203], v[194:195], v[210:211] op_sel_hi:[1,0,1] neg_lo:[0,0,1] neg_hi:[0,0,1]
  v_cvt_pk_bf16_f32 v148, v204, v205
  v_cvt_pk_bf16_f32 v149, v206, v207
  v_cvt_pk_bf16_f32 v150, v208, v209
  v_cvt_pk_bf16_f32 v151, v210, v211
  v_add_u32 v5, 0, v2
  v_lshrrev_b32 v5, 1, v5
  v_cvt_f32_u32 v192, v5
  v_cmp_eq_u32 vcc, 1, v2
  v_mul_f32 v192, 0x3acccccd, v192
  s_nop 0
  v_cndmask_b32 v192, v192, 0.5, vcc
  v_cndmask_b32 v195, v195, 0, vcc
  v_mul_f32 v194, 0x42000000, v192
  v_cos_f32 v194, v194
  v_fma_f32 v193, v192, v4, v195
  v_add_f32 v194, v194, v194
  v_add_f32 v212, v192, v192
  v_cos_f32 v212, v212
  v_fmamk_f32 v196, v192, 0x0, v193
  v_fmamk_f32 v197, v192, 0x3f800000, v193
  v_fmamk_f32 v198, v192, 0x40000000, v193
  v_fmamk_f32 v199, v192, 0x40400000, v193
  v_cos_f32 v196, v196
  v_cos_f32 v197, v197
  v_cos_f32 v198, v198
  v_cos_f32 v199, v199
  v_add_f32 v212, v212, v212
  v_pk_fma_f32 v[200:201], v[198:199], v[212:213], v[196:197] op_sel_hi:[1,0,1] neg_lo:[0,0,1] neg_hi:[0,0,1]
  v_pk_fma_f32 v[202:203], v[200:201], v[212:213], v[198:199] op_sel_hi:[1,0,1] neg_lo:[0,0,1] neg_hi:[0,0,1]
  v_cvt_pk_bf16_f32 v72, v196, v197
  v_cvt_pk_bf16_f32 v73, v198, v199
  v_cvt_pk_bf16_f32 v74, v200, v201
  v_cvt_pk_bf16_f32 v75, v202, v203
  v_fmamk_f32 v204, v192, 0x42000000, v193
  v_fmamk_f32 v205, v192, 0x42040000, v193
  v_fmamk_f32 v206, v192, 0x42080000, v193
  v_fmamk_f32 v207, v192, 0x420c0000, v193
  v_cos_f32 v204, v204
  v_cos_f32 v205, v205
  v_cos_f32 v206, v206
  v_cos_f32 v207, v207
  s_nop 0
  v_pk_fma_f32 v[208:209], v[206:207], v[212:213], v[204:205] op_sel_hi:[1,0,1] neg_lo:[0,0,1] neg_hi:[0,0,1]
  v_pk_fma_f32 v[210:211], v[208:209], v[212:213], v[206:207] op_sel_hi:[1,0,1] neg_lo:[0,0,1] neg_hi:[0,0,1]
  v_cvt_pk_bf16_f32 v76, v204, v205
  v_cvt_pk_bf16_f32 v77, v206, v207
  v_cvt_pk_bf16_f32 v78, v208, v209
  v_cvt_pk_bf16_f32 v79, v210, v211
  v_pk_fma_f32 v[196:197], v[204:205], v[194:195], v[196:197] op_sel_hi:[1,0,1] neg_lo:[0,0,1] neg_hi:[0,0,1]
  v_pk_fma_f32 v[198:199], v[206:207], v[194:195], v[198:199] op_sel_hi:[1,0,1] neg_lo:[0,0,1] neg_hi:[0,0,1]
  v_pk_fma_f32 v[200:201], v[208:209], v[194:195], v[200:201] op_sel_hi:[1,0,1] neg_lo:[0,0,1] neg_hi:[0,0,1]
  v_pk_fma_f32 v[202:203], v[210:211], v[194:195], v[202:203] op_sel_hi:[1,0,1] neg_lo:[0,0,1] neg_hi:[0,0,1]
  v_cvt_pk_bf16_f32 v80, v196, v197
  v_cvt_pk_bf16_f32 v81, v198, v199
  v_cvt_pk_bf16_f32 v82, v200, v201
  v_cvt_pk_bf16_f32 v83, v202, v203
  v_pk_fma_f32 v[204:205], v[196:197], v[194:195], v[204:205] op_sel_hi:[1,0,1] neg_lo:[0,0,1] neg_hi:[0,0,1]
  v_pk_fma_f32 v[206:207], v[198:199], v[194:195], v[206:207] op_sel_hi:[1,0,1] neg_lo:[0,0,1] neg_hi:[0,0,1]
  v_pk_fma_f32 v[208:209], v[200:201], v[194:195], v[208:209] op_sel_hi:[1,0,1] neg_lo:[0,0,1] neg_hi:[0,0,1]
  v_pk_fma_f32 v[210:211], v[202:203], v[194:195], v[210:211] op_sel_hi:[1,0,1] neg_lo:[0,0,1] neg_hi:[0,0,1]
  v_cvt_pk_bf16_f32 v84, v204, v205
  v_cvt_pk_bf16_f32 v85, v206, v207
  v_cvt_pk_bf16_f32 v86, v208, v209
  v_cvt_pk_bf16_f32 v87, v210, v211
  v_pk_fma_f32 v[196:197], v[204:205], v[194:195], v[196:197] op_sel_hi:[1,0,1] neg_lo:[0,0,1] neg_hi:[0,0,1]
  v_pk_fma_f32 v[198:199], v[206:207], v[194:195], v[198:199] op_sel_hi:[1,0,1] neg_lo:[0,0,1] neg_hi:[0,0,1]
  v_pk_fma_f32 v[200:201], v[208:209], v[194:195], v[200:201] op_sel_hi:[1,0,1] neg_lo:[0,0,1] neg_hi:[0,0,1]
  v_pk_fma_f32 v[202:203], v[210:211], v[194:195], v[202:203] op_sel_hi:[1,0,1] neg_lo:[0,0,1] neg_hi:[0,0,1]
  v_cvt_pk_bf16_f32 v88, v196, v197
  v_cvt_pk_bf16_f32 v89, v198, v199
  v_cvt_pk_bf16_f32 v90, v200, v201
  v_cvt_pk_bf16_f32 v91, v202, v203
  v_pk_fma_f32 v[204:205], v[196:197], v[194:195], v[204:205] op_sel_hi:[1,0,1] neg_lo:[0,0,1] neg_hi:[0,0,1]
  v_pk_fma_f32 v[206:207], v[198:199], v[194:195], v[206:207] op_sel_hi:[1,0,1] neg_lo:[0,0,1] neg_hi:[0,0,1]
  v_pk_fma_f32 v[208:209], v[200:201], v[194:195], v[208:209] op_sel_hi:[1,0,1] neg_lo:[0,0,1] neg_hi:[0,0,1]
  v_pk_fma_f32 v[210:211], v[202:203], v[194:195], v[210:211] op_sel_hi:[1,0,1] neg_lo:[0,0,1] neg_hi:[0,0,1]
  v_cvt_pk_bf16_f32 v92, v204, v205
  v_cvt_pk_bf16_f32 v93, v206, v207
  v_cvt_pk_bf16_f32 v94, v208, v209
  v_cvt_pk_bf16_f32 v95, v210, v211
  v_pk_fma_f32 v[196:197], v[204:205], v[194:195], v[196:197] op_sel_hi:[1,0,1] neg_lo:[0,0,1] neg_hi:[0,0,1]
  v_pk_fma_f32 v[198:199], v[206:207], v[194:195], v[198:199] op_sel_hi:[1,0,1] neg_lo:[0,0,1] neg_hi:[0,0,1]
  v_pk_fma_f32 v[200:201], v[208:209], v[194:195], v[200:201] op_sel_hi:[1,0,1] neg_lo:[0,0,1] neg_hi:[0,0,1]
  v_pk_fma_f32 v[202:203], v[210:211], v[194:195], v[202:203] op_sel_hi:[1,0,1] neg_lo:[0,0,1] neg_hi:[0,0,1]
  v_cvt_pk_bf16_f32 v96, v196, v197
  v_cvt_pk_bf16_f32 v97, v198, v199
  v_cvt_pk_bf16_f32 v98, v200, v201
  v_cvt_pk_bf16_f32 v99, v202, v203
  v_pk_fma_f32 v[204:205], v[196:197], v[194:195], v[204:205] op_sel_hi:[1,0,1] neg_lo:[0,0,1] neg_hi:[0,0,1]
  v_pk_fma_f32 v[206:207], v[198:199], v[194:195], v[206:207] op_sel_hi:[1,0,1] neg_lo:[0,0,1] neg_hi:[0,0,1]
  v_pk_fma_f32 v[208:209], v[200:201], v[194:195], v[208:209] op_sel_hi:[1,0,1] neg_lo:[0,0,1] neg_hi:[0,0,1]
  v_pk_fma_f32 v[210:211], v[202:203], v[194:195], v[210:211] op_sel_hi:[1,0,1] neg_lo:[0,0,1] neg_hi:[0,0,1]
  v_cvt_pk_bf16_f32 v100, v204, v205
  v_cvt_pk_bf16_f32 v101, v206, v207
  v_cvt_pk_bf16_f32 v102, v208, v209
  v_cvt_pk_bf16_f32 v103, v210, v211
  v_pk_fma_f32 v[196:197], v[204:205], v[194:195], v[196:197] op_sel_hi:[1,0,1] neg_lo:[0,0,1] neg_hi:[0,0,1]
  v_pk_fma_f32 v[198:199], v[206:207], v[194:195], v[198:199] op_sel_hi:[1,0,1] neg_lo:[0,0,1] neg_hi:[0,0,1]
  v_pk_fma_f32 v[200:201], v[208:209], v[194:195], v[200:201] op_sel_hi:[1,0,1] neg_lo:[0,0,1] neg_hi:[0,0,1]
  v_pk_fma_f32 v[202:203], v[210:211], v[194:195], v[202:203] op_sel_hi:[1,0,1] neg_lo:[0,0,1] neg_hi:[0,0,1]
  v_cvt_pk_bf16_f32 v104, v196, v197
  v_cvt_pk_bf16_f32 v105, v198, v199
  v_cvt_pk_bf16_f32 v106, v200, v201
  v_cvt_pk_bf16_f32 v107, v202, v203
  v_pk_fma_f32 v[204:205], v[196:197], v[194:195], v[204:205] op_sel_hi:[1,0,1] neg_lo:[0,0,1] neg_hi:[0,0,1]
  v_pk_fma_f32 v[206:207], v[198:199], v[194:195], v[206:207] op_sel_hi:[1,0,1] neg_lo:[0,0,1] neg_hi:[0,0,1]
  v_pk_fma_f32 v[208:209], v[200:201], v[194:195], v[208:209] op_sel_hi:[1,0,1] neg_lo:[0,0,1] neg_hi:[0,0,1]
  v_pk_fma_f32 v[210:211], v[202:203], v[194:195], v[210:211] op_sel_hi:[1,0,1] neg_lo:[0,0,1] neg_hi:[0,0,1]
  v_cvt_pk_bf16_f32 v108, v204, v205
  v_cvt_pk_bf16_f32 v109, v206, v207
  v_cvt_pk_bf16_f32 v110, v208, v209
  v_cvt_pk_bf16_f32 v111, v210, v211
L_setup:
  s_mov_b32 s23, 0x20000
  s_mov_b64 s[20:21], s[68:69]
  s_mov_b64 s[24:25], s[70:71]
  s_mov_b64 s[28:29], s[72:73]
  s_mov_b64 s[32:33], s[74:75]
  s_mov_b32 s31, s23
  s_mov_b32 s35, s23
  s_mov_b32 s27, s23
  s_mov_b32 s11, s23
  s_mov_b32 s22, 0x280000
  s_mov_b32 s10, s22
  s_movk_i32 s30, 0x6400
  s_movk_i32 s34, 0x6400
  s_mov_b32 s26, 0xc8000
  s_mov_b32 s46, 0xf00000
  s_mov_b32 s47, s23
  s_mov_b32 s78, 0x100
  s_mov_b32 s79, s23
  s_mov_b32 s38, 0xc8000
  s_mov_b32 s39, s23
  s_mov_b32 s42, 0x500000
  s_mov_b32 s43, s23
  s_mov_b32 s56, -1
  s_mov_b32 s57, 0
  s_mov_b32 s59, 0
  v_lshlrev_b32 v7, 4, v1
  v_mov_b32 v15, 2.0
  v_mov_b32 v16, 2.0
  v_mov_b32 v17, 2.0
  v_mov_b32 v18, 2.0
  s_mov_b32 s62, 0
  s_mov_b32 s63, 2.0
  s_getreg_b32 s81, hwreg(HW_REG_XCC_ID, 0, 4)
  s_lshr_b32 s49, s3, 2
  s_lshl1_add_u32 s48, s6, s49
  s_and_b32 s49, s3, 1
  s_lshl1_add_u32 s48, s48, s49
  s_lshl4_add_u32 s48, s48, s7
  s_bfe_u32 s49, s3, 0x10001
  s_lshl1_add_u32 s48, s48, s49
  s_lshl2_add_u32 s48, s48, 0x40000
  s_waitcnt lgkmcnt(0)
  v_and_b32 v2, 31, v1
  v_lshrrev_b32 v3, 5, v1
  v_mul_u32_u24 v3, 20, v3
  v_add_u32 v3, v3, v2
  v_lshlrev_b32 v3, 4, v3
  v_add_u32 v10, 5120, v3
  v_add_u32 v8, 61440, v7
  v_add_u32 v11, 66560, v3
  v_add_u32 v9, 122880, v7
  v_add_u32 v12, 128000, v3
  v_lshlrev_b32 v13, 3, v1
  v_add_u32 v14, 81920, v13
  s_mov_b32 s54, 0x000fffff
  s_mov_b32 s55, 0x000fffff
  v_mov_b32 v6, 0xdddddddd
  v_and_b32 v3, 0x1b, v1
  v_cmp_eq_u32 vcc, 24, v3
  v_mov_b32 v3, 0x4b804b80
  s_nop 0
  v_cndmask_b32 v24, 0, v3, vcc
  v_cndmask_b32 v25, 0, v3, vcc
  v_mov_b32 v56, 0
  v_mov_b32 v57, 0
  v_pk_mov_b32 v[26:27], v[24:25], v[24:25]
  v_pk_mov_b32 v[28:29], v[24:25], v[24:25]
  v_pk_mov_b32 v[30:31], v[24:25], v[24:25]
  v_pk_mov_b32 v[32:33], v[24:25], v[24:25]
  v_pk_mov_b32 v[34:35], v[24:25], v[24:25]
  v_pk_mov_b32 v[36:37], v[24:25], v[24:25]
  v_pk_mov_b32 v[38:39], v[24:25], v[24:25]
  v_pk_mov_b32 v[40:41], v[24:25], v[24:25]
  v_pk_mov_b32 v[42:43], v[24:25], v[24:25]
  v_pk_mov_b32 v[44:45], v[24:25], v[24:25]
  v_pk_mov_b32 v[46:47], v[24:25], v[24:25]
  v_pk_mov_b32 v[48:49], v[24:25], v[24:25]
  v_pk_mov_b32 v[50:51], v[24:25], v[24:25]
  v_pk_mov_b32 v[52:53], v[24:25], v[24:25]
  v_pk_mov_b32 v[54:55], v[24:25], v[24:25]
  v_pk_mov_b32 v[58:59], v[56:57], v[56:57]
  v_pk_mov_b32 v[60:61], v[56:57], v[56:57]
  v_pk_mov_b32 v[62:63], v[56:57], v[56:57]
  v_pk_mov_b32 v[64:65], v[56:57], v[56:57]
  v_pk_mov_b32 v[66:67], v[56:57], v[56:57]
  v_pk_mov_b32 v[68:69], v[56:57], v[56:57]
  v_pk_mov_b32 v[70:71], v[56:57], v[56:57]
  s_mul_i32 s65, s3, 25600
  s_mul_i32 s64, s7, 102400
  s_add_u32 s64, s64, s65
  s_add_u32 s64, s64, 0x720000
  s_add_u32 s65, s65, 10240
  s_and_b32 s49, s3, 1
  s_lshl1_add_u32 s49, s6, s49
  s_lshl3_add_u32 s49, s49, s7
  s_mul_i32 s49, s49, 5120
  s_add_u32 s49, s49, 0x100000
  s_lshr_b32 s50, s3, 1
  s_lshl_b32 s66, s50, 10
  s_add_u32 s66, s66, s49
  s_lshl_b32 s67, s50, 8
  s_add_u32 s67, s67, s49
  s_add_u32 s67, s67, 4096
  s_lshl_b32 s58, s3, 12
  s_and_b32 s49, s3, 1
  s_lshl2_add_u32 s49, s49, s50
  s_mulk_i32 s49, 1280
  s_add_u32 s49, s49, 114688
  v_add_u32 v19, s49, v7
  v_and_b32 v20, 0xff, v13
  v_add_u32 v20, s49, v20
  v_pk_mov_b32 v[238:239], v[56:57], v[56:57]
  v_pk_mov_b32 v[242:243], v[56:57], v[56:57]
  v_pk_mov_b32 v[244:245], v[56:57], v[56:57]
  v_pk_mov_b32 v[246:247], v[56:57], v[56:57]
  s_cmp_ge_u32 s3, 4
  s_cbranch_scc1 L_noop
  v_and_b32 v2, 15, v1
  v_lshrrev_b32 v3, 4, v1
  v_lshrrev_b32 v244, 1, v3
  v_and_b32 v5, 1, v3
  s_lshl_b32 s49, s3, 8
  s_add_u32 s49, s49, s2
  s_lshl_b32 s14, s49, 10
  s_add_u32 s14, s14, 0x720000
  s_mul_i32 s50, s49, 5243
  s_lshr_b32 s50, s50, 19
  s_mul_i32 s51, s50, 100
  s_sub_u32 s52, s49, s51
  s_mul_i32 s51, s52, 205
  s_lshr_b32 s51, s51, 10
  s_mul_i32 s82, s51, 5
  s_sub_u32 s52, s52, s82
  s_cmp_ge_u32 s51, 10
  s_cselect_b32 s82, 40, 0
  s_cselect_b32 s83, 10, 0
  s_sub_u32 s83, s51, s83
  v_mul_u32_u24 v4, 20, v244
  v_lshl_add_u32 v4, v5, 2, v4
  v_mul_u32_u24 v242, 80, v3
  s_mul_i32 s51, s83, 80
  s_mul_i32 s12, s83, 320
  s_sub_u32 s12, s12, 2544
  s_cmp_lt_u32 s83, 8
  s_cselect_b64 vcc, -1, 0
  s_cselect_b32 s51, s51, s12
  s_cselect_b32 s13, 8, 20
  v_cndmask_b32 v242, v242, v4, vcc
  s_add_u32 s51, s51, s82
  s_mulk_i32 s51, 1280
  s_mulk_i32 s13, 1280
  v_mul_u32_u24 v242, 1280, v242
  s_cmp_lt_u32 s52, 4
  s_cselect_b32 s82, 8, 2
  s_cselect_b32 s52, s52, 64
  v_mad_u32_u24 v242, v2, s82, v242
  s_mulk_i32 s50, 160
  s_lshl1_add_u32 s50, s52, s50
  s_add_u32 s12, s51, s50
  s_cmp_lt_u32 s49, 800
  s_cselect_b32 s12, s12, 2.0
  s_cselect_b32 s14, s14, 2.0
  s_add_u32 s13, s13, s12
  v_add_u32 v240, 10240, v7
  v_add_u32 v241, 61440, v7
  s_and_b32 s50, s3, 1
  s_lshl_b32 s50, s50, 4
  v_add_u32 v4, s50, v2
  v_mul_u32_u24 v245, 5120, v3
  v_lshl_add_u32 v245, v4, 3, v245
  v_mul_u32_u24 v246, 10240, v3
  v_lshl_add_u32 v247, v2, 1, v246
  v_lshl_add_u32 v246, v2, 3, v246
  v_lshlrev_b32 v244, 9, v3
  v_lshl_add_u32 v244, v4, 4, v244
  v_and_b32 v243, 15, v1
  s_lshr_b32 s50, s3, 1
  s_lshl_b32 s50, s50, 7
  v_lshl_add_u32 v243, v243, 2, s50
L_noop:
  v_and_b32 v2, 15, v1
  v_lshrrev_b32 v3, 4, v1
  v_bfe_u32 v4, v1, 1, 3
  v_xor_b32 v4, v4, v3
  v_lshlrev_b32 v4, 4, v4
  v_lshl_add_u32 v23, v2, 7, v4
  s_cmp_ge_u32 s3, 2
  s_cbranch_scc1 L_notq
  s_branch L_page
.p2align 12
L_page:
  s_lshl1_add_u32 s53, s2, s3
  s_cmp_eq_u32 s53, 1
  s_cbranch_scc0 L_noz
  s_waitcnt vmcnt(5)
  s_atomic_add s53, s[76:77], 0
L_noz:
  v_add_u32 v76, 32768, v23
  v_xor_b32 v77, 64, v76
  s_lshl_b32 s49, s3, 12
  s_add_u32 s49, s49, 53248
  v_add_u32 v79, s49, v23
  v_xor_b32 v80, 64, v79
  v_add_u32 v81, 61440, v79
  v_add_u32 v82, 61440, v80
  s_movk_i32 s51, 2048
  s_mov_b32 s49, 55296
  s_cmp_eq_u32 s3, 0
  s_cselect_b32 s49, 32768, s49
  s_cselect_b32 s71, s51, 20480
  s_cselect_b32 s72, s51, -81920
  v_add_u32 v72, s49, v23
  v_xor_b32 v73, 64, v72
  v_bfe_u32 v4, v1, 2, 2
  v_and_b32 v5, 3, v1
  v_lshl_add_u32 v96, v3, 3, v4
  v_mul_u32_u24 v96, 40, v96
  v_lshl_add_u32 v96, v5, 3, v96
  s_lshl_b32 s50, s3, 5
  s_add_u32 s50, s50, 0
  v_add_u32 v78, s50, v96
  v_and_b32 v96, 1, v3
  v_lshl_add_u32 v4, v96, 2, v4
  v_lshrrev_b32 v96, 1, v3
  v_lshl_add_u32 v4, v96, 4, v4
  v_mul_u32_u24 v4, 160, v4
  v_lshl_add_u32 v4, v5, 3, v4
  v_add_u32 v83, 59392, v4
  v_add_u32 v84, 61440, v83
  s_lshr_b32 s49, s7, 2
  s_xor_b32 s49, s49, s3
  s_mulk_i32 s49, 5120
  s_add_u32 s49, s49, 114688
  s_and_b32 s50, s7, 2
  s_lshl_b32 s50, s50, 3
  v_add_u32 v98, s50, v2
  v_xor_b32 v99, 16, v98
  v_lshlrev_b32 v5, 3, v3
  s_mov_b32 s50, 0x62604240
  v_lshrrev_b32 v4, v5, s50
  v_and_b32 v96, 31, v4
  v_lshl_add_u32 v96, v96, 8, s49
  v_bfe_u32 v97, v4, 5, 1
  v_lshl_add_u32 v96, v97, 3, v96
  v_bfe_u32 v97, v4, 6, 1
  v_add_u32 v97, 3, v97
  v_lshl_add_u32 v85, v98, v97, v96
  v_lshl_add_u32 v86, v99, v97, v96
  s_mov_b32 s50, 0x65474504
  v_lshrrev_b32 v4, v5, s50
  v_and_b32 v96, 31, v4
  v_lshl_add_u32 v96, v96, 8, s49
  v_bfe_u32 v97, v4, 5, 1
  v_lshl_add_u32 v96, v97, 3, v96
  v_bfe_u32 v97, v4, 6, 1
  v_add_u32 v97, 3, v97
  v_lshl_add_u32 v87, v98, v97, v96
  v_lshl_add_u32 v88, v99, v97, v96
  s_mov_b32 s50, 0x4c4a0967
  v_lshrrev_b32 v4, v5, s50
  v_and_b32 v96, 31, v4
  v_lshl_add_u32 v96, v96, 8, s49
  v_bfe_u32 v97, v4, 5, 1
  v_lshl_add_u32 v96, v97, 3, v96
  v_bfe_u32 v97, v4, 6, 1
  v_add_u32 v97, 3, v97
  v_lshl_add_u32 v89, v98, v97, v96
  v_lshl_add_u32 v90, v99, v97, v96
  s_mov_b32 s50, 0x4f0e6c6a
  v_lshrrev_b32 v4, v5, s50
  v_and_b32 v96, 31, v4
  v_lshl_add_u32 v96, v96, 8, s49
  v_bfe_u32 v97, v4, 5, 1
  v_lshl_add_u32 v96, v97, 3, v96
  v_bfe_u32 v97, v4, 6, 1
  v_add_u32 v97, 3, v97
  v_lshl_add_u32 v91, v98, v97, v96
  v_lshl_add_u32 v92, v99, v97, v96
  s_mov_b32 s50, 0x13716f51
  v_lshrrev_b32 v4, v5, s50
  v_and_b32 v96, 31, v4
  v_lshl_add_u32 v96, v96, 8, s49
  v_bfe_u32 v97, v4, 5, 1
  v_lshl_add_u32 v96, v97, 3, v96
  v_bfe_u32 v97, v4, 6, 1
  v_add_u32 v97, 3, v97
  v_lshl_add_u32 v93, v98, v97, v96
  v_lshl_add_u32 v94, v99, v97, v96
  v_cvt_f32_u32 v96, v2
  v_cvt_f32_u32 v97, v3
  v_mul_f32 v96, 0x3d000000, v96
  v_mul_f32 v97, 4.0, v97
  s_mul_i32 s49, s3, 0xbe800000
  v_fma_f32 v97, v97, v96, s49
  s_lshl_b32 s49, s3, 10
  v_add_u32 v4, s49, v7
  v_fmamk_f32 v104, v96, 0x0, v97
  v_fmamk_f32 v105, v96, 0x3f800000, v97
  v_fmamk_f32 v106, v96, 0x40000000, v97
  v_fmamk_f32 v107, v96, 0x40400000, v97
  v_fmamk_f32 v108, v96, 0x41800000, v97
  v_fmamk_f32 v109, v96, 0x41880000, v97
  v_fmamk_f32 v110, v96, 0x41900000, v97
  v_fmamk_f32 v111, v96, 0x41980000, v97
  v_cos_f32 v104, v104
  v_cos_f32 v105, v105
  v_cos_f32 v106, v106
  v_cos_f32 v107, v107
  v_cos_f32 v108, v108
  v_cos_f32 v109, v109
  v_cos_f32 v110, v110
  v_cos_f32 v111, v111
  v_cvt_pk_bf16_f32 v100, v104, v105
  v_cvt_pk_bf16_f32 v101, v106, v107
  v_cvt_pk_bf16_f32 v102, v108, v109
  v_cvt_pk_bf16_f32 v103, v110, v111
  ds_write_b128 v4, v[100:103] offset:26624
  s_lshl_b32 s68, s3, 8
  s_add_u32 s68, s68, s2
  s_lshr_b32 s49, s68, 4
  s_and_b32 s50, s68, 8
  s_lshl_b32 s50, s50, 7
  s_add_u32 s50, s50, s49
  v_and_b32 v96, 31, v1
  v_lshl_add_u32 v96, v96, 5, s50
  v_cvt_f32_u32 v96, v96
  v_mul_f32 v96, 0x3a000000, v96
  s_and_b32 s69, s68, 7
  s_lshl_b32 s69, s69, 3
  v_lshrrev_b32 v97, 5, v1
  v_lshl_add_u32 v97, v97, 2, s69
  v_cvt_f32_u32 v97, v97
  v_mul_f32 v97, v96, v97
  s_lshl_b32 s68, s68, 10
  s_add_u32 s73, s68, 0x80000
  v_fmamk_f32 v112, v96, 0x0, v97
  v_fmamk_f32 v113, v96, 0x3f800000, v97
  v_fmamk_f32 v114, v96, 0x40000000, v97
  v_fmamk_f32 v115, v96, 0x40400000, v97
  v_cos_f32 v116, v112
  v_cos_f32 v117, v113
  v_cos_f32 v118, v114
  v_cos_f32 v119, v115
  v_sin_f32 v112, v112
  v_sin_f32 v113, v113
  v_sin_f32 v114, v114
  v_sin_f32 v115, v115
  v_cvt_pk_bf16_f32 v248, v116, -v112
  v_cvt_pk_bf16_f32 v249, v117, -v113
  v_cvt_pk_bf16_f32 v250, v118, -v114
  v_cvt_pk_bf16_f32 v251, v119, -v115
  s_mov_b64 exec, 0
  s_cmp_eq_u32 s3, 0
  s_cbranch_scc1 L_pad0
  s_branch L_pad1
L_padend:
  s_mov_b64 exec, -1
  s_lshr_b32 s68, s6, 1
  s_mul_i32 s68, s68, 10240
  s_and_b32 s69, s6, 1
  s_lshr_b32 s70, s7, 1
  s_lshl2_add_u32 s69, s69, s70
  s_bitcmp0_b32 s7, 0
  s_cbranch_scc0 L_vjob
  s_waitcnt lgkmcnt(0)
  s_barrier
  ds_read_b128 v[104:107], v76 offset:0
  ds_read_b64_tr_b16 v[108:109], v78 offset:0
  ds_read_b64_tr_b16 v[110:111], v78 offset:160
  ds_read_b128 v[112:115], v77 offset:0
  ds_read_b64_tr_b16 v[116:117], v78 offset:1280
  ds_read_b64_tr_b16 v[118:119], v78 offset:1440
  ds_read_b128 v[120:123], v76 offset:2048
  ds_read_b64_tr_b16 v[124:125], v78 offset:2560
  ds_read_b64_tr_b16 v[126:127], v78 offset:2720
  ds_read_b128 v[128:131], v77 offset:2048
  ds_read_b64_tr_b16 v[132:133], v78 offset:3840
  ds_read_b64_tr_b16 v[134:135], v78 offset:4000
  ds_read_b128 v[136:139], v76 offset:4096
  ds_read_b64_tr_b16 v[140:141], v78 offset:5120
  ds_read_b64_tr_b16 v[142:143], v78 offset:5280
  s_waitcnt lgkmcnt(12)
  v_mfma_f32_16x16x32_bf16 v[96:99], v[108:111], v[104:107], 0
  ds_read_b128 v[104:107], v77 offset:4096
  ds_read_b64_tr_b16 v[108:109], v78 offset:6400
  ds_read_b64_tr_b16 v[110:111], v78 offset:6560
  s_waitcnt lgkmcnt(12)
  v_mfma_f32_16x16x32_bf16 v[96:99], v[116:119], v[112:115], v[96:99]
  ds_read_b128 v[112:115], v76 offset:6144
  ds_read_b64_tr_b16 v[116:117], v78 offset:7680
  ds_read_b64_tr_b16 v[118:119], v78 offset:7840
  s_waitcnt lgkmcnt(12)
  v_mfma_f32_16x16x32_bf16 v[96:99], v[124:127], v[120:123], v[96:99]
  ds_read_b128 v[120:123], v77 offset:6144
  ds_read_b64_tr_b16 v[124:125], v78 offset:8960
  ds_read_b64_tr_b16 v[126:127], v78 offset:9120
  s_waitcnt lgkmcnt(12)
  v_mfma_f32_16x16x32_bf16 v[96:99], v[132:135], v[128:131], v[96:99]
  ds_read_b128 v[128:131], v76 offset:8192
  ds_read_b64_tr_b16 v[132:133], v78 offset:10240
  ds_read_b64_tr_b16 v[134:135], v78 offset:10400
  s_waitcnt lgkmcnt(12)
  v_mfma_f32_16x16x32_bf16 v[96:99], v[140:143], v[136:139], v[96:99]
  ds_read_b128 v[136:139], v77 offset:8192
  ds_read_b64_tr_b16 v[140:141], v78 offset:11520
  ds_read_b64_tr_b16 v[142:143], v78 offset:11680
  s_waitcnt lgkmcnt(12)
  v_mfma_f32_16x16x32_bf16 v[96:99], v[108:111], v[104:107], v[96:99]
  ds_read_b128 v[104:107], v76 offset:10240
  ds_read_b64_tr_b16 v[108:109], v78 offset:12800
  ds_read_b64_tr_b16 v[110:111], v78 offset:12960
  s_waitcnt lgkmcnt(12)
  v_mfma_f32_16x16x32_bf16 v[96:99], v[116:119], v[112:115], v[96:99]
  ds_read_b128 v[112:115], v77 offset:10240
  ds_read_b64_tr_b16 v[116:117], v78 offset:14080
  ds_read_b64_tr_b16 v[118:119], v78 offset:14240
  s_waitcnt lgkmcnt(12)
  v_mfma_f32_16x16x32_bf16 v[96:99], v[124:127], v[120:123], v[96:99]
  ds_read_b128 v[120:123], v76 offset:12288
  ds_read_b64_tr_b16 v[124:125], v78 offset:15360
  ds_read_b64_tr_b16 v[126:127], v78 offset:15520
  s_waitcnt lgkmcnt(12)
  v_mfma_f32_16x16x32_bf16 v[96:99], v[132:135], v[128:131], v[96:99]
  ds_read_b128 v[128:131], v77 offset:12288
  ds_read_b64_tr_b16 v[132:133], v78 offset:16640
  ds_read_b64_tr_b16 v[134:135], v78 offset:16800
  s_waitcnt lgkmcnt(12)
  v_mfma_f32_16x16x32_bf16 v[96:99], v[140:143], v[136:139], v[96:99]
  ds_read_b128 v[136:139], v76 offset:14336
  ds_read_b64_tr_b16 v[140:141], v78 offset:17920
  ds_read_b64_tr_b16 v[142:143], v78 offset:18080
  s_waitcnt lgkmcnt(12)
  v_mfma_f32_16x16x32_bf16 v[96:99], v[108:111], v[104:107], v[96:99]
  ds_read_b128 v[104:107], v77 offset:14336
  ds_read_b64_tr_b16 v[108:109], v78 offset:19200
  ds_read_b64_tr_b16 v[110:111], v78 offset:19360
  s_waitcnt lgkmcnt(12)
  v_mfma_f32_16x16x32_bf16 v[96:99], v[116:119], v[112:115], v[96:99]
  ds_read_b128 v[112:115], v76 offset:16384
  ds_read_b64_tr_b16 v[116:117], v78 offset:20480
  ds_read_b64_tr_b16 v[118:119], v78 offset:20640
  s_waitcnt lgkmcnt(12)
  v_mfma_f32_16x16x32_bf16 v[96:99], v[124:127], v[120:123], v[96:99]
  ds_read_b128 v[120:123], v77 offset:16384
  ds_read_b64_tr_b16 v[124:125], v78 offset:21760
  ds_read_b64_tr_b16 v[126:127], v78 offset:21920
  s_waitcnt lgkmcnt(12)
  v_mfma_f32_16x16x32_bf16 v[96:99], v[132:135], v[128:131], v[96:99]
  ds_read_b128 v[128:131], v76 offset:18432
  ds_read_b64_tr_b16 v[132:133], v78 offset:23040
  ds_read_b64_tr_b16 v[134:135], v78 offset:23200
  s_waitcnt lgkmcnt(12)
  v_mfma_f32_16x16x32_bf16 v[96:99], v[140:143], v[136:139], v[96:99]
  ds_read_b128 v[136:139], v77 offset:18432
  ds_read_b64_tr_b16 v[140:141], v78 offset:24320
  ds_read_b64_tr_b16 v[142:143], v78 offset:24480
  s_waitcnt lgkmcnt(12)
  v_mfma_f32_16x16x32_bf16 v[96:99], v[108:111], v[104:107], v[96:99]
  s_waitcnt lgkmcnt(9)
  v_mfma_f32_16x16x32_bf16 v[96:99], v[116:119], v[112:115], v[96:99]
  s_waitcnt lgkmcnt(6)
  v_mfma_f32_16x16x32_bf16 v[96:99], v[124:127], v[120:123], v[96:99]
  s_waitcnt lgkmcnt(3)
  v_mfma_f32_16x16x32_bf16 v[96:99], v[132:135], v[128:131], v[96:99]
  s_waitcnt lgkmcnt(0)
  v_mfma_f32_16x16x32_bf16 v[96:99], v[140:143], v[136:139], v[96:99]
  s_lshr_b32 s49, s69, 1
  s_lshl_b32 s49, s49, 10
  s_and_b32 s50, s69, 1
  s_lshl_b32 s50, s50, 8
  s_add_u32 s49, s49, s50
  s_add_u32 s49, s49, s68
  s_lshl_b32 s50, s69, 7
  s_add_u32 s50, s50, s68
  s_add_u32 s50, s50, 4096
  v_mul_f32 v96, 0x3ea52b5c, v96
  v_mul_f32 v97, 0x3ea52b5c, v97
  v_mul_f32 v98, 0x3ea52b5c, v98
  v_mul_f32 v99, 0x3ea52b5c, v99
  v_cvt_pk_bf16_f32 v104, v96, v97
  v_cvt_pk_bf16_f32 v105, v98, v99
  s_cmp_eq_u32 s3, 0
  s_cbranch_scc1 L_kajob
  s_mov_b64 exec, 0xffff
  buffer_store_dwordx2 v[104:105], v13, s[44:47], s50 offen sc1
  s_branch L_kvdone
L_kajob:
  v_mov_b32 v106, v104
  v_mov_b32 v107, v105
  v_lshlrev_b32 v4, 9, v3
  v_lshl_add_u32 v4, v2, 4, v4
  v_permlane32_swap_b32 v104, v106
  v_permlane32_swap_b32 v105, v107
  s_mov_b64 exec, s[56:57]
  buffer_store_dwordx4 v[104:107], v4, s[44:47], s49 offen sc1
  s_branch L_kvdone
L_vjob:
  s_waitcnt lgkmcnt(0)
  s_barrier
  ds_read_b128 v[104:107], v76 offset:0
  ds_read_b64_tr_b16 v[108:109], v78 offset:0
  ds_read_b64_tr_b16 v[110:111], v78 offset:160
  ds_read_b128 v[112:115], v77 offset:0
  ds_read_b64_tr_b16 v[116:117], v78 offset:1280
  ds_read_b64_tr_b16 v[118:119], v78 offset:1440
  ds_read_b128 v[120:123], v76 offset:2048
  ds_read_b64_tr_b16 v[124:125], v78 offset:2560
  ds_read_b64_tr_b16 v[126:127], v78 offset:2720
  ds_read_b128 v[128:131], v77 offset:2048
  ds_read_b64_tr_b16 v[132:133], v78 offset:3840
  ds_read_b64_tr_b16 v[134:135], v78 offset:4000
  ds_read_b128 v[136:139], v76 offset:4096
  ds_read_b64_tr_b16 v[140:141], v78 offset:5120
  ds_read_b64_tr_b16 v[142:143], v78 offset:5280
  s_waitcnt lgkmcnt(12)
  v_mfma_f32_16x16x32_bf16 v[96:99], v[104:107], v[108:111], 0
  ds_read_b128 v[104:107], v77 offset:4096
  ds_read_b64_tr_b16 v[108:109], v78 offset:6400
  ds_read_b64_tr_b16 v[110:111], v78 offset:6560
  s_waitcnt lgkmcnt(12)
  v_mfma_f32_16x16x32_bf16 v[96:99], v[112:115], v[116:119], v[96:99]
  ds_read_b128 v[112:115], v76 offset:6144
  ds_read_b64_tr_b16 v[116:117], v78 offset:7680
  ds_read_b64_tr_b16 v[118:119], v78 offset:7840
  s_waitcnt lgkmcnt(12)
  v_mfma_f32_16x16x32_bf16 v[96:99], v[120:123], v[124:127], v[96:99]
  ds_read_b128 v[120:123], v77 offset:6144
  ds_read_b64_tr_b16 v[124:125], v78 offset:8960
  ds_read_b64_tr_b16 v[126:127], v78 offset:9120
  s_waitcnt lgkmcnt(12)
  v_mfma_f32_16x16x32_bf16 v[96:99], v[128:131], v[132:135], v[96:99]
  ds_read_b128 v[128:131], v76 offset:8192
  ds_read_b64_tr_b16 v[132:133], v78 offset:10240
  ds_read_b64_tr_b16 v[134:135], v78 offset:10400
  s_waitcnt lgkmcnt(12)
  v_mfma_f32_16x16x32_bf16 v[96:99], v[136:139], v[140:143], v[96:99]
  ds_read_b128 v[136:139], v77 offset:8192
  ds_read_b64_tr_b16 v[140:141], v78 offset:11520
  ds_read_b64_tr_b16 v[142:143], v78 offset:11680
  s_waitcnt lgkmcnt(12)
  v_mfma_f32_16x16x32_bf16 v[96:99], v[104:107], v[108:111], v[96:99]
  ds_read_b128 v[104:107], v76 offset:10240
  ds_read_b64_tr_b16 v[108:109], v78 offset:12800
  ds_read_b64_tr_b16 v[110:111], v78 offset:12960
  s_waitcnt lgkmcnt(12)
  v_mfma_f32_16x16x32_bf16 v[96:99], v[112:115], v[116:119], v[96:99]
  ds_read_b128 v[112:115], v77 offset:10240
  ds_read_b64_tr_b16 v[116:117], v78 offset:14080
  ds_read_b64_tr_b16 v[118:119], v78 offset:14240
  s_waitcnt lgkmcnt(12)
  v_mfma_f32_16x16x32_bf16 v[96:99], v[120:123], v[124:127], v[96:99]
  ds_read_b128 v[120:123], v76 offset:12288
  ds_read_b64_tr_b16 v[124:125], v78 offset:15360
  ds_read_b64_tr_b16 v[126:127], v78 offset:15520
  s_waitcnt lgkmcnt(12)
  v_mfma_f32_16x16x32_bf16 v[96:99], v[128:131], v[132:135], v[96:99]
  ds_read_b128 v[128:131], v77 offset:12288
  ds_read_b64_tr_b16 v[132:133], v78 offset:16640
  ds_read_b64_tr_b16 v[134:135], v78 offset:16800
  s_waitcnt lgkmcnt(12)
  v_mfma_f32_16x16x32_bf16 v[96:99], v[136:139], v[140:143], v[96:99]
  ds_read_b128 v[136:139], v76 offset:14336
  ds_read_b64_tr_b16 v[140:141], v78 offset:17920
  ds_read_b64_tr_b16 v[142:143], v78 offset:18080
  s_waitcnt lgkmcnt(12)
  v_mfma_f32_16x16x32_bf16 v[96:99], v[104:107], v[108:111], v[96:99]
  ds_read_b128 v[104:107], v77 offset:14336
  ds_read_b64_tr_b16 v[108:109], v78 offset:19200
  ds_read_b64_tr_b16 v[110:111], v78 offset:19360
  s_waitcnt lgkmcnt(12)
  v_mfma_f32_16x16x32_bf16 v[96:99], v[112:115], v[116:119], v[96:99]
  ds_read_b128 v[112:115], v76 offset:16384
  ds_read_b64_tr_b16 v[116:117], v78 offset:20480
  ds_read_b64_tr_b16 v[118:119], v78 offset:20640
  s_waitcnt lgkmcnt(12)
  v_mfma_f32_16x16x32_bf16 v[96:99], v[120:123], v[124:127], v[96:99]
  ds_read_b128 v[120:123], v77 offset:16384
  ds_read_b64_tr_b16 v[124:125], v78 offset:21760
  ds_read_b64_tr_b16 v[126:127], v78 offset:21920
  s_waitcnt lgkmcnt(12)
  v_mfma_f32_16x16x32_bf16 v[96:99], v[128:131], v[132:135], v[96:99]
  ds_read_b128 v[128:131], v76 offset:18432
  ds_read_b64_tr_b16 v[132:133], v78 offset:23040
  ds_read_b64_tr_b16 v[134:135], v78 offset:23200
  s_waitcnt lgkmcnt(12)
  v_mfma_f32_16x16x32_bf16 v[96:99], v[136:139], v[140:143], v[96:99]
  ds_read_b128 v[136:139], v77 offset:18432
  ds_read_b64_tr_b16 v[140:141], v78 offset:24320
  ds_read_b64_tr_b16 v[142:143], v78 offset:24480
  s_waitcnt lgkmcnt(12)
  v_mfma_f32_16x16x32_bf16 v[96:99], v[104:107], v[108:111], v[96:99]
  s_waitcnt lgkmcnt(9)
  v_mfma_f32_16x16x32_bf16 v[96:99], v[112:115], v[116:119], v[96:99]
  s_waitcnt lgkmcnt(6)
  v_mfma_f32_16x16x32_bf16 v[96:99], v[120:123], v[124:127], v[96:99]
  s_waitcnt lgkmcnt(3)
  v_mfma_f32_16x16x32_bf16 v[96:99], v[128:131], v[132:135], v[96:99]
  s_waitcnt lgkmcnt(0)
  v_mfma_f32_16x16x32_bf16 v[96:99], v[136:139], v[140:143], v[96:99]
  s_mul_i32 s49, s69, 640
  s_add_u32 s49, s49, s68
  s_lshl_b32 s51, s3, 8
  s_add_u32 s49, s49, s51
  s_mov_b32 s50, 0x4b800000
  s_cmp_eq_u32 s3, 0
  s_cselect_b32 s51, 0xffff, 15
  s_nop 1
  v_mul_f32 v96, s50, v96
  v_mul_f32 v97, s50, v97
  v_mul_f32 v98, s50, v98
  v_mul_f32 v99, s50, v99
  v_cvt_pk_bf16_f32 v104, v96, v97
  v_cvt_pk_bf16_f32 v105, v98, v99
  v_cvt_pk_bf16_f32 v106, v96, v97
  v_cvt_pk_bf16_f32 v107, v98, v99
  s_nop 1
  v_permlane16_swap_b32 v104, v106
  v_permlane16_swap_b32 v105, v107
  s_mov_b32 exec_lo, s51
  s_mov_b32 exec_hi, s51
  buffer_store_dwordx4 v[104:107], v10, s[44:47], s49 offen sc1
L_kvdone:
L_pad0:
  s_cbranch_execz L_pad2
  s_mov_b64 exec, -1
  s_barrier
  ds_read_b128 v[136:139], v72
  ds_read_b128 v[140:143], v79 offset:0
  ds_read_b64_tr_b16 v[144:145], v83 offset:0
  ds_read_b64_tr_b16 v[146:147], v83 offset:1280
  ds_read_b64_tr_b16 v[148:149], v83 offset:32
  ds_read_b64_tr_b16 v[150:151], v83 offset:1312
  ds_read_b64_tr_b16 v[152:153], v83 offset:64
  ds_read_b64_tr_b16 v[154:155], v83 offset:1344
  ds_read_b64_tr_b16 v[156:157], v83 offset:96
  ds_read_b64_tr_b16 v[158:159], v83 offset:1376
  ds_read_b64_tr_b16 v[160:161], v83 offset:128
  ds_read_b64_tr_b16 v[162:163], v83 offset:1408
  s_waitcnt lgkmcnt(6)
  v_mfma_f32_16x16x32_bf16 v[96:99], v[144:147], v[136:139], 0
  ds_read_b128 v[164:167], v73
  ds_read_b128 v[168:171], v80 offset:0
  v_mfma_f32_16x16x32_bf16 v[116:119], v[144:147], v[140:143], 0
  ds_read_b64_tr_b16 v[172:173], v83 offset:5120
  ds_read_b64_tr_b16 v[174:175], v83 offset:6400
  v_mfma_f32_16x16x32_bf16 v[100:103], v[148:151], v[136:139], 0
  ds_read_b64_tr_b16 v[176:177], v83 offset:5152
  ds_read_b64_tr_b16 v[178:179], v83 offset:6432
  v_mfma_f32_16x16x32_bf16 v[120:123], v[148:151], v[140:143], 0
  ds_read_b64_tr_b16 v[180:181], v83 offset:5184
  ds_read_b64_tr_b16 v[182:183], v83 offset:6464
  s_waitcnt lgkmcnt(10)
  v_mfma_f32_16x16x32_bf16 v[104:107], v[152:155], v[136:139], 0
  ds_read_b64_tr_b16 v[184:185], v83 offset:5216
  ds_read_b64_tr_b16 v[186:187], v83 offset:6496
  v_mfma_f32_16x16x32_bf16 v[124:127], v[152:155], v[140:143], 0
  ds_read_b64_tr_b16 v[188:189], v83 offset:5248
  ds_read_b64_tr_b16 v[190:191], v83 offset:6528
  v_mfma_f32_16x16x32_bf16 v[108:111], v[156:159], v[136:139], 0
  v_mfma_f32_16x16x32_bf16 v[128:131], v[156:159], v[140:143], 0
  s_waitcnt lgkmcnt(12)
  v_mfma_f32_16x16x32_bf16 v[112:115], v[160:163], v[136:139], 0
  v_mfma_f32_16x16x32_bf16 v[132:135], v[160:163], v[140:143], 0
  s_waitcnt lgkmcnt(6)
  v_mfma_f32_16x16x32_bf16 v[96:99], v[172:175], v[164:167], v[96:99]
  v_mfma_f32_16x16x32_bf16 v[116:119], v[172:175], v[168:171], v[116:119]
  v_add_u32 v72, s71, v72
  v_add_u32 v73, s71, v73
  v_mfma_f32_16x16x32_bf16 v[100:103], v[176:179], v[164:167], v[100:103]
  s_waitcnt lgkmcnt(0)
  v_mfma_f32_16x16x32_bf16 v[120:123], v[176:179], v[168:171], v[120:123]
  s_barrier
  v_mfma_f32_16x16x32_bf16 v[104:107], v[180:183], v[164:167], v[104:107]
  ds_read_b128 v[136:139], v72
  ds_read_b128 v[140:143], v79 offset:20480
  v_mfma_f32_16x16x32_bf16 v[124:127], v[180:183], v[168:171], v[124:127]
  ds_read_b64_tr_b16 v[144:145], v83 offset:20480
  ds_read_b64_tr_b16 v[146:147], v83 offset:21760
  v_mfma_f32_16x16x32_bf16 v[108:111], v[184:187], v[164:167], v[108:111]
  ds_read_b64_tr_b16 v[148:149], v83 offset:20512
  ds_read_b64_tr_b16 v[150:151], v83 offset:21792
  v_mfma_f32_16x16x32_bf16 v[128:131], v[184:187], v[168:171], v[128:131]
  ds_read_b64_tr_b16 v[152:153], v83 offset:20544
  ds_read_b64_tr_b16 v[154:155], v83 offset:21824
  v_mfma_f32_16x16x32_bf16 v[112:115], v[188:191], v[164:167], v[112:115]
  ds_read_b64_tr_b16 v[156:157], v83 offset:20576
  ds_read_b64_tr_b16 v[158:159], v83 offset:21856
  v_mfma_f32_16x16x32_bf16 v[132:135], v[188:191], v[168:171], v[132:135]
  ds_read_b64_tr_b16 v[160:161], v83 offset:20608
  ds_read_b64_tr_b16 v[162:163], v83 offset:21888
  s_waitcnt lgkmcnt(6)
  v_mfma_f32_16x16x32_bf16 v[96:99], v[144:147], v[136:139], v[96:99]
  ds_read_b128 v[164:167], v73
  ds_read_b128 v[168:171], v80 offset:20480
  v_mfma_f32_16x16x32_bf16 v[116:119], v[144:147], v[140:143], v[116:119]
  ds_read_b64_tr_b16 v[172:173], v83 offset:25600
  ds_read_b64_tr_b16 v[174:175], v83 offset:26880
  v_mfma_f32_16x16x32_bf16 v[100:103], v[148:151], v[136:139], v[100:103]
  ds_read_b64_tr_b16 v[176:177], v83 offset:25632
  ds_read_b64_tr_b16 v[178:179], v83 offset:26912
  v_mfma_f32_16x16x32_bf16 v[120:123], v[148:151], v[140:143], v[120:123]
  ds_read_b64_tr_b16 v[180:181], v83 offset:25664
  ds_read_b64_tr_b16 v[182:183], v83 offset:26944
  s_waitcnt lgkmcnt(10)
  v_mfma_f32_16x16x32_bf16 v[104:107], v[152:155], v[136:139], v[104:107]
  ds_read_b64_tr_b16 v[184:185], v83 offset:25696
  ds_read_b64_tr_b16 v[186:187], v83 offset:26976
  v_mfma_f32_16x16x32_bf16 v[124:127], v[152:155], v[140:143], v[124:127]
  ds_read_b64_tr_b16 v[188:189], v83 offset:25728
  ds_read_b64_tr_b16 v[190:191], v83 offset:27008
  v_mfma_f32_16x16x32_bf16 v[108:111], v[156:159], v[136:139], v[108:111]
  v_mfma_f32_16x16x32_bf16 v[128:131], v[156:159], v[140:143], v[128:131]
  s_waitcnt lgkmcnt(12)
  v_mfma_f32_16x16x32_bf16 v[112:115], v[160:163], v[136:139], v[112:115]
  v_mfma_f32_16x16x32_bf16 v[132:135], v[160:163], v[140:143], v[132:135]
  s_waitcnt lgkmcnt(6)
  v_mfma_f32_16x16x32_bf16 v[96:99], v[172:175], v[164:167], v[96:99]
  v_mfma_f32_16x16x32_bf16 v[116:119], v[172:175], v[168:171], v[116:119]
  v_add_u32 v72, s71, v72
  v_add_u32 v73, s71, v73
  v_mfma_f32_16x16x32_bf16 v[100:103], v[176:179], v[164:167], v[100:103]
  s_waitcnt lgkmcnt(0)
  v_mfma_f32_16x16x32_bf16 v[120:123], v[176:179], v[168:171], v[120:123]
  s_waitcnt vmcnt(0)
  s_barrier
  v_mfma_f32_16x16x32_bf16 v[104:107], v[180:183], v[164:167], v[104:107]
  ds_read_b128 v[136:139], v72
  ds_read_b128 v[140:143], v79 offset:40960
  v_mfma_f32_16x16x32_bf16 v[124:127], v[180:183], v[168:171], v[124:127]
  ds_read_b64_tr_b16 v[144:145], v83 offset:40960
  ds_read_b64_tr_b16 v[146:147], v83 offset:42240
  v_mfma_f32_16x16x32_bf16 v[108:111], v[184:187], v[164:167], v[108:111]
  ds_read_b64_tr_b16 v[148:149], v83 offset:40992
  ds_read_b64_tr_b16 v[150:151], v83 offset:42272
  v_mfma_f32_16x16x32_bf16 v[128:131], v[184:187], v[168:171], v[128:131]
  ds_read_b64_tr_b16 v[152:153], v83 offset:41024
  ds_read_b64_tr_b16 v[154:155], v83 offset:42304
  v_mfma_f32_16x16x32_bf16 v[112:115], v[188:191], v[164:167], v[112:115]
  ds_read_b64_tr_b16 v[156:157], v83 offset:41056
  ds_read_b64_tr_b16 v[158:159], v83 offset:42336
  v_mfma_f32_16x16x32_bf16 v[132:135], v[188:191], v[168:171], v[132:135]
  ds_read_b64_tr_b16 v[160:161], v83 offset:41088
  ds_read_b64_tr_b16 v[162:163], v83 offset:42368
  s_waitcnt lgkmcnt(6)
  v_mfma_f32_16x16x32_bf16 v[96:99], v[144:147], v[136:139], v[96:99]
  ds_read_b128 v[164:167], v73
  ds_read_b128 v[168:171], v80 offset:40960
  v_mfma_f32_16x16x32_bf16 v[116:119], v[144:147], v[140:143], v[116:119]
  ds_read_b64_tr_b16 v[172:173], v83 offset:46080
  ds_read_b64_tr_b16 v[174:175], v83 offset:47360
  v_mfma_f32_16x16x32_bf16 v[100:103], v[148:151], v[136:139], v[100:103]
  ds_read_b64_tr_b16 v[176:177], v83 offset:46112
  ds_read_b64_tr_b16 v[178:179], v83 offset:47392
  v_mfma_f32_16x16x32_bf16 v[120:123], v[148:151], v[140:143], v[120:123]
  ds_read_b64_tr_b16 v[180:181], v83 offset:46144
  ds_read_b64_tr_b16 v[182:183], v83 offset:47424
  s_waitcnt lgkmcnt(10)
  v_mfma_f32_16x16x32_bf16 v[104:107], v[152:155], v[136:139], v[104:107]
  ds_read_b64_tr_b16 v[184:185], v83 offset:46176
  ds_read_b64_tr_b16 v[186:187], v83 offset:47456
  v_mfma_f32_16x16x32_bf16 v[124:127], v[152:155], v[140:143], v[124:127]
  ds_read_b64_tr_b16 v[188:189], v83 offset:46208
  ds_read_b64_tr_b16 v[190:191], v83 offset:47488
  v_mfma_f32_16x16x32_bf16 v[108:111], v[156:159], v[136:139], v[108:111]
  v_mfma_f32_16x16x32_bf16 v[128:131], v[156:159], v[140:143], v[128:131]
  s_waitcnt lgkmcnt(12)
  v_mfma_f32_16x16x32_bf16 v[112:115], v[160:163], v[136:139], v[112:115]
  v_mfma_f32_16x16x32_bf16 v[132:135], v[160:163], v[140:143], v[132:135]
  s_waitcnt lgkmcnt(6)
  v_mfma_f32_16x16x32_bf16 v[96:99], v[172:175], v[164:167], v[96:99]
  v_mfma_f32_16x16x32_bf16 v[116:119], v[172:175], v[168:171], v[116:119]
  v_add_u32 v72, s71, v72
  v_add_u32 v73, s71, v73
  v_mfma_f32_16x16x32_bf16 v[100:103], v[176:179], v[164:167], v[100:103]
  s_waitcnt lgkmcnt(0)
  v_mfma_f32_16x16x32_bf16 v[120:123], v[176:179], v[168:171], v[120:123]
  s_barrier
  v_mfma_f32_16x16x32_bf16 v[104:107], v[180:183], v[164:167], v[104:107]
  ds_read_b128 v[136:139], v72
  ds_read_b128 v[140:143], v81 offset:0
  v_mfma_f32_16x16x32_bf16 v[124:127], v[180:183], v[168:171], v[124:127]
  ds_read_b64_tr_b16 v[144:145], v84 offset:0
  ds_read_b64_tr_b16 v[146:147], v84 offset:1280
  v_mfma_f32_16x16x32_bf16 v[108:111], v[184:187], v[164:167], v[108:111]
  ds_read_b64_tr_b16 v[148:149], v84 offset:32
  ds_read_b64_tr_b16 v[150:151], v84 offset:1312
  v_mfma_f32_16x16x32_bf16 v[128:131], v[184:187], v[168:171], v[128:131]
  ds_read_b64_tr_b16 v[152:153], v84 offset:64
  ds_read_b64_tr_b16 v[154:155], v84 offset:1344
  v_mfma_f32_16x16x32_bf16 v[112:115], v[188:191], v[164:167], v[112:115]
  ds_read_b64_tr_b16 v[156:157], v84 offset:96
  ds_read_b64_tr_b16 v[158:159], v84 offset:1376
  v_mfma_f32_16x16x32_bf16 v[132:135], v[188:191], v[168:171], v[132:135]
  ds_read_b64_tr_b16 v[160:161], v84 offset:128
  ds_read_b64_tr_b16 v[162:163], v84 offset:1408
  s_waitcnt lgkmcnt(6)
  v_mfma_f32_16x16x32_bf16 v[96:99], v[144:147], v[136:139], v[96:99]
  ds_read_b128 v[164:167], v73
  ds_read_b128 v[168:171], v82 offset:0
  v_mfma_f32_16x16x32_bf16 v[116:119], v[144:147], v[140:143], v[116:119]
  ds_read_b64_tr_b16 v[172:173], v84 offset:5120
  ds_read_b64_tr_b16 v[174:175], v84 offset:6400
  v_mfma_f32_16x16x32_bf16 v[100:103], v[148:151], v[136:139], v[100:103]
L_pad1:
  s_cbranch_execz L_pad3
  ds_read_b64_tr_b16 v[176:177], v84 offset:5152
  ds_read_b64_tr_b16 v[178:179], v84 offset:6432
  v_mfma_f32_16x16x32_bf16 v[120:123], v[148:151], v[140:143], v[120:123]
  ds_read_b64_tr_b16 v[180:181], v84 offset:5184
  ds_read_b64_tr_b16 v[182:183], v84 offset:6464
  s_waitcnt lgkmcnt(10)
  v_mfma_f32_16x16x32_bf16 v[104:107], v[152:155], v[136:139], v[104:107]
  ds_read_b64_tr_b16 v[184:185], v84 offset:5216
  ds_read_b64_tr_b16 v[186:187], v84 offset:6496
  v_mfma_f32_16x16x32_bf16 v[124:127], v[152:155], v[140:143], v[124:127]
  ds_read_b64_tr_b16 v[188:189], v84 offset:5248
  ds_read_b64_tr_b16 v[190:191], v84 offset:6528
  v_mfma_f32_16x16x32_bf16 v[108:111], v[156:159], v[136:139], v[108:111]
  v_mfma_f32_16x16x32_bf16 v[128:131], v[156:159], v[140:143], v[128:131]
  s_waitcnt lgkmcnt(12)
  v_mfma_f32_16x16x32_bf16 v[112:115], v[160:163], v[136:139], v[112:115]
  v_mfma_f32_16x16x32_bf16 v[132:135], v[160:163], v[140:143], v[132:135]
  s_waitcnt lgkmcnt(6)
  v_mfma_f32_16x16x32_bf16 v[96:99], v[172:175], v[164:167], v[96:99]
  v_mfma_f32_16x16x32_bf16 v[116:119], v[172:175], v[168:171], v[116:119]
  v_add_u32 v72, s71, v72
  v_add_u32 v73, s71, v73
  v_mfma_f32_16x16x32_bf16 v[100:103], v[176:179], v[164:167], v[100:103]
  s_waitcnt lgkmcnt(0)
  v_mfma_f32_16x16x32_bf16 v[120:123], v[176:179], v[168:171], v[120:123]
  s_barrier
  v_mfma_f32_16x16x32_bf16 v[104:107], v[180:183], v[164:167], v[104:107]
  ds_read_b128 v[136:139], v72
  ds_read_b128 v[140:143], v81 offset:20480
  v_mfma_f32_16x16x32_bf16 v[124:127], v[180:183], v[168:171], v[124:127]
  ds_read_b64_tr_b16 v[144:145], v84 offset:20480
  ds_read_b64_tr_b16 v[146:147], v84 offset:21760
  v_mfma_f32_16x16x32_bf16 v[108:111], v[184:187], v[164:167], v[108:111]
  ds_read_b64_tr_b16 v[148:149], v84 offset:20512
  ds_read_b64_tr_b16 v[150:151], v84 offset:21792
  v_mfma_f32_16x16x32_bf16 v[128:131], v[184:187], v[168:171], v[128:131]
  ds_read_b64_tr_b16 v[152:153], v84 offset:20544
  ds_read_b64_tr_b16 v[154:155], v84 offset:21824
  v_mfma_f32_16x16x32_bf16 v[112:115], v[188:191], v[164:167], v[112:115]
  ds_read_b64_tr_b16 v[156:157], v84 offset:20576
  ds_read_b64_tr_b16 v[158:159], v84 offset:21856
  v_mfma_f32_16x16x32_bf16 v[132:135], v[188:191], v[168:171], v[132:135]
  ds_read_b64_tr_b16 v[160:161], v84 offset:20608
  ds_read_b64_tr_b16 v[162:163], v84 offset:21888
  s_waitcnt lgkmcnt(6)
  v_mfma_f32_16x16x32_bf16 v[96:99], v[144:147], v[136:139], v[96:99]
  ds_read_b128 v[164:167], v73
  ds_read_b128 v[168:171], v82 offset:20480
  v_mfma_f32_16x16x32_bf16 v[116:119], v[144:147], v[140:143], v[116:119]
  ds_read_b64_tr_b16 v[172:173], v84 offset:25600
  ds_read_b64_tr_b16 v[174:175], v84 offset:26880
  v_mfma_f32_16x16x32_bf16 v[100:103], v[148:151], v[136:139], v[100:103]
  ds_read_b64_tr_b16 v[176:177], v84 offset:25632
  ds_read_b64_tr_b16 v[178:179], v84 offset:26912
  v_mfma_f32_16x16x32_bf16 v[120:123], v[148:151], v[140:143], v[120:123]
  ds_read_b64_tr_b16 v[180:181], v84 offset:25664
  ds_read_b64_tr_b16 v[182:183], v84 offset:26944
  s_waitcnt lgkmcnt(10)
  v_mfma_f32_16x16x32_bf16 v[104:107], v[152:155], v[136:139], v[104:107]
  ds_read_b64_tr_b16 v[184:185], v84 offset:25696
  ds_read_b64_tr_b16 v[186:187], v84 offset:26976
  v_mfma_f32_16x16x32_bf16 v[124:127], v[152:155], v[140:143], v[124:127]
  ds_read_b64_tr_b16 v[188:189], v84 offset:25728
  ds_read_b64_tr_b16 v[190:191], v84 offset:27008
  v_mfma_f32_16x16x32_bf16 v[108:111], v[156:159], v[136:139], v[108:111]
  v_mfma_f32_16x16x32_bf16 v[128:131], v[156:159], v[140:143], v[128:131]
  s_waitcnt lgkmcnt(12)
  v_mfma_f32_16x16x32_bf16 v[112:115], v[160:163], v[136:139], v[112:115]
  v_mfma_f32_16x16x32_bf16 v[132:135], v[160:163], v[140:143], v[132:135]
  s_waitcnt lgkmcnt(6)
  v_mfma_f32_16x16x32_bf16 v[96:99], v[172:175], v[164:167], v[96:99]
  v_mfma_f32_16x16x32_bf16 v[116:119], v[172:175], v[168:171], v[116:119]
  v_add_u32 v72, s72, v72
  v_add_u32 v73, s72, v73
  v_mfma_f32_16x16x32_bf16 v[100:103], v[176:179], v[164:167], v[100:103]
  s_waitcnt lgkmcnt(0)
  v_mfma_f32_16x16x32_bf16 v[120:123], v[176:179], v[168:171], v[120:123]
  s_barrier
  v_mfma_f32_16x16x32_bf16 v[104:107], v[180:183], v[164:167], v[104:107]
  ds_read_b128 v[136:139], v72
  ds_read_b128 v[140:143], v79 offset:0
  v_mfma_f32_16x16x32_bf16 v[124:127], v[180:183], v[168:171], v[124:127]
  ds_read_b64_tr_b16 v[144:145], v83 offset:0
  ds_read_b64_tr_b16 v[146:147], v83 offset:1280
  v_mfma_f32_16x16x32_bf16 v[108:111], v[184:187], v[164:167], v[108:111]
  ds_read_b64_tr_b16 v[148:149], v83 offset:32
  ds_read_b64_tr_b16 v[150:151], v83 offset:1312
  v_mfma_f32_16x16x32_bf16 v[128:131], v[184:187], v[168:171], v[128:131]
  ds_read_b64_tr_b16 v[152:153], v83 offset:64
  ds_read_b64_tr_b16 v[154:155], v83 offset:1344
  v_mfma_f32_16x16x32_bf16 v[112:115], v[188:191], v[164:167], v[112:115]
  ds_read_b64_tr_b16 v[156:157], v83 offset:96
  ds_read_b64_tr_b16 v[158:159], v83 offset:1376
  v_mfma_f32_16x16x32_bf16 v[132:135], v[188:191], v[168:171], v[132:135]
  ds_read_b64_tr_b16 v[160:161], v83 offset:128
  ds_read_b64_tr_b16 v[162:163], v83 offset:1408
  s_waitcnt lgkmcnt(6)
  v_mfma_f32_16x16x32_bf16 v[96:99], v[144:147], v[136:139], v[96:99]
  ds_read_b128 v[164:167], v73
  ds_read_b128 v[168:171], v80 offset:0
  v_mfma_f32_16x16x32_bf16 v[116:119], v[144:147], v[140:143], v[116:119]
  ds_read_b64_tr_b16 v[172:173], v83 offset:5120
  ds_read_b64_tr_b16 v[174:175], v83 offset:6400
  v_mfma_f32_16x16x32_bf16 v[100:103], v[148:151], v[136:139], v[100:103]
  ds_read_b64_tr_b16 v[176:177], v83 offset:5152
  ds_read_b64_tr_b16 v[178:179], v83 offset:6432
  v_mfma_f32_16x16x32_bf16 v[120:123], v[148:151], v[140:143], v[120:123]
  ds_read_b64_tr_b16 v[180:181], v83 offset:5184
  ds_read_b64_tr_b16 v[182:183], v83 offset:6464
  s_waitcnt lgkmcnt(10)
  v_mfma_f32_16x16x32_bf16 v[104:107], v[152:155], v[136:139], v[104:107]
  ds_read_b64_tr_b16 v[184:185], v83 offset:5216
  ds_read_b64_tr_b16 v[186:187], v83 offset:6496
  v_mfma_f32_16x16x32_bf16 v[124:127], v[152:155], v[140:143], v[124:127]
  ds_read_b64_tr_b16 v[188:189], v83 offset:5248
  ds_read_b64_tr_b16 v[190:191], v83 offset:6528
  v_mfma_f32_16x16x32_bf16 v[108:111], v[156:159], v[136:139], v[108:111]
  v_mfma_f32_16x16x32_bf16 v[128:131], v[156:159], v[140:143], v[128:131]
  s_waitcnt lgkmcnt(12)
  v_mfma_f32_16x16x32_bf16 v[112:115], v[160:163], v[136:139], v[112:115]
  v_mfma_f32_16x16x32_bf16 v[132:135], v[160:163], v[140:143], v[132:135]
  s_waitcnt lgkmcnt(6)
  v_mfma_f32_16x16x32_bf16 v[96:99], v[172:175], v[164:167], v[96:99]
  v_mfma_f32_16x16x32_bf16 v[116:119], v[172:175], v[168:171], v[116:119]
  v_add_u32 v72, s71, v72
  v_add_u32 v73, s71, v73
  v_mfma_f32_16x16x32_bf16 v[100:103], v[176:179], v[164:167], v[100:103]
  s_waitcnt lgkmcnt(0)
  v_mfma_f32_16x16x32_bf16 v[120:123], v[176:179], v[168:171], v[120:123]
  s_barrier
  v_mfma_f32_16x16x32_bf16 v[104:107], v[180:183], v[164:167], v[104:107]
  ds_read_b128 v[136:139], v72
  ds_read_b128 v[140:143], v79 offset:20480
  v_mfma_f32_16x16x32_bf16 v[124:127], v[180:183], v[168:171], v[124:127]
  ds_read_b64_tr_b16 v[144:145], v83 offset:20480
  ds_read_b64_tr_b16 v[146:147], v83 offset:21760
  v_mfma_f32_16x16x32_bf16 v[108:111], v[184:187], v[164:167], v[108:111]
  ds_read_b64_tr_b16 v[148:149], v83 offset:20512
  ds_read_b64_tr_b16 v[150:151], v83 offset:21792
  v_mfma_f32_16x16x32_bf16 v[128:131], v[184:187], v[168:171], v[128:131]
  ds_read_b64_tr_b16 v[152:153], v83 offset:20544
  ds_read_b64_tr_b16 v[154:155], v83 offset:21824
  v_mfma_f32_16x16x32_bf16 v[112:115], v[188:191], v[164:167], v[112:115]
  ds_read_b64_tr_b16 v[156:157], v83 offset:20576
  ds_read_b64_tr_b16 v[158:159], v83 offset:21856
  v_mfma_f32_16x16x32_bf16 v[132:135], v[188:191], v[168:171], v[132:135]
  ds_read_b64_tr_b16 v[160:161], v83 offset:20608
  ds_read_b64_tr_b16 v[162:163], v83 offset:21888
  s_waitcnt lgkmcnt(6)
  v_mfma_f32_16x16x32_bf16 v[96:99], v[144:147], v[136:139], v[96:99]
  ds_read_b128 v[164:167], v73
  ds_read_b128 v[168:171], v80 offset:20480
  v_mfma_f32_16x16x32_bf16 v[116:119], v[144:147], v[140:143], v[116:119]
  ds_read_b64_tr_b16 v[172:173], v83 offset:25600
  ds_read_b64_tr_b16 v[174:175], v83 offset:26880
  v_mfma_f32_16x16x32_bf16 v[100:103], v[148:151], v[136:139], v[100:103]
  ds_read_b64_tr_b16 v[176:177], v83 offset:25632
  ds_read_b64_tr_b16 v[178:179], v83 offset:26912
  v_mfma_f32_16x16x32_bf16 v[120:123], v[148:151], v[140:143], v[120:123]
  ds_read_b64_tr_b16 v[180:181], v83 offset:25664
  ds_read_b64_tr_b16 v[182:183], v83 offset:26944
  s_waitcnt lgkmcnt(10)
  v_mfma_f32_16x16x32_bf16 v[104:107], v[152:155], v[136:139], v[104:107]
  ds_read_b64_tr_b16 v[184:185], v83 offset:25696
  ds_read_b64_tr_b16 v[186:187], v83 offset:26976
  v_mfma_f32_16x16x32_bf16 v[124:127], v[152:155], v[140:143], v[124:127]
  ds_read_b64_tr_b16 v[188:189], v83 offset:25728
  ds_read_b64_tr_b16 v[190:191], v83 offset:27008
  v_mfma_f32_16x16x32_bf16 v[108:111], v[156:159], v[136:139], v[108:111]
  v_mfma_f32_16x16x32_bf16 v[128:131], v[156:159], v[140:143], v[128:131]
  s_waitcnt lgkmcnt(12)
  v_mfma_f32_16x16x32_bf16 v[112:115], v[160:163], v[136:139], v[112:115]
  v_mfma_f32_16x16x32_bf16 v[132:135], v[160:163], v[140:143], v[132:135]
  s_waitcnt lgkmcnt(6)
  v_mfma_f32_16x16x32_bf16 v[96:99], v[172:175], v[164:167], v[96:99]
  v_mfma_f32_16x16x32_bf16 v[116:119], v[172:175], v[168:171], v[116:119]
  v_add_u32 v72, s71, v72
  v_add_u32 v73, s71, v73
  v_mfma_f32_16x16x32_bf16 v[100:103], v[176:179], v[164:167], v[100:103]
  s_waitcnt lgkmcnt(0)
  v_mfma_f32_16x16x32_bf16 v[120:123], v[176:179], v[168:171], v[120:123]
  s_barrier
  v_mfma_f32_16x16x32_bf16 v[104:107], v[180:183], v[164:167], v[104:107]
  ds_read_b128 v[136:139], v72
  ds_read_b128 v[140:143], v79 offset:40960
  v_mfma_f32_16x16x32_bf16 v[124:127], v[180:183], v[168:171], v[124:127]
  ds_read_b64_tr_b16 v[144:145], v83 offset:40960
  ds_read_b64_tr_b16 v[146:147], v83 offset:42240
  v_mfma_f32_16x16x32_bf16 v[108:111], v[184:187], v[164:167], v[108:111]
  ds_read_b64_tr_b16 v[148:149], v83 offset:40992
  ds_read_b64_tr_b16 v[150:151], v83 offset:42272
  v_mfma_f32_16x16x32_bf16 v[128:131], v[184:187], v[168:171], v[128:131]
  ds_read_b64_tr_b16 v[152:153], v83 offset:41024
  ds_read_b64_tr_b16 v[154:155], v83 offset:42304
  v_mfma_f32_16x16x32_bf16 v[112:115], v[188:191], v[164:167], v[112:115]
  ds_read_b64_tr_b16 v[156:157], v83 offset:41056
  ds_read_b64_tr_b16 v[158:159], v83 offset:42336
  v_mfma_f32_16x16x32_bf16 v[132:135], v[188:191], v[168:171], v[132:135]
  ds_read_b64_tr_b16 v[160:161], v83 offset:41088
  ds_read_b64_tr_b16 v[162:163], v83 offset:42368
  s_waitcnt lgkmcnt(6)
  v_mfma_f32_16x16x32_bf16 v[96:99], v[144:147], v[136:139], v[96:99]
  ds_read_b128 v[164:167], v73
  ds_read_b128 v[168:171], v80 offset:40960
  v_mfma_f32_16x16x32_bf16 v[116:119], v[144:147], v[140:143], v[116:119]
  ds_read_b64_tr_b16 v[172:173], v83 offset:46080
  ds_read_b64_tr_b16 v[174:175], v83 offset:47360
  v_mfma_f32_16x16x32_bf16 v[100:103], v[148:151], v[136:139], v[100:103]
  ds_read_b64_tr_b16 v[176:177], v83 offset:46112
  ds_read_b64_tr_b16 v[178:179], v83 offset:47392
  v_mfma_f32_16x16x32_bf16 v[120:123], v[148:151], v[140:143], v[120:123]
  ds_read_b64_tr_b16 v[180:181], v83 offset:46144
  ds_read_b64_tr_b16 v[182:183], v83 offset:47424
  s_waitcnt lgkmcnt(10)
  v_mfma_f32_16x16x32_bf16 v[104:107], v[152:155], v[136:139], v[104:107]
  ds_read_b64_tr_b16 v[184:185], v83 offset:46176
  ds_read_b64_tr_b16 v[186:187], v83 offset:47456
  v_mfma_f32_16x16x32_bf16 v[124:127], v[152:155], v[140:143], v[124:127]
  ds_read_b64_tr_b16 v[188:189], v83 offset:46208
  ds_read_b64_tr_b16 v[190:191], v83 offset:47488
  v_mfma_f32_16x16x32_bf16 v[108:111], v[156:159], v[136:139], v[108:111]
  v_mfma_f32_16x16x32_bf16 v[128:131], v[156:159], v[140:143], v[128:131]
  s_waitcnt lgkmcnt(12)
  v_mfma_f32_16x16x32_bf16 v[112:115], v[160:163], v[136:139], v[112:115]
  v_mfma_f32_16x16x32_bf16 v[132:135], v[160:163], v[140:143], v[132:135]
  s_waitcnt lgkmcnt(6)
  v_mfma_f32_16x16x32_bf16 v[96:99], v[172:175], v[164:167], v[96:99]
  v_mfma_f32_16x16x32_bf16 v[116:119], v[172:175], v[168:171], v[116:119]
  v_add_u32 v72, s71, v72
  v_add_u32 v73, s71, v73
  v_mfma_f32_16x16x32_bf16 v[100:103], v[176:179], v[164:167], v[100:103]
  s_waitcnt lgkmcnt(0)
  v_mfma_f32_16x16x32_bf16 v[120:123], v[176:179], v[168:171], v[120:123]
  s_barrier
  v_mfma_f32_16x16x32_bf16 v[104:107], v[180:183], v[164:167], v[104:107]
  ds_read_b128 v[136:139], v72
  ds_read_b128 v[140:143], v81 offset:0
  v_mfma_f32_16x16x32_bf16 v[124:127], v[180:183], v[168:171], v[124:127]
  ds_read_b64_tr_b16 v[144:145], v84 offset:0
  ds_read_b64_tr_b16 v[146:147], v84 offset:1280
  v_mfma_f32_16x16x32_bf16 v[108:111], v[184:187], v[164:167], v[108:111]
  ds_read_b64_tr_b16 v[148:149], v84 offset:32
  ds_read_b64_tr_b16 v[150:151], v84 offset:1312
  v_mfma_f32_16x16x32_bf16 v[128:131], v[184:187], v[168:171], v[128:131]
  ds_read_b64_tr_b16 v[152:153], v84 offset:64
  ds_read_b64_tr_b16 v[154:155], v84 offset:1344
  v_mfma_f32_16x16x32_bf16 v[112:115], v[188:191], v[164:167], v[112:115]
  ds_read_b64_tr_b16 v[156:157], v84 offset:96
  ds_read_b64_tr_b16 v[158:159], v84 offset:1376
  v_mfma_f32_16x16x32_bf16 v[132:135], v[188:191], v[168:171], v[132:135]
  ds_read_b64_tr_b16 v[160:161], v84 offset:128
  ds_read_b64_tr_b16 v[162:163], v84 offset:1408
  s_waitcnt lgkmcnt(6)
  v_mfma_f32_16x16x32_bf16 v[96:99], v[144:147], v[136:139], v[96:99]
  ds_read_b128 v[164:167], v73
  ds_read_b128 v[168:171], v82 offset:0
  v_mfma_f32_16x16x32_bf16 v[116:119], v[144:147], v[140:143], v[116:119]
  ds_read_b64_tr_b16 v[172:173], v84 offset:5120
  ds_read_b64_tr_b16 v[174:175], v84 offset:6400
  v_mfma_f32_16x16x32_bf16 v[100:103], v[148:151], v[136:139], v[100:103]
  ds_read_b64_tr_b16 v[176:177], v84 offset:5152
  ds_read_b64_tr_b16 v[178:179], v84 offset:6432
  v_mfma_f32_16x16x32_bf16 v[120:123], v[148:151], v[140:143], v[120:123]
  ds_read_b64_tr_b16 v[180:181], v84 offset:5184
  ds_read_b64_tr_b16 v[182:183], v84 offset:6464
  s_waitcnt lgkmcnt(10)
  v_mfma_f32_16x16x32_bf16 v[104:107], v[152:155], v[136:139], v[104:107]
  ds_read_b64_tr_b16 v[184:185], v84 offset:5216
  ds_read_b64_tr_b16 v[186:187], v84 offset:6496
  v_mfma_f32_16x16x32_bf16 v[124:127], v[152:155], v[140:143], v[124:127]
  ds_read_b64_tr_b16 v[188:189], v84 offset:5248
  ds_read_b64_tr_b16 v[190:191], v84 offset:6528
  v_mfma_f32_16x16x32_bf16 v[108:111], v[156:159], v[136:139], v[108:111]
  v_mfma_f32_16x16x32_bf16 v[128:131], v[156:159], v[140:143], v[128:131]
  s_waitcnt lgkmcnt(12)
  v_mfma_f32_16x16x32_bf16 v[112:115], v[160:163], v[136:139], v[112:115]
  v_mfma_f32_16x16x32_bf16 v[132:135], v[160:163], v[140:143], v[132:135]
  s_waitcnt lgkmcnt(6)
  v_mfma_f32_16x16x32_bf16 v[96:99], v[172:175], v[164:167], v[96:99]
  v_mfma_f32_16x16x32_bf16 v[116:119], v[172:175], v[168:171], v[116:119]
  v_add_u32 v72, s71, v72
  v_add_u32 v73, s71, v73
  v_mfma_f32_16x16x32_bf16 v[100:103], v[176:179], v[164:167], v[100:103]
  s_waitcnt lgkmcnt(0)
  v_mfma_f32_16x16x32_bf16 v[120:123], v[176:179], v[168:171], v[120:123]
  s_barrier
  ds_read_b128 v[136:139], v72
  ds_read_b128 v[140:143], v81 offset:20480
  v_mfma_f32_16x16x32_bf16 v[104:107], v[180:183], v[164:167], v[104:107]
  ds_read_b64_tr_b16 v[144:145], v84 offset:20480
  ds_read_b64_tr_b16 v[146:147], v84 offset:21760
  v_mfma_f32_16x16x32_bf16 v[124:127], v[180:183], v[168:171], v[124:127]
  ds_read_b128 v[192:195], v73
  ds_read_b128 v[196:199], v82 offset:20480
  v_mfma_f32_16x16x32_bf16 v[108:111], v[184:187], v[164:167], v[108:111]
  ds_read_b64_tr_b16 v[200:201], v84 offset:25600
  ds_read_b64_tr_b16 v[202:203], v84 offset:26880
  v_mfma_f32_16x16x32_bf16 v[128:131], v[184:187], v[168:171], v[128:131]
  ds_read_b64_tr_b16 v[148:149], v84 offset:20512
  ds_read_b64_tr_b16 v[150:151], v84 offset:21792
  v_mfma_f32_16x16x32_bf16 v[112:115], v[188:191], v[164:167], v[112:115]
  ds_read_b64_tr_b16 v[204:205], v84 offset:25632
  ds_read_b64_tr_b16 v[206:207], v84 offset:26912
  v_mfma_f32_16x16x32_bf16 v[132:135], v[188:191], v[168:171], v[132:135]
  s_waitcnt lgkmcnt(4)
  v_mfma_f32_16x16x32_bf16 v[96:99], v[144:147], v[136:139], v[96:99]
  ds_read_b64_tr_b16 v[152:153], v84 offset:20544
  ds_read_b64_tr_b16 v[154:155], v84 offset:21824
  v_mfma_f32_16x16x32_bf16 v[116:119], v[144:147], v[140:143], v[116:119]
  ds_read_b64_tr_b16 v[208:209], v84 offset:25664
  ds_read_b64_tr_b16 v[210:211], v84 offset:26944
  v_mfma_f32_16x16x32_bf16 v[96:99], v[200:203], v[192:195], v[96:99]
  ds_read_b64_tr_b16 v[156:157], v84 offset:20576
  ds_read_b64_tr_b16 v[158:159], v84 offset:21856
  v_mfma_f32_16x16x32_bf16 v[116:119], v[200:203], v[196:199], v[116:119]
  ds_read_b64_tr_b16 v[212:213], v84 offset:25696
  ds_read_b64_tr_b16 v[214:215], v84 offset:26976
  s_waitcnt lgkmcnt(8)
  v_mfma_f32_16x16x32_bf16 v[100:103], v[148:151], v[136:139], v[100:103]
  ds_read_b64_tr_b16 v[160:161], v84 offset:20608
  ds_read_b64_tr_b16 v[162:163], v84 offset:21888
  v_mfma_f32_16x16x32_bf16 v[120:123], v[148:151], v[140:143], v[120:123]
  ds_read_b64_tr_b16 v[216:217], v84 offset:25728
  ds_read_b64_tr_b16 v[218:219], v84 offset:27008
  v_mfma_f32_16x16x32_bf16 v[100:103], v[204:207], v[192:195], v[100:103]
  v_mfma_f32_16x16x32_bf16 v[120:123], v[204:207], v[196:199], v[120:123]
  s_waitcnt lgkmcnt(0)
  v_mfma_f32_16x16x32_bf16 v[104:107], v[152:155], v[136:139], v[104:107]
  v_cvt_pk_bf16_f32 v220, v96, v97
  v_cvt_pk_bf16_f32 v221, v98, v99
  v_mfma_f32_16x16x32_bf16 v[124:127], v[152:155], v[140:143], v[124:127]
  ds_write_b64 v85, v[220:221]
  v_cvt_pk_bf16_f32 v222, v116, v117
  v_mfma_f32_16x16x32_bf16 v[104:107], v[208:211], v[192:195], v[104:107]
  v_cvt_pk_bf16_f32 v223, v118, v119
  ds_write_b64 v86, v[222:223]
  v_mfma_f32_16x16x32_bf16 v[124:127], v[208:211], v[196:199], v[124:127]
  v_mfma_f32_16x16x32_bf16 v[108:111], v[156:159], v[136:139], v[108:111]
  v_cvt_pk_bf16_f32 v224, v100, v101
  v_cvt_pk_bf16_f32 v225, v102, v103
  v_mfma_f32_16x16x32_bf16 v[128:131], v[156:159], v[140:143], v[128:131]
  ds_write_b64 v87, v[224:225]
  v_cvt_pk_bf16_f32 v226, v120, v121
  v_mfma_f32_16x16x32_bf16 v[108:111], v[212:215], v[192:195], v[108:111]
  v_cvt_pk_bf16_f32 v227, v122, v123
  ds_write_b64 v88, v[226:227]
  v_mfma_f32_16x16x32_bf16 v[128:131], v[212:215], v[196:199], v[128:131]
  v_mfma_f32_16x16x32_bf16 v[112:115], v[160:163], v[136:139], v[112:115]
  v_cvt_pk_bf16_f32 v228, v104, v105
  v_cvt_pk_bf16_f32 v229, v106, v107
  v_mfma_f32_16x16x32_bf16 v[132:135], v[160:163], v[140:143], v[132:135]
  ds_write_b64 v89, v[228:229]
  v_cvt_pk_bf16_f32 v230, v124, v125
  v_mfma_f32_16x16x32_bf16 v[112:115], v[216:219], v[192:195], v[112:115]
  v_cvt_pk_bf16_f32 v231, v126, v127
  ds_write_b64 v90, v[230:231]
  v_mfma_f32_16x16x32_bf16 v[132:135], v[216:219], v[196:199], v[132:135]
  v_cvt_pk_bf16_f32 v232, v108, v109
  v_cvt_pk_bf16_f32 v233, v110, v111
  ds_write_b64 v91, v[232:233]
  v_cvt_pk_bf16_f32 v234, v128, v129
  v_cvt_pk_bf16_f32 v235, v130, v131
  ds_write_b64 v92, v[234:235]
  s_nop 0
  v_cvt_pk_bf16_f32 v236, v112, v113
  v_cvt_pk_bf16_f32 v237, v114, v115
  ds_write_b64 v93, v[236:237]
  v_cvt_pk_bf16_f32 v238, v132, v133
  v_cvt_pk_bf16_f32 v239, v134, v135
  ds_write_b64 v94, v[238:239]
  s_branch L_attn2
L_notq:
  s_cmp_ge_u32 s3, 4
  s_cbranch_scc0 L_h2
  s_cmp_ge_u32 s3, 6
  s_cbranch_scc1 L_h1
  v_lshrrev_b32 v2, 3, v1
  v_and_b32 v3, 7, v1
  v_lshrrev_b32 v4, 4, v1
  v_xor_b32 v3, v3, v4
  v_lshlrev_b32 v3, 4, v3
  v_xor_b32 v4, 64, v3
  s_movk_i32 s51, 1280
  s_mov_b32 s52, 81920
  v_mad_u32_u24 v72, v2, s51, v3
  v_mad_u32_u24 v73, v2, s51, v4
  v_mad_u32_u24 v74, v2, s52, v3
  v_mad_u32_u24 v75, v2, s52, v4
  s_sub_u32 s73, s3, 4
  s_movk_i32 s50, 6554
  s_movk_i32 s51, 1280
  v_add_u32 v2, 0, v1
  v_mul_u32_u24 v3, s50, v2
  v_lshrrev_b32 v3, 16, v3
  v_mul_u32_u24 v4, 10, v3
  v_sub_u32 v2, v2, v4
  v_and_b32 v4, 0x13, v3
  v_bfe_u32 v5, v3, 2, 1
  v_lshl_add_u32 v4, v5, 3, v4
  v_bfe_u32 v5, v3, 3, 1
  v_lshl_add_u32 v4, v5, 2, v4
  v_lshlrev_b32 v2, 4, v2
  v_mad_u32_u24 v76, v4, s51, v2
  v_add_u32 v2, 64, v1
  v_mul_u32_u24 v3, s50, v2
  v_lshrrev_b32 v3, 16, v3
  v_mul_u32_u24 v4, 10, v3
  v_sub_u32 v2, v2, v4
  v_and_b32 v4, 0x13, v3
  v_bfe_u32 v5, v3, 2, 1
  v_lshl_add_u32 v4, v5, 3, v4
  v_bfe_u32 v5, v3, 3, 1
  v_lshl_add_u32 v4, v5, 2, v4
  v_lshlrev_b32 v2, 4, v2
  v_mad_u32_u24 v77, v4, s51, v2
  v_subrev_u32 v77, 1024, v77
  v_add_u32 v2, 128, v1
  v_mul_u32_u24 v3, s50, v2
  v_lshrrev_b32 v3, 16, v3
  v_mul_u32_u24 v4, 10, v3
  v_sub_u32 v2, v2, v4
  v_and_b32 v4, 0x13, v3
  v_bfe_u32 v5, v3, 2, 1
  v_lshl_add_u32 v4, v5, 3, v4
  v_bfe_u32 v5, v3, 3, 1
  v_lshl_add_u32 v4, v5, 2, v4
  v_lshlrev_b32 v2, 4, v2
  v_mad_u32_u24 v78, v4, s51, v2
  v_subrev_u32 v78, 2048, v78
  v_add_u32 v2, 192, v1
  v_mul_u32_u24 v3, s50, v2
  v_lshrrev_b32 v3, 16, v3
  v_mul_u32_u24 v4, 10, v3
  v_sub_u32 v2, v2, v4
  v_and_b32 v4, 0x13, v3
  v_bfe_u32 v5, v3, 2, 1
  v_lshl_add_u32 v4, v5, 3, v4
  v_bfe_u32 v5, v3, 3, 1
  v_lshl_add_u32 v4, v5, 2, v4
  v_lshlrev_b32 v2, 4, v2
  v_mad_u32_u24 v79, v4, s51, v2
  v_subrev_u32 v79, 3072, v79
  v_add_u32 v2, 256, v1
  v_mul_u32_u24 v3, s50, v2
  v_lshrrev_b32 v3, 16, v3
  v_mul_u32_u24 v4, 10, v3
  v_sub_u32 v2, v2, v4
  v_and_b32 v4, 0x13, v3
  v_bfe_u32 v5, v3, 2, 1
  v_lshl_add_u32 v4, v5, 3, v4
  v_bfe_u32 v5, v3, 3, 1
  v_lshl_add_u32 v4, v5, 2, v4
  v_lshlrev_b32 v2, 4, v2
  v_mad_u32_u24 v80, v4, s51, v2
  v_add_u32 v85, 0, v74
  v_add_u32 v86, 654336, v75
  s_mul_i32 s49, s73, 3
  s_add_u32 s49, s49, 2
  s_and_b32 s50, s49, 1
  s_lshl_b32 s50, s50, 6
  v_xor_b32 v81, s50, v72
  s_and_b32 s50, s7, 6
  s_xor_b32 s49, s49, s50
  s_mulk_i32 s49, 10240
  v_add_u32 v81, s49, v81
  s_mul_i32 s49, s73, 3
  s_add_u32 s49, s49, 3
  s_and_b32 s50, s49, 1
  s_lshl_b32 s50, s50, 6
  v_xor_b32 v82, s50, v72
  s_and_b32 s50, s7, 6
  s_xor_b32 s49, s49, s50
  s_mulk_i32 s49, 10240
  v_add_u32 v82, s49, v82
  s_mul_i32 s49, s73, 3
  s_add_u32 s49, s49, 4
  s_and_b32 s50, s49, 1
  s_lshl_b32 s50, s50, 6
  v_xor_b32 v83, s50, v72
  s_and_b32 s50, s7, 6
  s_xor_b32 s49, s49, s50
  s_mulk_i32 s49, 10240
  v_add_u32 v83, s49, v83
  s_mul_i32 s52, s5, 3
  s_add_u32 s52, s52, s3
  s_sub_u32 s52, s52, 4
  s_cmp_ge_u32 s52, 88
  s_cbranch_scc1 L_s2z0
  s_mul_i32 s49, s52, 187
  s_lshr_b32 s49, s49, 11
  s_mul_i32 s50, s49, 11
  s_sub_u32 s61, s52, s50
  s_lshl3_add_u32 s60, s4, s49
  s_lshl_b32 s63, s60, 13
  s_add_u32 s63, s63, 0x80000
  s_lshr_b32 s49, s60, 1
  s_and_b32 s51, s60, 1
  s_lshl_b32 s51, s51, 10
  s_add_u32 s51, s51, s49
  s_mul_i32 s62, s49, 81920
  s_add_u32 s62, s62, 0x400000
  v_and_b32 v2, 31, v1
  v_and_b32 v3, 32, v1
  v_lshl_add_u32 v4, v2, 5, s51
  s_movk_i32 s50, 2560
  s_lshl_b32 s49, s61, 6
  v_add_u32 v16, s49, v3
  v_mad_u32_u24 v15, v4, s50, v16
  v_sub_u32 v4, 0, v4
  v_and_b32 v4, 0x7ff, v4
  v_sub_u32 v17, 1248, v16
  v_subrev_u32 v16, 1, v16
  v_cmp_gt_u32 vcc, 640, v16
  v_mad_u32_u24 v17, v4, s50, v17
  v_mul_u32_u24 v16, 160, v3
  v_cndmask_b32 v18, v18, v17, vcc
  s_cmp_eq_u32 s61, 10
  s_cbranch_scc0 L_s2n0
  v_mov_b32 v15, 2.0
  v_mov_b32 v17, 2.0
  s_add_u32 s62, s62, 8388608
  s_branch L_s2z0
L_s2n0:
  v_and_b32 v4, 3, v2
  v_lshl_add_u32 v16, v4, 2, v16
  v_lshrrev_b32 v4, 3, v2
  v_lshl_add_u32 v16, v4, 4, v16
  v_bfe_u32 v4, v2, 2, 1
  v_lshl_add_u32 v16, v4, 6, v16
  s_lshl1_add_u32 s62, s49, s62
L_s2z0:
  s_and_b32 s68, s7, 6
  s_add_u32 s68, s68, s73
  s_lshl3_add_u32 s68, s6, s68
  s_mul_i32 s68, s68, 10240
  s_lshl_b32 s69, s73, 6
  v_xor_b32 v2, s69, v72
  s_lshl_b32 s69, s73, 10
  s_mul_i32 s70, s73, 6144
  s_bitcmp0_b32 s7, 0
  s_cselect_b32 s28, s28, s32
  s_cselect_b32 s29, s29, s33
  s_add_u32 m0, s69, 32768
  s_add_u32 s49, s68, 0
  buffer_load_dwordx4 v2, s[20:23], s49 offen  lds
  s_add_u32 m0, s69, 34816
  s_add_u32 s49, s68, 128
  buffer_load_dwordx4 v2, s[20:23], s49 offen  lds
  s_add_u32 m0, s69, 36864
  s_add_u32 s49, s68, 256
  buffer_load_dwordx4 v2, s[20:23], s49 offen  lds
  s_add_u32 m0, s69, 38912
  s_add_u32 s49, s68, 384
  buffer_load_dwordx4 v2, s[20:23], s49 offen  lds
  s_add_u32 m0, s69, 40960
  s_add_u32 s49, s68, 512
  buffer_load_dwordx4 v2, s[20:23], s49 offen  lds
  s_add_u32 m0, s70, 0
  s_add_u32 s49, s70, 0
  buffer_load_dwordx4 v7, s[28:31], s49 offen offset:0 lds
  buffer_load_dwordx4 v7, s[28:31], s49 offen offset:1024 lds
  buffer_load_dwordx4 v7, s[28:31], s49 offen offset:2048 lds
  buffer_load_dwordx4 v7, s[28:31], s49 offen offset:3072 lds
  s_add_u32 m0, s70, 4096
  s_add_u32 s49, s70, 4096
  buffer_load_dwordx4 v7, s[28:31], s49 offen offset:0 lds
  buffer_load_dwordx4 v7, s[28:31], s49 offen offset:1024 lds
  buffer_load_dwordx4 v7, s[28:31], s49 offen offset:2048 lds
  s_add_u32 m0, s69, 43008
  s_add_u32 s49, s68, 640
  buffer_load_dwordx4 v2, s[20:23], s49 offen  lds
  s_add_u32 m0, s69, 45056
  s_add_u32 s49, s68, 768
  buffer_load_dwordx4 v2, s[20:23], s49 offen  lds
  s_add_u32 m0, s69, 47104
  s_add_u32 s49, s68, 896
  buffer_load_dwordx4 v2, s[20:23], s49 offen  lds
  s_add_u32 m0, s69, 49152
  s_add_u32 s49, s68, 1024
  buffer_load_dwordx4 v2, s[20:23], s49 offen  lds
  s_add_u32 m0, s69, 51200
  s_add_u32 s49, s68, 1152
  buffer_load_dwordx4 v2, s[20:23], s49 offen  lds
  s_add_u32 m0, s70, 13312
  s_add_u32 s49, s70, 13312
  buffer_load_dwordx4 v7, s[28:31], s49 offen offset:0 lds
  buffer_load_dwordx4 v7, s[28:31], s49 offen offset:1024 lds
  buffer_load_dwordx4 v7, s[28:31], s49 offen offset:2048 lds
  buffer_load_dwordx4 v7, s[28:31], s49 offen offset:3072 lds
  s_add_u32 m0, s70, 17408
  s_add_u32 s49, s70, 17408
  buffer_load_dwordx4 v7, s[28:31], s49 offen offset:0 lds
  buffer_load_dwordx4 v7, s[28:31], s49 offen offset:1024 lds
  s_lshr_b32 s49, s7, 2
  s_lshl1_add_u32 s49, s6, s49
  s_lshl_b32 s50, s73, 10
  s_add_u32 s49, s49, s50
  s_mul_i32 s68, s6, 81920
  s_mul_i32 s74, s73, 3072
  s_mul_i32 s69, s49, 1280
L_pad2:
  s_cbranch_execz L_pad4
  s_lshl_b32 s75, s73, 11
  s_mul_i32 s70, s73, 40960
  s_mul_i32 s49, s7, 160
  s_add_u32 s70, s70, s49
  s_lshl_b32 s71, s73, 12
  s_mul_i32 s72, s73, 5120
  s_add_u32 m0, s75, 151552
  s_add_u32 s49, s69, 640
  buffer_load_dwordx4 v85, s[8:11], s49 offen offset:0  lds
  buffer_load_dwordx4 v86, s[8:11], s49 offen offset:1024  lds
  s_add_u32 m0, s74, 53248
  s_add_u32 s49, s68, 0
  buffer_load_dwordx4 v81, s[20:23], s49 offen  lds
  s_add_u32 m0, s74, 54272
  s_add_u32 s49, s68, 0
  buffer_load_dwordx4 v82, s[20:23], s49 offen  lds
  s_add_u32 m0, s74, 55296
  s_add_u32 s49, s68, 0
  buffer_load_dwordx4 v83, s[20:23], s49 offen  lds
  s_add_u32 m0, s72, 63488
  s_add_u32 s49, s70, 0
  buffer_load_dwordx4 v80, s[24:27], s49 offen lds
  s_add_u32 m0, s72, 59392
  s_nop 0
  buffer_load_dwordx4 v76, s[24:27], s49 offen offset:0 lds
  buffer_load_dwordx4 v77, s[24:27], s49 offen offset:1024 lds
  buffer_load_dwordx4 v78, s[24:27], s49 offen offset:2048 lds
  buffer_load_dwordx4 v79, s[24:27], s49 offen offset:3072 lds
  s_add_u32 m0, s75, 69632
  s_add_u32 s49, s69, 768
  buffer_load_dwordx4 v85, s[8:11], s49 offen offset:0  lds
  buffer_load_dwordx4 v86, s[8:11], s49 offen offset:1024  lds
  s_waitcnt vmcnt(10)
  s_barrier
  s_add_u32 m0, s74, 73728
  s_add_u32 s49, s68, 128
  buffer_load_dwordx4 v81, s[20:23], s49 offen  lds
  s_add_u32 m0, s74, 74752
  s_add_u32 s49, s68, 128
  buffer_load_dwordx4 v82, s[20:23], s49 offen  lds
  s_add_u32 m0, s74, 75776
  s_add_u32 s49, s68, 128
  buffer_load_dwordx4 v83, s[20:23], s49 offen  lds
  s_add_u32 m0, s72, 83968
  s_add_u32 s49, s70, 81920
  buffer_load_dwordx4 v80, s[24:27], s49 offen lds
  s_add_u32 m0, s72, 79872
  s_nop 0
  buffer_load_dwordx4 v76, s[24:27], s49 offen offset:0 lds
  buffer_load_dwordx4 v77, s[24:27], s49 offen offset:1024 lds
  buffer_load_dwordx4 v78, s[24:27], s49 offen offset:2048 lds
  buffer_load_dwordx4 v79, s[24:27], s49 offen offset:3072 lds
  s_add_u32 m0, s75, 90112
  s_add_u32 s49, s69, 896
  buffer_load_dwordx4 v85, s[8:11], s49 offen offset:0  lds
  buffer_load_dwordx4 v86, s[8:11], s49 offen offset:1024  lds
  s_add_u32 m0, s74, 94208
  s_add_u32 s49, s68, 256
  buffer_load_dwordx4 v81, s[20:23], s49 offen  lds
  s_add_u32 m0, s74, 95232
  s_add_u32 s49, s68, 256
  buffer_load_dwordx4 v82, s[20:23], s49 offen  lds
  s_add_u32 m0, s74, 96256
  s_add_u32 s49, s68, 256
  buffer_load_dwordx4 v83, s[20:23], s49 offen  lds
  s_add_u32 m0, s72, 104448
  s_add_u32 s49, s70, 163840
  buffer_load_dwordx4 v80, s[24:27], s49 offen lds
  s_add_u32 m0, s72, 100352
  s_nop 0
  buffer_load_dwordx4 v76, s[24:27], s49 offen offset:0 lds
  buffer_load_dwordx4 v77, s[24:27], s49 offen offset:1024 lds
  buffer_load_dwordx4 v78, s[24:27], s49 offen offset:2048 lds
  buffer_load_dwordx4 v79, s[24:27], s49 offen offset:3072 lds
  s_add_u32 m0, s75, 110592
  s_add_u32 s49, s69, 1024
  buffer_load_dwordx4 v85, s[8:11], s49 offen offset:0  lds
  buffer_load_dwordx4 v86, s[8:11], s49 offen offset:1024  lds
  s_add_u32 m0, s74, 114688
  s_add_u32 s49, s68, 384
  buffer_load_dwordx4 v81, s[20:23], s49 offen  lds
  s_add_u32 m0, s74, 115712
  s_add_u32 s49, s68, 384
  buffer_load_dwordx4 v82, s[20:23], s49 offen  lds
  s_add_u32 m0, s74, 116736
  s_add_u32 s49, s68, 384
  buffer_load_dwordx4 v83, s[20:23], s49 offen  lds
  s_add_u32 m0, s72, 124928
  s_add_u32 s49, s70, 245760
  buffer_load_dwordx4 v80, s[24:27], s49 offen lds
  s_add_u32 m0, s72, 120832
  s_nop 0
  buffer_load_dwordx4 v76, s[24:27], s49 offen offset:0 lds
  s_waitcnt vmcnt(25)
  s_barrier
  buffer_load_dwordx4 v77, s[24:27], s49 offen offset:1024 lds
  buffer_load_dwordx4 v78, s[24:27], s49 offen offset:2048 lds
  buffer_load_dwordx4 v79, s[24:27], s49 offen offset:3072 lds
  s_add_u32 m0, s75, 131072
  s_add_u32 s49, s69, 1152
  buffer_load_dwordx4 v85, s[8:11], s49 offen offset:0  lds
  buffer_load_dwordx4 v86, s[8:11], s49 offen offset:1024  lds
  s_add_u32 m0, s74, 135168
  s_add_u32 s49, s68, 512
  buffer_load_dwordx4 v81, s[20:23], s49 offen  lds
  s_add_u32 m0, s74, 136192
  s_add_u32 s49, s68, 512
  buffer_load_dwordx4 v82, s[20:23], s49 offen  lds
  s_add_u32 m0, s74, 137216
  s_add_u32 s49, s68, 512
  buffer_load_dwordx4 v83, s[20:23], s49 offen  lds
  s_add_u32 m0, s72, 145408
  s_add_u32 s49, s70, 327680
  buffer_load_dwordx4 v80, s[24:27], s49 offen lds
  s_add_u32 m0, s72, 141312
  s_nop 0
  buffer_load_dwordx4 v76, s[24:27], s49 offen offset:0 lds
  buffer_load_dwordx4 v77, s[24:27], s49 offen offset:1024 lds
  s_waitcnt vmcnt(26)
  s_barrier
  s_load_dword s82, s[76:77], 0
  buffer_load_dwordx4 v78, s[24:27], s49 offen offset:2048 lds
  buffer_load_dwordx4 v79, s[24:27], s49 offen offset:3072 lds
  s_add_u32 m0, s75, 151552
  s_add_u32 s49, s69, 0
  buffer_load_dwordx4 v85, s[8:11], s49 offen offset:0  lds
  buffer_load_dwordx4 v86, s[8:11], s49 offen offset:1024  lds
  s_add_u32 m0, s74, 53248
  s_add_u32 s49, s68, 640
  buffer_load_dwordx4 v81, s[20:23], s49 offen  lds
  s_add_u32 m0, s74, 54272
  s_add_u32 s49, s68, 640
  buffer_load_dwordx4 v82, s[20:23], s49 offen  lds
  s_add_u32 m0, s74, 55296
  s_add_u32 s49, s68, 640
  buffer_load_dwordx4 v83, s[20:23], s49 offen  lds
  s_add_u32 m0, s72, 63488
  s_add_u32 s49, s70, 409600
  buffer_load_dwordx4 v80, s[24:27], s49 offen lds
  s_waitcnt vmcnt(24)
  s_barrier
  s_waitcnt lgkmcnt(0)
  s_cmp_lg_u32 s82, 0
  s_cbranch_scc1 L_zspx
  s_mov_b32 s53, 0x40000
L_zsp:
  s_sleep 4
  buffer_load_dword v5, off, s[76:79], 0 sc1
  s_sub_u32 s53, s53, 1
  s_cbranch_scc1 L_zspx
  s_waitcnt vmcnt(0)
  v_cmp_eq_u32 vcc, 0, v5
  s_cbranch_vccnz L_zsp
L_zspx:
  s_cmp_eq_u32 s73, 0
  s_cbranch_scc1 L_noadd
  s_bfe_u32 s50, s2, 0x30002
  s_lshl_b32 s50, s50, 7
  s_add_u32 s50, s50, 0x34000
  s_mov_b32 s51, 1
  s_atomic_add s51, s[44:45], s50
L_noadd:
  s_add_u32 m0, s72, 59392
  s_nop 0
  buffer_load_dwordx4 v76, s[24:27], s49 offen offset:0 lds
  buffer_load_dwordx4 v77, s[24:27], s49 offen offset:1024 lds
  buffer_load_dwordx4 v78, s[24:27], s49 offen offset:2048 lds
  buffer_load_dwordx4 v79, s[24:27], s49 offen offset:3072 lds
  s_add_u32 m0, s75, 69632
  s_add_u32 s49, s69, 128
  buffer_load_dwordx4 v85, s[8:11], s49 offen offset:0  lds
  buffer_load_dwordx4 v86, s[8:11], s49 offen offset:1024  lds
  s_waitcnt vmcnt(20)
  s_barrier
  s_add_u32 m0, s74, 73728
  s_add_u32 s49, s68, 768
  buffer_load_dwordx4 v81, s[20:23], s49 offen  lds
  s_add_u32 m0, s74, 74752
  s_add_u32 s49, s68, 768
  buffer_load_dwordx4 v82, s[20:23], s49 offen  lds
  s_add_u32 m0, s74, 75776
  s_add_u32 s49, s68, 768
  buffer_load_dwordx4 v83, s[20:23], s49 offen  lds
  s_add_u32 m0, s72, 83968
  s_add_u32 s49, s70, 491520
  buffer_load_dwordx4 v80, s[24:27], s49 offen lds
  s_add_u32 m0, s72, 79872
  s_nop 0
  buffer_load_dwordx4 v76, s[24:27], s49 offen offset:0 lds
  buffer_load_dwordx4 v77, s[24:27], s49 offen offset:1024 lds
  s_waitcnt vmcnt(16)
  s_barrier
  buffer_load_dwordx4 v78, s[24:27], s49 offen offset:2048 lds
  buffer_load_dwordx4 v79, s[24:27], s49 offen offset:3072 lds
  s_add_u32 m0, s75, 90112
  s_add_u32 s49, s69, 256
  buffer_load_dwordx4 v85, s[8:11], s49 offen offset:0  lds
  buffer_load_dwordx4 v86, s[8:11], s49 offen offset:1024  lds
  s_add_u32 m0, s74, 94208
  s_add_u32 s49, s68, 896
  buffer_load_dwordx4 v81, s[20:23], s49 offen  lds
  s_add_u32 m0, s74, 95232
  s_add_u32 s49, s68, 896
  buffer_load_dwordx4 v82, s[20:23], s49 offen  lds
  s_add_u32 m0, s74, 96256
  s_add_u32 s49, s68, 896
  buffer_load_dwordx4 v83, s[20:23], s49 offen  lds
  s_add_u32 m0, s72, 104448
  s_add_u32 s49, s70, 573440
  buffer_load_dwordx4 v80, s[24:27], s49 offen lds
  s_add_u32 m0, s72, 100352
  s_nop 0
  buffer_load_dwordx4 v76, s[24:27], s49 offen offset:0 lds
  s_waitcnt vmcnt(15)
  s_barrier
  buffer_load_dwordx4 v77, s[24:27], s49 offen offset:1024 lds
  buffer_load_dwordx4 v78, s[24:27], s49 offen offset:2048 lds
  buffer_load_dwordx4 v79, s[24:27], s49 offen offset:3072 lds
  s_add_u32 m0, s75, 110592
  s_add_u32 s49, s69, 384
  buffer_load_dwordx4 v85, s[8:11], s49 offen offset:0  lds
  buffer_load_dwordx4 v86, s[8:11], s49 offen offset:1024  lds
  s_add_u32 m0, s74, 114688
  s_add_u32 s49, s68, 1024
  buffer_load_dwordx4 v81, s[20:23], s49 offen  lds
  s_add_u32 m0, s74, 115712
  s_add_u32 s49, s68, 1024
  buffer_load_dwordx4 v82, s[20:23], s49 offen  lds
  s_add_u32 m0, s74, 116736
  s_add_u32 s49, s68, 1024
  buffer_load_dwordx4 v83, s[20:23], s49 offen  lds
  s_add_u32 m0, s72, 124928
  s_add_u32 s49, s70, 655360
  buffer_load_dwordx4 v80, s[24:27], s49 offen lds
  s_add_u32 m0, s72, 120832
  s_nop 0
  buffer_load_dwordx4 v76, s[24:27], s49 offen offset:0 lds
  s_waitcnt vmcnt(15)
  s_barrier
  buffer_load_dwordx4 v77, s[24:27], s49 offen offset:1024 lds
  buffer_load_dwordx4 v78, s[24:27], s49 offen offset:2048 lds
  buffer_load_dwordx4 v79, s[24:27], s49 offen offset:3072 lds
  s_add_u32 m0, s75, 131072
  s_add_u32 s49, s69, 512
  buffer_load_dwordx4 v85, s[8:11], s49 offen offset:0  lds
  buffer_load_dwordx4 v86, s[8:11], s49 offen offset:1024  lds
  s_add_u32 m0, s74, 135168
  s_add_u32 s49, s68, 1152
  buffer_load_dwordx4 v81, s[20:23], s49 offen  lds
  s_add_u32 m0, s74, 136192
  s_add_u32 s49, s68, 1152
  buffer_load_dwordx4 v82, s[20:23], s49 offen  lds
  s_add_u32 m0, s74, 137216
  s_add_u32 s49, s68, 1152
  buffer_load_dwordx4 v83, s[20:23], s49 offen  lds
  s_add_u32 m0, s72, 145408
  s_add_u32 s49, s70, 737280
  buffer_load_dwordx4 v80, s[24:27], s49 offen lds
  s_add_u32 m0, s72, 141312
  s_nop 0
  buffer_load_dwordx4 v76, s[24:27], s49 offen offset:0 lds
  s_waitcnt vmcnt(15)
  s_barrier
  s_load_dword s12, s[44:45], 0x34000
  s_load_dword s13, s[44:45], 0x34080
  s_load_dword s14, s[44:45], 0x34100
  s_load_dword s15, s[44:45], 0x34180
  s_load_dword s16, s[44:45], 0x34200
  s_load_dword s17, s[44:45], 0x34280
  s_load_dword s18, s[44:45], 0x34300
  s_load_dword s19, s[44:45], 0x34380
  buffer_load_dwordx4 v77, s[24:27], s49 offen offset:1024 lds
  buffer_load_dwordx4 v78, s[24:27], s49 offen offset:2048 lds
  buffer_load_dwordx4 v79, s[24:27], s49 offen offset:3072 lds
  s_waitcnt lgkmcnt(0)
  s_min_u32 s12, s12, s13
  s_min_u32 s12, s12, s14
  s_min_u32 s12, s12, s15
  s_min_u32 s12, s12, s16
  s_min_u32 s12, s12, s17
  s_min_u32 s12, s12, s18
  s_min_u32 s12, s12, s19
  s_cmp_ge_u32 s12, 32
  s_cbranch_scc0 L_kvlate
  s_add_u32 m0, s71, 0
  s_add_u32 s49, s71, 0
  buffer_load_dwordx4 v7, s[44:47], s49 offen offset:0 sc1 lds
  buffer_load_dwordx4 v7, s[44:47], s49 offen offset:1024 sc1 lds
  buffer_load_dwordx4 v7, s[44:47], s49 offen offset:2048 sc1 lds
  s_waitcnt vmcnt(11)
  s_barrier
  buffer_load_dwordx4 v7, s[44:47], s49 offen offset:3072 sc1 lds
  s_add_u32 m0, s71, 8192
  s_add_u32 s49, s71, 8192
  buffer_load_dwordx4 v7, s[44:47], s49 offen offset:0 sc1 lds
  buffer_load_dwordx4 v7, s[44:47], s49 offen offset:1024 sc1 lds
  buffer_load_dwordx4 v7, s[44:47], s49 offen offset:2048 sc1 lds
  buffer_load_dwordx4 v7, s[44:47], s49 offen offset:3072 sc1 lds
  s_add_u32 m0, s71, 16384
  s_add_u32 s49, s71, 16384
  buffer_load_dwordx4 v7, s[44:47], s49 offen offset:0 sc1 lds
  s_waitcnt vmcnt(9)
  s_barrier
  buffer_load_dwordx4 v7, s[44:47], s49 offen offset:1024 sc1 lds
  buffer_load_dwordx4 v7, s[44:47], s49 offen offset:2048 sc1 lds
  buffer_load_dwordx4 v7, s[44:47], s49 offen offset:3072 sc1 lds
  s_add_u32 m0, s71, 24576
  s_add_u32 s49, s71, 24576
  buffer_load_dwordx4 v7, s[44:47], s49 offen offset:0 sc1 lds
  buffer_load_dwordx4 v7, s[44:47], s49 offen offset:1024 sc1 lds
  buffer_load_dwordx4 v7, s[44:47], s49 offen offset:2048 sc1 lds
  buffer_load_dwordx4 v7, s[44:47], s49 offen offset:3072 sc1 lds
  s_branch L_kvgot
L_kvlate:
  s_waitcnt vmcnt(8)
  s_barrier
  s_waitcnt vmcnt(0)
  s_barrier
  v_lshlrev_b32 v5, 5, v1
  s_mov_b32 s49, 0x34000
  v_and_b32 v5, 0x380, v5
  buffer_load_dword v5, v5, s[44:47], s49 offen sc1
  s_waitcnt vmcnt(0)
  v_cmp_gt_u32 vcc, 32, v5
  s_cbranch_vccz L_kvpx
  s_mov_b32 s53, 0x40000
L_kvp:
  s_sleep 8
  v_lshlrev_b32 v5, 5, v1
  s_mov_b32 s49, 0x34000
  v_and_b32 v5, 0x380, v5
  buffer_load_dword v5, v5, s[44:47], s49 offen sc1
  s_sub_u32 s53, s53, 1
  s_cbranch_scc1 L_kvpx
  s_waitcnt vmcnt(0)
  v_cmp_gt_u32 vcc, 32, v5
  s_cbranch_vccnz L_kvp
L_kvpx:
  s_add_u32 m0, s71, 0
  s_add_u32 s49, s71, 0
  buffer_load_dwordx4 v7, s[44:47], s49 offen offset:0 sc1 lds
  buffer_load_dwordx4 v7, s[44:47], s49 offen offset:1024 sc1 lds
  buffer_load_dwordx4 v7, s[44:47], s49 offen offset:2048 sc1 lds
  buffer_load_dwordx4 v7, s[44:47], s49 offen offset:3072 sc1 lds
  s_add_u32 m0, s71, 8192
  s_add_u32 s49, s71, 8192
  buffer_load_dwordx4 v7, s[44:47], s49 offen offset:0 sc1 lds
  buffer_load_dwordx4 v7, s[44:47], s49 offen offset:1024 sc1 lds
  buffer_load_dwordx4 v7, s[44:47], s49 offen offset:2048 sc1 lds
  buffer_load_dwordx4 v7, s[44:47], s49 offen offset:3072 sc1 lds
  s_add_u32 m0, s71, 16384
  s_add_u32 s49, s71, 16384
  buffer_load_dwordx4 v7, s[44:47], s49 offen offset:0 sc1 lds
  buffer_load_dwordx4 v7, s[44:47], s49 offen offset:1024 sc1 lds
  buffer_load_dwordx4 v7, s[44:47], s49 offen offset:2048 sc1 lds
  buffer_load_dwordx4 v7, s[44:47], s49 offen offset:3072 sc1 lds
  s_add_u32 m0, s71, 24576
  s_add_u32 s49, s71, 24576
  buffer_load_dwordx4 v7, s[44:47], s49 offen offset:0 sc1 lds
  buffer_load_dwordx4 v7, s[44:47], s49 offen offset:1024 sc1 lds
  buffer_load_dwordx4 v7, s[44:47], s49 offen offset:2048 sc1 lds
  buffer_load_dwordx4 v7, s[44:47], s49 offen offset:3072 sc1 lds
L_kvgot:
  s_sub_u32 s49, s48, 256
  v_mov_b32 v4, s81
  v_mov_b32 v5, s81
  v_lshlrev_b32 v3, 8, v1
  s_mov_b64 exec, 3
  buffer_store_dwordx2 v[4:5], v3, s[44:47], s49 offen sc1
  s_mov_b64 exec, -1
  s_waitcnt vmcnt(5)
  s_branch L_attn2
L_h1:
  v_add_u32 v232, 69632, v23
  v_xor_b32 v233, 64, v232
  v_add_u32 v234, 61440, v232
  v_add_u32 v235, 61440, v233
  v_lshlrev_b32 v236, 30, v1
  v_and_b32 v236, 0x80000000, v236
  v_or_b32 v236, 1.0, v236
  s_mov_b32 s50, 81920
  v_lshlrev_b32 v4, 4, v3
  v_mad_u32_u24 v23, v2, s50, v4
  v_cmp_eq_u32 vcc, 0, v2
  v_sub_u32 v5, 32, v2
  s_mov_b32 s68, s80
  v_cndmask_b32 v5, v5, 16, vcc
  v_mad_u32_u24 v5, v5, s50, v4
  v_lshlrev_b32 v4, 3, v3
  v_sub_u32 v238, v23, v4
  v_sub_u32 v239, v5, v4
  s_lshr_b32 s70, s7, 2
  s_lshl1_add_u32 s70, s6, s70
  s_mulk_i32 s70, 1280
  s_lshl1_add_u32 s70, s68, s70
  s_add_u32 s70, s70, 0x400000
  s_barrier
  ds_read_b128 v[216:219], v234 offset:20480
  ds_read_b128 v[220:223], v234 offset:22528
  ds_read_b128 v[224:227], v235 offset:20480
  ds_read_b128 v[228:231], v235 offset:22528
  s_waitcnt lgkmcnt(3)
  v_mfma_f32_16x16x32_bf16 v[192:195], v[216:219], v[72:75], 0
  v_mfma_f32_16x16x32_bf16 v[200:203], v[216:219], v[112:115], 0
  s_waitcnt lgkmcnt(2)
  v_mfma_f32_16x16x32_bf16 v[196:199], v[220:223], v[72:75], 0
  v_mfma_f32_16x16x32_bf16 v[204:207], v[220:223], v[112:115], 0
  s_waitcnt lgkmcnt(1)
  v_mfma_f32_16x16x32_bf16 v[192:195], v[224:227], v[76:79], v[192:195]
  v_mfma_f32_16x16x32_bf16 v[200:203], v[224:227], v[116:119], v[200:203]
  s_waitcnt lgkmcnt(0)
  v_mfma_f32_16x16x32_bf16 v[196:199], v[228:231], v[76:79], v[196:199]
  v_mfma_f32_16x16x32_bf16 v[204:207], v[228:231], v[116:119], v[204:207]
  ds_read_b128 v[248:251], v7 offset:26624
  ds_read_b128 v[252:255], v7 offset:27648
  s_waitcnt lgkmcnt(0)
  s_cmp_eq_u32 s3, 7
  s_cbranch_scc1 L_nos2s
  s_mul_i32 s52, s5, 3
  s_add_u32 s52, s52, s3
  s_sub_u32 s52, s52, 4
  s_cmp_ge_u32 s52, 88
  s_cbranch_scc1 L_s2z1
  s_mul_i32 s49, s52, 187
  s_lshr_b32 s49, s49, 11
  s_mul_i32 s50, s49, 11
  s_sub_u32 s61, s52, s50
  s_lshl3_add_u32 s60, s4, s49
  s_lshl_b32 s63, s60, 13
  s_add_u32 s63, s63, 0x80000
  s_lshr_b32 s49, s60, 1
  s_and_b32 s51, s60, 1
  s_lshl_b32 s51, s51, 10
  s_add_u32 s51, s51, s49
  s_mul_i32 s62, s49, 81920
  s_add_u32 s62, s62, 0x400000
  v_and_b32 v2, 31, v1
  v_and_b32 v3, 32, v1
  v_lshl_add_u32 v4, v2, 5, s51
  s_movk_i32 s50, 2560
  s_lshl_b32 s49, s61, 6
  v_add_u32 v16, s49, v3
  v_mad_u32_u24 v15, v4, s50, v16
  v_sub_u32 v4, 0, v4
  v_and_b32 v4, 0x7ff, v4
  v_sub_u32 v17, 1248, v16
  v_subrev_u32 v16, 1, v16
  v_cmp_gt_u32 vcc, 640, v16
  v_mad_u32_u24 v17, v4, s50, v17
  v_mul_u32_u24 v16, 160, v3
  v_cndmask_b32 v18, v18, v17, vcc
  s_cmp_eq_u32 s61, 10
  s_cbranch_scc0 L_s2n1
  v_mov_b32 v15, 2.0
  v_mov_b32 v17, 2.0
  s_add_u32 s62, s62, 8388608
  s_branch L_s2z1
L_s2n1:
  v_and_b32 v4, 3, v2
  v_lshl_add_u32 v16, v4, 2, v16
  v_lshrrev_b32 v4, 3, v2
  v_lshl_add_u32 v16, v4, 4, v16
  v_bfe_u32 v4, v2, 2, 1
  v_lshl_add_u32 v16, v4, 6, v16
  s_lshl1_add_u32 s62, s49, s62
L_s2z1:
L_nos2s:
  s_barrier
  ds_read_b128 v[216:219], v232 offset:0
  ds_read_b128 v[220:223], v232 offset:2048
  ds_read_b128 v[224:227], v233 offset:0
  ds_read_b128 v[228:231], v233 offset:2048
  s_waitcnt lgkmcnt(3)
  v_mfma_f32_16x16x32_bf16 v[192:195], v[216:219], v[80:83], v[192:195]
  v_mfma_f32_16x16x32_bf16 v[200:203], v[216:219], v[120:123], v[200:203]
  s_waitcnt lgkmcnt(2)
  v_mfma_f32_16x16x32_bf16 v[196:199], v[220:223], v[80:83], v[196:199]
  v_mfma_f32_16x16x32_bf16 v[204:207], v[220:223], v[120:123], v[204:207]
  s_waitcnt lgkmcnt(1)
  v_mfma_f32_16x16x32_bf16 v[192:195], v[224:227], v[84:87], v[192:195]
  v_mfma_f32_16x16x32_bf16 v[200:203], v[224:227], v[124:127], v[200:203]
  s_waitcnt lgkmcnt(0)
  v_mfma_f32_16x16x32_bf16 v[196:199], v[228:231], v[84:87], v[196:199]
  v_mfma_f32_16x16x32_bf16 v[204:207], v[228:231], v[124:127], v[204:207]
  s_barrier
  ds_read_b128 v[216:219], v232 offset:20480
  ds_read_b128 v[220:223], v232 offset:22528
  ds_read_b128 v[224:227], v233 offset:20480
  ds_read_b128 v[228:231], v233 offset:22528
  s_waitcnt lgkmcnt(3)
  v_mfma_f32_16x16x32_bf16 v[192:195], v[216:219], v[88:91], v[192:195]
  v_mfma_f32_16x16x32_bf16 v[200:203], v[216:219], v[128:131], v[200:203]
  s_waitcnt lgkmcnt(2)
  v_mfma_f32_16x16x32_bf16 v[196:199], v[220:223], v[88:91], v[196:199]
  v_mfma_f32_16x16x32_bf16 v[204:207], v[220:223], v[128:131], v[204:207]
  s_waitcnt lgkmcnt(1)
  v_mfma_f32_16x16x32_bf16 v[192:195], v[224:227], v[92:95], v[192:195]
  v_mfma_f32_16x16x32_bf16 v[200:203], v[224:227], v[132:135], v[200:203]
  s_waitcnt lgkmcnt(0)
  v_mfma_f32_16x16x32_bf16 v[196:199], v[228:231], v[92:95], v[196:199]
  v_mfma_f32_16x16x32_bf16 v[204:207], v[228:231], v[132:135], v[204:207]
  s_barrier
  ds_read_b128 v[216:219], v232 offset:40960
  ds_read_b128 v[220:223], v232 offset:43008
  ds_read_b128 v[224:227], v233 offset:40960
  ds_read_b128 v[228:231], v233 offset:43008
  s_waitcnt lgkmcnt(3)
  v_mfma_f32_16x16x32_bf16 v[192:195], v[216:219], v[96:99], v[192:195]
  v_mfma_f32_16x16x32_bf16 v[200:203], v[216:219], v[136:139], v[200:203]
  s_waitcnt lgkmcnt(2)
  v_mfma_f32_16x16x32_bf16 v[196:199], v[220:223], v[96:99], v[196:199]
  v_mfma_f32_16x16x32_bf16 v[204:207], v[220:223], v[136:139], v[204:207]
  s_waitcnt lgkmcnt(1)
  v_mfma_f32_16x16x32_bf16 v[192:195], v[224:227], v[100:103], v[192:195]
  v_mfma_f32_16x16x32_bf16 v[200:203], v[224:227], v[140:143], v[200:203]
  s_waitcnt lgkmcnt(0)
  v_mfma_f32_16x16x32_bf16 v[196:199], v[228:231], v[100:103], v[196:199]
  v_mfma_f32_16x16x32_bf16 v[204:207], v[228:231], v[140:143], v[204:207]
  s_barrier
  ds_read_b128 v[216:219], v234 offset:0
  ds_read_b128 v[220:223], v234 offset:2048
  ds_read_b128 v[224:227], v235 offset:0
  ds_read_b128 v[228:231], v235 offset:2048
  s_waitcnt lgkmcnt(3)
  v_mfma_f32_16x16x32_bf16 v[192:195], v[216:219], v[104:107], v[192:195]
  v_mfma_f32_16x16x32_bf16 v[200:203], v[216:219], v[144:147], v[200:203]
  s_waitcnt lgkmcnt(2)
  v_mfma_f32_16x16x32_bf16 v[196:199], v[220:223], v[104:107], v[196:199]
  v_mfma_f32_16x16x32_bf16 v[204:207], v[220:223], v[144:147], v[204:207]
  s_waitcnt lgkmcnt(1)
  v_mfma_f32_16x16x32_bf16 v[192:195], v[224:227], v[108:111], v[192:195]
  v_mfma_f32_16x16x32_bf16 v[200:203], v[224:227], v[148:151], v[200:203]
  s_waitcnt lgkmcnt(0)
  v_mfma_f32_16x16x32_bf16 v[196:199], v[228:231], v[108:111], v[196:199]
  v_mfma_f32_16x16x32_bf16 v[204:207], v[228:231], v[148:151], v[204:207]
  s_barrier
  ds_read_b128 v[216:219], v234 offset:20480
  ds_read_b128 v[220:223], v234 offset:22528
  ds_read_b128 v[224:227], v235 offset:20480
  ds_read_b128 v[228:231], v235 offset:22528
  s_nop 3
  v_pk_mul_f32 v[192:193], v[192:193], v[236:237] op_sel_hi:[1,0]
  v_pk_mul_f32 v[194:195], v[194:195], v[236:237] op_sel_hi:[1,0]
  v_pk_mul_f32 v[200:201], v[200:201], v[236:237] op_sel_hi:[1,0]
  v_pk_mul_f32 v[202:203], v[202:203], v[236:237] op_sel_hi:[1,0]
  v_pk_mul_f32 v[196:197], v[196:197], v[236:237] op_sel_hi:[1,0]
  v_pk_mul_f32 v[198:199], v[198:199], v[236:237] op_sel_hi:[1,0]
  v_pk_mul_f32 v[204:205], v[204:205], v[236:237] op_sel_hi:[1,0]
  v_pk_mul_f32 v[206:207], v[206:207], v[236:237] op_sel_hi:[1,0]
  s_nop 1
  s_waitcnt lgkmcnt(3)
  v_mfma_f32_16x16x32_bf16 v[192:195], v[216:219], v[72:75], v[192:195]
  v_mfma_f32_16x16x32_bf16 v[200:203], v[216:219], v[112:115], v[200:203]
  s_waitcnt lgkmcnt(2)
  v_mfma_f32_16x16x32_bf16 v[196:199], v[220:223], v[72:75], v[196:199]
  v_mfma_f32_16x16x32_bf16 v[204:207], v[220:223], v[112:115], v[204:207]
  s_waitcnt lgkmcnt(1)
  v_mfma_f32_16x16x32_bf16 v[192:195], v[224:227], v[76:79], v[192:195]
  v_mfma_f32_16x16x32_bf16 v[200:203], v[224:227], v[116:119], v[200:203]
  s_waitcnt lgkmcnt(0)
  v_mfma_f32_16x16x32_bf16 v[196:199], v[228:231], v[76:79], v[196:199]
  v_mfma_f32_16x16x32_bf16 v[204:207], v[228:231], v[116:119], v[204:207]
  s_barrier
  ds_read_b128 v[216:219], v232 offset:0
  ds_read_b128 v[220:223], v232 offset:2048
  ds_read_b128 v[224:227], v233 offset:0
  ds_read_b128 v[228:231], v233 offset:2048
  s_waitcnt lgkmcnt(3)
  v_mfma_f32_16x16x32_bf16 v[192:195], v[216:219], v[80:83], v[192:195]
  v_mfma_f32_16x16x32_bf16 v[200:203], v[216:219], v[120:123], v[200:203]
  s_waitcnt lgkmcnt(2)
  v_mfma_f32_16x16x32_bf16 v[196:199], v[220:223], v[80:83], v[196:199]
  v_mfma_f32_16x16x32_bf16 v[204:207], v[220:223], v[120:123], v[204:207]
  s_waitcnt lgkmcnt(1)
  v_mfma_f32_16x16x32_bf16 v[192:195], v[224:227], v[84:87], v[192:195]
  v_mfma_f32_16x16x32_bf16 v[200:203], v[224:227], v[124:127], v[200:203]
  s_waitcnt lgkmcnt(0)
  v_mfma_f32_16x16x32_bf16 v[196:199], v[228:231], v[84:87], v[196:199]
  v_mfma_f32_16x16x32_bf16 v[204:207], v[228:231], v[124:127], v[204:207]
  s_barrier
  ds_read_b128 v[216:219], v232 offset:20480
  ds_read_b128 v[220:223], v232 offset:22528
  ds_read_b128 v[224:227], v233 offset:20480
  ds_read_b128 v[228:231], v233 offset:22528
  s_waitcnt lgkmcnt(3)
  v_mfma_f32_16x16x32_bf16 v[192:195], v[216:219], v[88:91], v[192:195]
  v_mfma_f32_16x16x32_bf16 v[200:203], v[216:219], v[128:131], v[200:203]
  s_waitcnt lgkmcnt(2)
  v_mfma_f32_16x16x32_bf16 v[196:199], v[220:223], v[88:91], v[196:199]
  v_mfma_f32_16x16x32_bf16 v[204:207], v[220:223], v[128:131], v[204:207]
  s_waitcnt lgkmcnt(1)
  v_mfma_f32_16x16x32_bf16 v[192:195], v[224:227], v[92:95], v[192:195]
  v_mfma_f32_16x16x32_bf16 v[200:203], v[224:227], v[132:135], v[200:203]
  s_waitcnt lgkmcnt(0)
  v_mfma_f32_16x16x32_bf16 v[196:199], v[228:231], v[92:95], v[196:199]
  v_mfma_f32_16x16x32_bf16 v[204:207], v[228:231], v[132:135], v[204:207]
  s_barrier
  ds_read_b128 v[216:219], v232 offset:40960
  ds_read_b128 v[220:223], v232 offset:43008
  ds_read_b128 v[224:227], v233 offset:40960
  ds_read_b128 v[228:231], v233 offset:43008
  s_waitcnt lgkmcnt(3)
  v_mfma_f32_16x16x32_bf16 v[192:195], v[216:219], v[96:99], v[192:195]
  v_mfma_f32_16x16x32_bf16 v[200:203], v[216:219], v[136:139], v[200:203]
  s_waitcnt lgkmcnt(2)
  v_mfma_f32_16x16x32_bf16 v[196:199], v[220:223], v[96:99], v[196:199]
  v_mfma_f32_16x16x32_bf16 v[204:207], v[220:223], v[136:139], v[204:207]
  s_waitcnt lgkmcnt(1)
  v_mfma_f32_16x16x32_bf16 v[192:195], v[224:227], v[100:103], v[192:195]
  v_mfma_f32_16x16x32_bf16 v[200:203], v[224:227], v[140:143], v[200:203]
  s_waitcnt lgkmcnt(0)
  v_mfma_f32_16x16x32_bf16 v[196:199], v[228:231], v[100:103], v[196:199]
  v_mfma_f32_16x16x32_bf16 v[204:207], v[228:231], v[140:143], v[204:207]
  s_barrier
  ds_read_b128 v[216:219], v234 offset:0
L_pad3:
  s_cbranch_execz L_pad5
  ds_read_b128 v[220:223], v234 offset:2048
  ds_read_b128 v[224:227], v235 offset:0
  ds_read_b128 v[228:231], v235 offset:2048
  s_waitcnt lgkmcnt(3)
  v_mfma_f32_16x16x32_bf16 v[192:195], v[216:219], v[104:107], v[192:195]
  v_mfma_f32_16x16x32_bf16 v[200:203], v[216:219], v[144:147], v[200:203]
  s_waitcnt lgkmcnt(2)
  v_mfma_f32_16x16x32_bf16 v[196:199], v[220:223], v[104:107], v[196:199]
  v_mfma_f32_16x16x32_bf16 v[204:207], v[220:223], v[144:147], v[204:207]
  s_waitcnt lgkmcnt(1)
  v_mfma_f32_16x16x32_bf16 v[192:195], v[224:227], v[108:111], v[192:195]
  v_mfma_f32_16x16x32_bf16 v[200:203], v[224:227], v[148:151], v[200:203]
  s_waitcnt lgkmcnt(0)
  v_mfma_f32_16x16x32_bf16 v[196:199], v[228:231], v[108:111], v[196:199]
  v_mfma_f32_16x16x32_bf16 v[204:207], v[228:231], v[148:151], v[204:207]
  s_barrier
  v_mov_b32 v84, 0xbf803f80
  v_mov_b32 v85, 0xbf803f80
  v_mov_b32 v86, 0xbf803f80
  v_mov_b32 v87, 0xbf803f80
  s_nop 2
  v_cvt_pk_bf16_f32 v72, v192, v193
  v_cvt_pk_bf16_f32 v73, v194, v195
  v_cvt_pk_bf16_f32 v74, v196, v197
  v_cvt_pk_bf16_f32 v75, v198, v199
  v_cvt_pk_bf16_f32 v76, v200, v201
  v_cvt_pk_bf16_f32 v77, v202, v203
  v_cvt_pk_bf16_f32 v78, v204, v205
  v_cvt_pk_bf16_f32 v79, v206, v207
  v_mfma_f32_16x16x32_bf16 v[88:91], v[72:75], v[248:251], 0
  v_mfma_f32_16x16x32_bf16 v[92:95], v[72:75], v[252:255], 0
  v_mfma_f32_16x16x32_bf16 v[96:99], v[72:75], v[84:87], 0
  v_mfma_f32_16x16x32_bf16 v[100:103], v[76:79], v[248:251], 0
  v_mfma_f32_16x16x32_bf16 v[104:107], v[76:79], v[252:255], 0
  v_mfma_f32_16x16x32_bf16 v[108:111], v[76:79], v[84:87], 0
  s_nop 3
  v_add_f32 v124, v88, v93
  v_sub_f32 v125, v92, v89
  v_sub_f32 v126, v88, v93
  v_add_f32 v127, v92, v89
  v_cvt_pk_bf16_f32 v184, v124, v125
  v_cvt_pk_bf16_f32 v192, v126, -v127
  v_add_f32 v124, v90, v95
  v_sub_f32 v125, v94, v91
  v_sub_f32 v126, v90, v95
  v_add_f32 v127, v94, v91
  v_cvt_pk_bf16_f32 v185, v124, v125
  v_cvt_pk_bf16_f32 v193, v126, -v127
  v_add_f32 v124, v100, v105
  v_sub_f32 v125, v104, v101
  v_sub_f32 v126, v100, v105
  v_add_f32 v127, v104, v101
  v_cvt_pk_bf16_f32 v186, v124, v125
  v_cvt_pk_bf16_f32 v194, v126, -v127
  v_add_f32 v124, v102, v107
  v_sub_f32 v125, v106, v103
  v_sub_f32 v126, v102, v107
  v_add_f32 v127, v106, v103
  v_cvt_pk_bf16_f32 v187, v124, v125
  v_cvt_pk_bf16_f32 v195, v126, -v127
  s_mov_b32 exec_lo, 0x10001
  s_mov_b32 exec_hi, 0x10001
  v_cvt_pk_bf16_f32 v192, v96, -v97
  v_cvt_pk_bf16_f32 v193, v98, -v99
  v_cvt_pk_bf16_f32 v194, v108, -v109
  v_cvt_pk_bf16_f32 v195, v110, -v111
  s_mov_b64 exec, -1
  s_branch L_attn
L_h2:
  v_add_u32 v232, 69632, v23
  v_xor_b32 v233, 64, v232
  v_add_u32 v234, 61440, v232
  v_add_u32 v235, 61440, v233
  v_lshlrev_b32 v236, 30, v1
  v_and_b32 v236, 0x80000000, v236
  v_or_b32 v236, 1.0, v236
  s_mov_b32 s50, 81920
  v_lshlrev_b32 v4, 4, v3
  v_mad_u32_u24 v23, v2, s50, v4
  v_cmp_eq_u32 vcc, 0, v2
  v_sub_u32 v5, 32, v2
  s_mov_b32 s68, s80
  v_cndmask_b32 v5, v5, 16, vcc
  v_mad_u32_u24 v5, v5, s50, v4
  v_lshlrev_b32 v4, 3, v3
  v_sub_u32 v238, v23, v4
  v_sub_u32 v239, v5, v4
  s_lshr_b32 s70, s7, 2
  s_lshl1_add_u32 s70, s6, s70
  s_mulk_i32 s70, 1280
  s_lshl1_add_u32 s70, s68, s70
  s_add_u32 s70, s70, 0x400000
  s_barrier
  ds_read_b128 v[216:219], v234 offset:20480
  ds_read_b128 v[220:223], v234 offset:22528
  ds_read_b128 v[224:227], v235 offset:20480
  ds_read_b128 v[228:231], v235 offset:22528
  s_waitcnt lgkmcnt(3)
  v_mfma_f32_16x16x32_bf16 v[192:195], v[216:219], v[72:75], 0
  v_mfma_f32_16x16x32_bf16 v[200:203], v[216:219], v[112:115], 0
  v_mfma_f32_16x16x32_bf16 v[208:211], v[216:219], v[152:155], 0
  s_waitcnt lgkmcnt(2)
  v_mfma_f32_16x16x32_bf16 v[196:199], v[220:223], v[72:75], 0
  v_mfma_f32_16x16x32_bf16 v[204:207], v[220:223], v[112:115], 0
  v_mfma_f32_16x16x32_bf16 v[212:215], v[220:223], v[152:155], 0
  s_waitcnt lgkmcnt(1)
  v_mfma_f32_16x16x32_bf16 v[192:195], v[224:227], v[76:79], v[192:195]
  v_mfma_f32_16x16x32_bf16 v[200:203], v[224:227], v[116:119], v[200:203]
  v_mfma_f32_16x16x32_bf16 v[208:211], v[224:227], v[156:159], v[208:211]
  s_waitcnt lgkmcnt(0)
  v_mfma_f32_16x16x32_bf16 v[196:199], v[228:231], v[76:79], v[196:199]
  v_mfma_f32_16x16x32_bf16 v[204:207], v[228:231], v[116:119], v[204:207]
  v_mfma_f32_16x16x32_bf16 v[212:215], v[228:231], v[156:159], v[212:215]
  ds_read_b128 v[248:251], v7 offset:26624
  ds_read_b128 v[252:255], v7 offset:27648
  s_waitcnt lgkmcnt(0)
  s_barrier
  ds_read_b128 v[216:219], v232 offset:0
  ds_read_b128 v[220:223], v232 offset:2048
  ds_read_b128 v[224:227], v233 offset:0
  ds_read_b128 v[228:231], v233 offset:2048
  s_waitcnt lgkmcnt(3)
  v_mfma_f32_16x16x32_bf16 v[192:195], v[216:219], v[80:83], v[192:195]
  v_mfma_f32_16x16x32_bf16 v[200:203], v[216:219], v[120:123], v[200:203]
  v_mfma_f32_16x16x32_bf16 v[208:211], v[216:219], v[160:163], v[208:211]
  s_waitcnt lgkmcnt(2)
  v_mfma_f32_16x16x32_bf16 v[196:199], v[220:223], v[80:83], v[196:199]
  v_mfma_f32_16x16x32_bf16 v[204:207], v[220:223], v[120:123], v[204:207]
  v_mfma_f32_16x16x32_bf16 v[212:215], v[220:223], v[160:163], v[212:215]
  s_waitcnt lgkmcnt(1)
  v_mfma_f32_16x16x32_bf16 v[192:195], v[224:227], v[84:87], v[192:195]
  v_mfma_f32_16x16x32_bf16 v[200:203], v[224:227], v[124:127], v[200:203]
  v_mfma_f32_16x16x32_bf16 v[208:211], v[224:227], v[164:167], v[208:211]
  s_waitcnt lgkmcnt(0)
  v_mfma_f32_16x16x32_bf16 v[196:199], v[228:231], v[84:87], v[196:199]
  v_mfma_f32_16x16x32_bf16 v[204:207], v[228:231], v[124:127], v[204:207]
  v_mfma_f32_16x16x32_bf16 v[212:215], v[228:231], v[164:167], v[212:215]
  s_barrier
  ds_read_b128 v[216:219], v232 offset:20480
  ds_read_b128 v[220:223], v232 offset:22528
  ds_read_b128 v[224:227], v233 offset:20480
  ds_read_b128 v[228:231], v233 offset:22528
  s_waitcnt lgkmcnt(3)
  v_mfma_f32_16x16x32_bf16 v[192:195], v[216:219], v[88:91], v[192:195]
  v_mfma_f32_16x16x32_bf16 v[200:203], v[216:219], v[128:131], v[200:203]
  v_mfma_f32_16x16x32_bf16 v[208:211], v[216:219], v[168:171], v[208:211]
  s_waitcnt lgkmcnt(2)
  v_mfma_f32_16x16x32_bf16 v[196:199], v[220:223], v[88:91], v[196:199]
  v_mfma_f32_16x16x32_bf16 v[204:207], v[220:223], v[128:131], v[204:207]
  v_mfma_f32_16x16x32_bf16 v[212:215], v[220:223], v[168:171], v[212:215]
  s_waitcnt lgkmcnt(1)
  v_mfma_f32_16x16x32_bf16 v[192:195], v[224:227], v[92:95], v[192:195]
  v_mfma_f32_16x16x32_bf16 v[200:203], v[224:227], v[132:135], v[200:203]
  v_mfma_f32_16x16x32_bf16 v[208:211], v[224:227], v[172:175], v[208:211]
  s_waitcnt lgkmcnt(0)
  v_mfma_f32_16x16x32_bf16 v[196:199], v[228:231], v[92:95], v[196:199]
  v_mfma_f32_16x16x32_bf16 v[204:207], v[228:231], v[132:135], v[204:207]
  v_mfma_f32_16x16x32_bf16 v[212:215], v[228:231], v[172:175], v[212:215]
  s_barrier
  ds_read_b128 v[216:219], v232 offset:40960
  ds_read_b128 v[220:223], v232 offset:43008
  ds_read_b128 v[224:227], v233 offset:40960
  ds_read_b128 v[228:231], v233 offset:43008
  s_waitcnt lgkmcnt(3)
  v_mfma_f32_16x16x32_bf16 v[192:195], v[216:219], v[96:99], v[192:195]
  v_mfma_f32_16x16x32_bf16 v[200:203], v[216:219], v[136:139], v[200:203]
  v_mfma_f32_16x16x32_bf16 v[208:211], v[216:219], v[176:179], v[208:211]
  s_waitcnt lgkmcnt(2)
  v_mfma_f32_16x16x32_bf16 v[196:199], v[220:223], v[96:99], v[196:199]
  v_mfma_f32_16x16x32_bf16 v[204:207], v[220:223], v[136:139], v[204:207]
  v_mfma_f32_16x16x32_bf16 v[212:215], v[220:223], v[176:179], v[212:215]
  s_waitcnt lgkmcnt(1)
  v_mfma_f32_16x16x32_bf16 v[192:195], v[224:227], v[100:103], v[192:195]
  v_mfma_f32_16x16x32_bf16 v[200:203], v[224:227], v[140:143], v[200:203]
  v_mfma_f32_16x16x32_bf16 v[208:211], v[224:227], v[180:183], v[208:211]
  s_waitcnt lgkmcnt(0)
  v_mfma_f32_16x16x32_bf16 v[196:199], v[228:231], v[100:103], v[196:199]
  v_mfma_f32_16x16x32_bf16 v[204:207], v[228:231], v[140:143], v[204:207]
  v_mfma_f32_16x16x32_bf16 v[212:215], v[228:231], v[180:183], v[212:215]
  s_barrier
  ds_read_b128 v[216:219], v234 offset:0
  ds_read_b128 v[220:223], v234 offset:2048
  ds_read_b128 v[224:227], v235 offset:0
  ds_read_b128 v[228:231], v235 offset:2048
  s_waitcnt lgkmcnt(3)
  v_mfma_f32_16x16x32_bf16 v[192:195], v[216:219], v[104:107], v[192:195]
  v_mfma_f32_16x16x32_bf16 v[200:203], v[216:219], v[144:147], v[200:203]
  v_mfma_f32_16x16x32_bf16 v[208:211], v[216:219], v[184:187], v[208:211]
  s_waitcnt lgkmcnt(2)
  v_mfma_f32_16x16x32_bf16 v[196:199], v[220:223], v[104:107], v[196:199]
  v_mfma_f32_16x16x32_bf16 v[204:207], v[220:223], v[144:147], v[204:207]
  v_mfma_f32_16x16x32_bf16 v[212:215], v[220:223], v[184:187], v[212:215]
  s_waitcnt lgkmcnt(1)
  v_mfma_f32_16x16x32_bf16 v[192:195], v[224:227], v[108:111], v[192:195]
  v_mfma_f32_16x16x32_bf16 v[200:203], v[224:227], v[148:151], v[200:203]
  v_mfma_f32_16x16x32_bf16 v[208:211], v[224:227], v[188:191], v[208:211]
  s_waitcnt lgkmcnt(0)
  v_mfma_f32_16x16x32_bf16 v[196:199], v[228:231], v[108:111], v[196:199]
  v_mfma_f32_16x16x32_bf16 v[204:207], v[228:231], v[148:151], v[204:207]
  v_mfma_f32_16x16x32_bf16 v[212:215], v[228:231], v[188:191], v[212:215]
  s_barrier
  ds_read_b128 v[216:219], v234 offset:20480
  ds_read_b128 v[220:223], v234 offset:22528
  ds_read_b128 v[224:227], v235 offset:20480
  ds_read_b128 v[228:231], v235 offset:22528
  s_nop 3
  v_pk_mul_f32 v[192:193], v[192:193], v[236:237] op_sel_hi:[1,0]
  v_pk_mul_f32 v[194:195], v[194:195], v[236:237] op_sel_hi:[1,0]
  v_pk_mul_f32 v[200:201], v[200:201], v[236:237] op_sel_hi:[1,0]
  v_pk_mul_f32 v[202:203], v[202:203], v[236:237] op_sel_hi:[1,0]
  v_pk_mul_f32 v[208:209], v[208:209], v[236:237] op_sel_hi:[1,0]
  v_pk_mul_f32 v[210:211], v[210:211], v[236:237] op_sel_hi:[1,0]
  v_pk_mul_f32 v[196:197], v[196:197], v[236:237] op_sel_hi:[1,0]
  v_pk_mul_f32 v[198:199], v[198:199], v[236:237] op_sel_hi:[1,0]
  v_pk_mul_f32 v[204:205], v[204:205], v[236:237] op_sel_hi:[1,0]
  v_pk_mul_f32 v[206:207], v[206:207], v[236:237] op_sel_hi:[1,0]
  v_pk_mul_f32 v[212:213], v[212:213], v[236:237] op_sel_hi:[1,0]
  v_pk_mul_f32 v[214:215], v[214:215], v[236:237] op_sel_hi:[1,0]
  s_nop 1
  s_waitcnt lgkmcnt(3)
  v_mfma_f32_16x16x32_bf16 v[192:195], v[216:219], v[72:75], v[192:195]
  v_mfma_f32_16x16x32_bf16 v[200:203], v[216:219], v[112:115], v[200:203]
  v_mfma_f32_16x16x32_bf16 v[208:211], v[216:219], v[152:155], v[208:211]
  s_waitcnt lgkmcnt(2)
  v_mfma_f32_16x16x32_bf16 v[196:199], v[220:223], v[72:75], v[196:199]
  v_mfma_f32_16x16x32_bf16 v[204:207], v[220:223], v[112:115], v[204:207]
  v_mfma_f32_16x16x32_bf16 v[212:215], v[220:223], v[152:155], v[212:215]
  s_waitcnt lgkmcnt(1)
  v_mfma_f32_16x16x32_bf16 v[192:195], v[224:227], v[76:79], v[192:195]
  v_mfma_f32_16x16x32_bf16 v[200:203], v[224:227], v[116:119], v[200:203]
  v_mfma_f32_16x16x32_bf16 v[208:211], v[224:227], v[156:159], v[208:211]
  s_waitcnt lgkmcnt(0)
  v_mfma_f32_16x16x32_bf16 v[196:199], v[228:231], v[76:79], v[196:199]
  v_mfma_f32_16x16x32_bf16 v[204:207], v[228:231], v[116:119], v[204:207]
  v_mfma_f32_16x16x32_bf16 v[212:215], v[228:231], v[156:159], v[212:215]
  s_barrier
  ds_read_b128 v[216:219], v232 offset:0
  ds_read_b128 v[220:223], v232 offset:2048
  ds_read_b128 v[224:227], v233 offset:0
  ds_read_b128 v[228:231], v233 offset:2048
  s_waitcnt lgkmcnt(3)
  v_mfma_f32_16x16x32_bf16 v[192:195], v[216:219], v[80:83], v[192:195]
  v_mfma_f32_16x16x32_bf16 v[200:203], v[216:219], v[120:123], v[200:203]
  v_mfma_f32_16x16x32_bf16 v[208:211], v[216:219], v[160:163], v[208:211]
  s_waitcnt lgkmcnt(2)
  v_mfma_f32_16x16x32_bf16 v[196:199], v[220:223], v[80:83], v[196:199]
  v_mfma_f32_16x16x32_bf16 v[204:207], v[220:223], v[120:123], v[204:207]
  v_mfma_f32_16x16x32_bf16 v[212:215], v[220:223], v[160:163], v[212:215]
  s_waitcnt lgkmcnt(1)
  v_mfma_f32_16x16x32_bf16 v[192:195], v[224:227], v[84:87], v[192:195]
  v_mfma_f32_16x16x32_bf16 v[200:203], v[224:227], v[124:127], v[200:203]
  v_mfma_f32_16x16x32_bf16 v[208:211], v[224:227], v[164:167], v[208:211]
  s_waitcnt lgkmcnt(0)
  v_mfma_f32_16x16x32_bf16 v[196:199], v[228:231], v[84:87], v[196:199]
  v_mfma_f32_16x16x32_bf16 v[204:207], v[228:231], v[124:127], v[204:207]
  v_mfma_f32_16x16x32_bf16 v[212:215], v[228:231], v[164:167], v[212:215]
  s_barrier
  ds_read_b128 v[216:219], v232 offset:20480
  ds_read_b128 v[220:223], v232 offset:22528
  ds_read_b128 v[224:227], v233 offset:20480
  ds_read_b128 v[228:231], v233 offset:22528
  s_waitcnt lgkmcnt(3)
  v_mfma_f32_16x16x32_bf16 v[192:195], v[216:219], v[88:91], v[192:195]
  v_mfma_f32_16x16x32_bf16 v[200:203], v[216:219], v[128:131], v[200:203]
  v_mfma_f32_16x16x32_bf16 v[208:211], v[216:219], v[168:171], v[208:211]
  s_waitcnt lgkmcnt(2)
  v_mfma_f32_16x16x32_bf16 v[196:199], v[220:223], v[88:91], v[196:199]
  v_mfma_f32_16x16x32_bf16 v[204:207], v[220:223], v[128:131], v[204:207]
  v_mfma_f32_16x16x32_bf16 v[212:215], v[220:223], v[168:171], v[212:215]
  s_waitcnt lgkmcnt(1)
  v_mfma_f32_16x16x32_bf16 v[192:195], v[224:227], v[92:95], v[192:195]
  v_mfma_f32_16x16x32_bf16 v[200:203], v[224:227], v[132:135], v[200:203]
  v_mfma_f32_16x16x32_bf16 v[208:211], v[224:227], v[172:175], v[208:211]
  s_waitcnt lgkmcnt(0)
  v_mfma_f32_16x16x32_bf16 v[196:199], v[228:231], v[92:95], v[196:199]
  v_mfma_f32_16x16x32_bf16 v[204:207], v[228:231], v[132:135], v[204:207]
  v_mfma_f32_16x16x32_bf16 v[212:215], v[228:231], v[172:175], v[212:215]
  s_barrier
  ds_read_b128 v[216:219], v232 offset:40960
  ds_read_b128 v[220:223], v232 offset:43008
  ds_read_b128 v[224:227], v233 offset:40960
  ds_read_b128 v[228:231], v233 offset:43008
  s_waitcnt lgkmcnt(3)
  v_mfma_f32_16x16x32_bf16 v[192:195], v[216:219], v[96:99], v[192:195]
  v_mfma_f32_16x16x32_bf16 v[200:203], v[216:219], v[136:139], v[200:203]
  v_mfma_f32_16x16x32_bf16 v[208:211], v[216:219], v[176:179], v[208:211]
  s_waitcnt lgkmcnt(2)
  v_mfma_f32_16x16x32_bf16 v[196:199], v[220:223], v[96:99], v[196:199]
  v_mfma_f32_16x16x32_bf16 v[204:207], v[220:223], v[136:139], v[204:207]
  v_mfma_f32_16x16x32_bf16 v[212:215], v[220:223], v[176:179], v[212:215]
  s_waitcnt lgkmcnt(1)
  v_mfma_f32_16x16x32_bf16 v[192:195], v[224:227], v[100:103], v[192:195]
  v_mfma_f32_16x16x32_bf16 v[200:203], v[224:227], v[140:143], v[200:203]
  v_mfma_f32_16x16x32_bf16 v[208:211], v[224:227], v[180:183], v[208:211]
  s_waitcnt lgkmcnt(0)
  v_mfma_f32_16x16x32_bf16 v[196:199], v[228:231], v[100:103], v[196:199]
  v_mfma_f32_16x16x32_bf16 v[204:207], v[228:231], v[140:143], v[204:207]
  v_mfma_f32_16x16x32_bf16 v[212:215], v[228:231], v[180:183], v[212:215]
  s_barrier
  ds_read_b128 v[216:219], v234 offset:0
  ds_read_b128 v[220:223], v234 offset:2048
  ds_read_b128 v[224:227], v235 offset:0
  ds_read_b128 v[228:231], v235 offset:2048
  s_waitcnt lgkmcnt(3)
  v_mfma_f32_16x16x32_bf16 v[192:195], v[216:219], v[104:107], v[192:195]
  v_mfma_f32_16x16x32_bf16 v[200:203], v[216:219], v[144:147], v[200:203]
  v_mfma_f32_16x16x32_bf16 v[208:211], v[216:219], v[184:187], v[208:211]
  s_waitcnt lgkmcnt(2)
  v_mfma_f32_16x16x32_bf16 v[196:199], v[220:223], v[104:107], v[196:199]
  v_mfma_f32_16x16x32_bf16 v[204:207], v[220:223], v[144:147], v[204:207]
  v_mfma_f32_16x16x32_bf16 v[212:215], v[220:223], v[184:187], v[212:215]
  s_waitcnt lgkmcnt(1)
  v_mfma_f32_16x16x32_bf16 v[192:195], v[224:227], v[108:111], v[192:195]
  v_mfma_f32_16x16x32_bf16 v[200:203], v[224:227], v[148:151], v[200:203]
  v_mfma_f32_16x16x32_bf16 v[208:211], v[224:227], v[188:191], v[208:211]
  s_waitcnt lgkmcnt(0)
  v_mfma_f32_16x16x32_bf16 v[196:199], v[228:231], v[108:111], v[196:199]
  v_mfma_f32_16x16x32_bf16 v[204:207], v[228:231], v[148:151], v[204:207]
  v_mfma_f32_16x16x32_bf16 v[212:215], v[228:231], v[188:191], v[212:215]
  s_barrier
  v_mov_b32 v84, 0xbf803f80
  v_mov_b32 v85, 0xbf803f80
  v_mov_b32 v86, 0xbf803f80
  v_mov_b32 v87, 0xbf803f80
  s_nop 2
  v_cvt_pk_bf16_f32 v72, v192, v193
  v_cvt_pk_bf16_f32 v73, v194, v195
  v_cvt_pk_bf16_f32 v74, v196, v197
  v_cvt_pk_bf16_f32 v75, v198, v199
  v_cvt_pk_bf16_f32 v76, v200, v201
  v_cvt_pk_bf16_f32 v77, v202, v203
  v_cvt_pk_bf16_f32 v78, v204, v205
  v_cvt_pk_bf16_f32 v79, v206, v207
  v_cvt_pk_bf16_f32 v80, v208, v209
  v_cvt_pk_bf16_f32 v81, v210, v211
  v_cvt_pk_bf16_f32 v82, v212, v213
  v_cvt_pk_bf16_f32 v83, v214, v215
  v_mfma_f32_16x16x32_bf16 v[88:91], v[72:75], v[248:251], 0
  v_mfma_f32_16x16x32_bf16 v[92:95], v[72:75], v[252:255], 0
  v_mfma_f32_16x16x32_bf16 v[96:99], v[72:75], v[84:87], 0
  v_mfma_f32_16x16x32_bf16 v[100:103], v[76:79], v[248:251], 0
  v_mfma_f32_16x16x32_bf16 v[104:107], v[76:79], v[252:255], 0
  v_mfma_f32_16x16x32_bf16 v[108:111], v[76:79], v[84:87], 0
  v_mfma_f32_16x16x32_bf16 v[112:115], v[80:83], v[248:251], 0
  v_mfma_f32_16x16x32_bf16 v[116:119], v[80:83], v[252:255], 0
  v_mfma_f32_16x16x32_bf16 v[120:123], v[80:83], v[84:87], 0
  s_nop 0
  s_cmp_eq_u32 s68, 0
  s_cbranch_scc0 L_nonyq
  v_cvt_pk_bf16_f32 v190, v89, v93
  v_cvt_pk_bf16_f32 v191, v89, -v93
  s_mov_b64 exec, 1
  v_cvt_pk_bf16_f32 v191, v97, 0
  s_mov_b64 exec, 0xffff
  v_mov_b32 v89, 0
  v_mov_b32 v93, 0
  v_mov_b32 v97, 0
  s_mov_b64 exec, -1
L_nonyq:
  v_add_f32 v124, v88, v93
  v_sub_f32 v125, v92, v89
  v_sub_f32 v126, v88, v93
  v_add_f32 v127, v92, v89
  v_cvt_pk_bf16_f32 v184, v124, v125
  v_cvt_pk_bf16_f32 v192, v126, -v127
  v_add_f32 v124, v90, v95
  v_sub_f32 v125, v94, v91
  v_sub_f32 v126, v90, v95
  v_add_f32 v127, v94, v91
  v_cvt_pk_bf16_f32 v185, v124, v125
  v_cvt_pk_bf16_f32 v193, v126, -v127
  v_add_f32 v124, v100, v105
  v_sub_f32 v125, v104, v101
  v_sub_f32 v126, v100, v105
  v_add_f32 v127, v104, v101
  v_cvt_pk_bf16_f32 v186, v124, v125
  v_cvt_pk_bf16_f32 v194, v126, -v127
  v_add_f32 v124, v102, v107
  v_sub_f32 v125, v106, v103
  v_sub_f32 v126, v102, v107
  v_add_f32 v127, v106, v103
  v_cvt_pk_bf16_f32 v187, v124, v125
  v_cvt_pk_bf16_f32 v195, v126, -v127
  v_add_f32 v124, v112, v117
  v_sub_f32 v125, v116, v113
  v_sub_f32 v126, v112, v117
  v_add_f32 v127, v116, v113
  v_cvt_pk_bf16_f32 v188, v124, v125
  v_cvt_pk_bf16_f32 v196, v126, -v127
  v_add_f32 v124, v114, v119
  v_sub_f32 v125, v118, v115
  v_sub_f32 v126, v114, v119
  v_add_f32 v127, v118, v115
  v_cvt_pk_bf16_f32 v189, v124, v125
  v_cvt_pk_bf16_f32 v197, v126, -v127
  s_mov_b32 exec_lo, 0x10001
  s_mov_b32 exec_hi, 0x10001
  v_cvt_pk_bf16_f32 v192, v96, -v97
  v_cvt_pk_bf16_f32 v193, v98, -v99
  v_cvt_pk_bf16_f32 v194, v108, -v109
  v_cvt_pk_bf16_f32 v195, v110, -v111
  v_cvt_pk_bf16_f32 v196, v120, -v121
  v_cvt_pk_bf16_f32 v197, v122, -v123
  s_mov_b64 exec, -1
L_attn:
  s_bitcmp1_b32 s3, 1
  s_cbranch_scc0 L_tsx
  buffer_store_dwordx4 v[184:187], v23, s[44:47], s70 offen sc1
  buffer_store_dwordx4 v[192:195], v5, s[44:47], s70 offen sc1
  s_cmp_ge_u32 s3, 4
  s_cbranch_scc1 L_tsx
  buffer_store_dwordx2 v[188:189], v238, s[44:47], s70 offen offset:64 sc1
  buffer_store_dwordx2 v[196:197], v239, s[44:47], s70 offen offset:64 sc1
  s_cmp_eq_u32 s68, 0
  s_cbranch_scc0 L_tsx
  s_add_u32 s70, s70, 8388608
  s_mov_b64 exec, 0xffff
  buffer_store_dword v190, v23, s[44:47], s70 offen sc1
  buffer_store_dword v191, v5, s[44:47], s70 offen sc1
  s_mov_b64 exec, -1
L_tsx:
L_attn2:
  s_waitcnt lgkmcnt(0)
  s_barrier
  ds_read_b64 v[76:77], v20 offset:1024
  ds_read2st64_b64 v[80:83], v13 offset0:8 offset1:9
  ds_read_b128 v[72:75], v19
  ds_read_b128 v[96:99], v7 offset:0
  ds_read_b128 v[100:103], v7 offset:1024
  s_waitcnt lgkmcnt(3)
  v_mfma_f32_32x32x4_2b_bf16 v[104:135], v[80:81], v[76:77], 0
  ds_read_b128 v[88:91], v7 offset:2048
  ds_read_b128 v[92:95], v7 offset:3072
  s_mov_b64 exec, s[54:55]
  ds_read_b128 v[24:27], v10 offset:0
  ds_read_b128 v[28:31], v10 offset:640
  ds_read_b128 v[32:35], v10 offset:1280
  ds_read_b128 v[36:39], v10 offset:1920
  s_mov_b64 exec, -1
  s_nop 8
  s_waitcnt lgkmcnt(6)
  v_mfma_f32_32x32x16_bf16 v[104:119], v[96:99], v[72:75], v[104:119]
  v_mfma_f32_32x32x16_bf16 v[120:135], v[100:103], v[72:75], v[120:135]
  s_cmp_ge_u32 s3, 2
  s_cbranch_scc1 L_nocfs
  buffer_store_dwordx4 v[248:251], v7, s[44:47], s73 offen sc1
L_nocfs:
  s_nop 10
  v_max3_f32 v2, v104, v105, v106
  v_max3_f32 v3, v107, v108, v109
  v_max3_f32 v2, v2, v110, v111
  v_max3_f32 v3, v3, v112, v113
  v_max3_f32 v2, v2, v114, v115
  v_max3_f32 v3, v3, v116, v117
  v_max3_f32 v2, v2, v118, v119
  v_max3_f32 v3, v3, v120, v121
  v_max3_f32 v2, v2, v122, v123
  v_max3_f32 v3, v3, v124, v125
  v_max3_f32 v2, v2, v126, v127
  v_max3_f32 v3, v3, v128, v129
  v_max3_f32 v2, v2, v130, v131
  v_max3_f32 v3, v3, v132, v133
  v_max3_f32 v2, v2, v134, v135
  v_max_f32 v2, v2, v3
  v_mov_b32 v3, v2
  s_nop 1
  v_permlane32_swap_b32 v2, v3
  s_nop 1
  v_max_f32 v2, v2, v3
  v_sub_f32 v168, -100.0, v2
  v_sub_f32 v169, -100.0, v2
  v_pk_mov_b32 v[170:171], v[168:169], v[168:169]
  v_pk_mov_b32 v[172:173], v[168:169], v[168:169]
  v_pk_mov_b32 v[174:175], v[168:169], v[168:169]
  v_pk_mov_b32 v[176:177], v[168:169], v[168:169]
  v_pk_mov_b32 v[178:179], v[168:169], v[168:169]
  v_pk_mov_b32 v[180:181], v[168:169], v[168:169]
  v_pk_mov_b32 v[182:183], v[168:169], v[168:169]
  v_pk_add_f32 v[104:105], v[104:105], v[168:169]
  v_pk_add_f32 v[106:107], v[106:107], v[168:169]
  v_pk_add_f32 v[108:109], v[108:109], v[168:169]
  v_pk_add_f32 v[110:111], v[110:111], v[168:169]
  v_pk_add_f32 v[112:113], v[112:113], v[168:169]
  v_pk_add_f32 v[114:115], v[114:115], v[168:169]
  v_pk_add_f32 v[116:117], v[116:117], v[168:169]
  v_pk_add_f32 v[118:119], v[118:119], v[168:169]
  v_pk_add_f32 v[120:121], v[120:121], v[168:169]
  v_pk_add_f32 v[122:123], v[122:123], v[168:169]
  v_pk_add_f32 v[124:125], v[124:125], v[168:169]
  v_pk_add_f32 v[126:127], v[126:127], v[168:169]
  v_pk_add_f32 v[128:129], v[128:129], v[168:169]
  v_pk_add_f32 v[130:131], v[130:131], v[168:169]
  v_pk_add_f32 v[132:133], v[132:133], v[168:169]
  v_pk_add_f32 v[134:135], v[134:135], v[168:169]
  s_cmp_ge_u32 s3, 4
  s_cbranch_scc1 L_young
  s_setprio 1
  s_waitcnt lgkmcnt(0)
  v_exp_f32 v104, v104
  v_exp_f32 v105, v105
  v_exp_f32 v106, v106
  v_exp_f32 v107, v107
  v_exp_f32 v108, v108
  v_exp_f32 v109, v109
  v_mfma_f32_32x32x16_bf16 v[136:151], v[88:91], v[72:75], v[168:183]
  v_exp_f32 v110, v110
  v_exp_f32 v111, v111
  v_exp_f32 v112, v112
  v_exp_f32 v113, v113
  v_mfma_f32_32x32x16_bf16 v[152:167], v[92:95], v[72:75], v[168:183]
  v_exp_f32 v114, v114
  v_exp_f32 v115, v115
  v_exp_f32 v116, v116
  ds_read_b128 v[96:99], v7 offset:10240
  ds_read_b128 v[100:103], v7 offset:11264
  ds_read2st64_b64 v[84:87], v13 offset0:28 offset1:29
  v_exp_f32 v117, v117
  v_smfmac_f32_32x32x32_bf16 v[56:71], v[24:27], v[104:111], v6
  v_exp_f32 v118, v118
  v_exp_f32 v119, v119
  v_exp_f32 v120, v120
  v_exp_f32 v121, v121
  s_add_u32 m0, s58, 32768
  s_add_u32 s49, s58, 32768
  buffer_load_dwordx4 v7, s[44:47], s49 offen offset:0 sc1 lds
  buffer_load_dwordx4 v7, s[44:47], s49 offen offset:1024 sc1 lds
  buffer_load_dwordx4 v7, s[44:47], s49 offen offset:2048 sc1 lds
  buffer_load_dwordx4 v7, s[44:47], s49 offen offset:3072 sc1 lds
  v_exp_f32 v122, v122
  v_mfma_f32_32x32x4_2b_bf16 v[136:167], v[82:83], v[76:77], v[136:167]
  v_exp_f32 v123, v123
  v_exp_f32 v124, v124
  v_exp_f32 v125, v125
  v_exp_f32 v126, v126
  v_exp_f32 v127, v127
  v_exp_f32 v128, v128
  v_exp_f32 v129, v129
  s_mov_b64 exec, s[54:55]
  ds_read_b128 v[40:43], v10 offset:2560
  ds_read_b128 v[44:47], v10 offset:3200
  ds_read_b128 v[48:51], v10 offset:3840
  ds_read_b128 v[52:55], v10 offset:4480
  s_mov_b64 exec, -1
  v_exp_f32 v130, v130
  v_smfmac_f32_32x32x32_bf16 v[56:71], v[28:31], v[112:119], v6
  v_exp_f32 v131, v131
  v_exp_f32 v132, v132
  v_exp_f32 v133, v133
  v_smfmac_f32_32x32x32_bf16 v[56:71], v[32:35], v[120:127], v6
  v_exp_f32 v134, v134
  v_exp_f32 v135, v135
  s_setprio 0
  s_waitcnt lgkmcnt(0)
  v_exp_f32 v136, v136
  v_exp_f32 v137, v137
  v_exp_f32 v138, v138
  v_smfmac_f32_32x32x32_bf16 v[56:71], v[36:39], v[128:135], v6
  v_exp_f32 v139, v139
  v_exp_f32 v140, v140
  v_exp_f32 v141, v141
  v_mfma_f32_32x32x16_bf16 v[104:119], v[96:99], v[72:75], v[168:183]
  v_exp_f32 v142, v142
  v_exp_f32 v143, v143
  v_exp_f32 v144, v144
  v_exp_f32 v145, v145
  v_mfma_f32_32x32x16_bf16 v[120:135], v[100:103], v[72:75], v[168:183]
  v_exp_f32 v146, v146
  v_exp_f32 v147, v147
  v_exp_f32 v148, v148
  ds_read_b128 v[88:91], v7 offset:12288
  ds_read_b128 v[92:95], v7 offset:13312
  v_exp_f32 v149, v149
  v_smfmac_f32_32x32x32_bf16 v[56:71], v[40:43], v[136:143], v6
  v_exp_f32 v150, v150
  v_exp_f32 v151, v151
  v_exp_f32 v152, v152
  v_exp_f32 v153, v153
  s_add_u32 m0, s58, 65536
  s_add_u32 s49, s58, 65536
  buffer_load_dwordx4 v7, s[44:47], s49 offen offset:0 sc1 lds
  buffer_load_dwordx4 v7, s[44:47], s49 offen offset:1024 sc1 lds
  buffer_load_dwordx4 v7, s[44:47], s49 offen offset:2048 sc1 lds
  buffer_load_dwordx4 v7, s[44:47], s49 offen offset:3072 sc1 lds
  v_exp_f32 v154, v154
  v_mfma_f32_32x32x4_2b_bf16 v[104:135], v[84:85], v[76:77], v[104:135]
  v_exp_f32 v155, v155
  v_exp_f32 v156, v156
  v_exp_f32 v157, v157
  v_exp_f32 v158, v158
  v_exp_f32 v159, v159
  v_exp_f32 v160, v160
  v_exp_f32 v161, v161
  s_mov_b64 exec, s[54:55]
  ds_read_b128 v[24:27], v10 offset:10240
  ds_read_b128 v[28:31], v10 offset:10880
  ds_read_b128 v[32:35], v10 offset:11520
  ds_read_b128 v[36:39], v10 offset:12160
  s_mov_b64 exec, -1
  v_exp_f32 v162, v162
  v_smfmac_f32_32x32x32_bf16 v[56:71], v[44:47], v[144:151], v6
  v_exp_f32 v163, v163
  v_exp_f32 v164, v164
  v_exp_f32 v165, v165
  v_smfmac_f32_32x32x32_bf16 v[56:71], v[48:51], v[152:159], v6
  v_exp_f32 v166, v166
  v_exp_f32 v167, v167
  s_setprio 0
  s_waitcnt lgkmcnt(0)
  v_exp_f32 v104, v104
  v_exp_f32 v105, v105
  v_exp_f32 v106, v106
  v_smfmac_f32_32x32x32_bf16 v[56:71], v[52:55], v[160:167], v6
  v_exp_f32 v107, v107
  v_exp_f32 v108, v108
  v_exp_f32 v109, v109
  v_mfma_f32_32x32x16_bf16 v[136:151], v[88:91], v[72:75], v[168:183]
  v_exp_f32 v110, v110
  v_exp_f32 v111, v111
  v_exp_f32 v112, v112
  v_exp_f32 v113, v113
  v_mfma_f32_32x32x16_bf16 v[152:167], v[92:95], v[72:75], v[168:183]
  v_exp_f32 v114, v114
  v_exp_f32 v115, v115
  v_exp_f32 v116, v116
  s_waitcnt vmcnt(4)
  s_barrier
  ds_read_b128 v[96:99], v7 offset:20480
  ds_read_b128 v[100:103], v7 offset:21504
  ds_read2st64_b64 v[80:83], v13 offset0:48 offset1:49
  v_exp_f32 v117, v117
  v_smfmac_f32_32x32x32_bf16 v[56:71], v[24:27], v[104:111], v6
  v_exp_f32 v118, v118
  v_exp_f32 v119, v119
  v_exp_f32 v120, v120
  v_exp_f32 v121, v121
  buffer_load_ushort v216, v242, s[36:39], s12 offen offset:0
  buffer_load_ushort v217, v242, s[36:39], s12 offen offset:1280
  buffer_load_ushort v218, v242, s[36:39], s12 offen offset:2560
  buffer_load_ushort v219, v242, s[36:39], s12 offen offset:3840
  buffer_load_ushort v220, v242, s[36:39], s13 offen offset:0
L_pad4:
  s_cbranch_execz L_pad6
  buffer_load_ushort v221, v242, s[36:39], s13 offen offset:1280
  buffer_load_ushort v222, v242, s[36:39], s13 offen offset:2560
  buffer_load_ushort v223, v242, s[36:39], s13 offen offset:3840
  v_exp_f32 v122, v122
  v_mfma_f32_32x32x4_2b_bf16 v[136:167], v[86:87], v[76:77], v[136:167]
  v_exp_f32 v123, v123
  v_exp_f32 v124, v124
  v_exp_f32 v125, v125
  v_exp_f32 v126, v126
  v_exp_f32 v127, v127
  v_exp_f32 v128, v128
  v_exp_f32 v129, v129
  s_mov_b64 exec, s[54:55]
  ds_read_b128 v[40:43], v10 offset:12800
  ds_read_b128 v[44:47], v10 offset:13440
  ds_read_b128 v[48:51], v10 offset:14080
  ds_read_b128 v[52:55], v10 offset:14720
  s_mov_b64 exec, -1
  v_exp_f32 v130, v130
  v_smfmac_f32_32x32x32_bf16 v[56:71], v[28:31], v[112:119], v6
  v_exp_f32 v131, v131
  v_exp_f32 v132, v132
  v_exp_f32 v133, v133
  v_smfmac_f32_32x32x32_bf16 v[56:71], v[32:35], v[120:127], v6
  v_exp_f32 v134, v134
  v_exp_f32 v135, v135
  s_setprio 3
  s_waitcnt lgkmcnt(0)
  v_exp_f32 v136, v136
  v_exp_f32 v137, v137
  v_exp_f32 v138, v138
  v_smfmac_f32_32x32x32_bf16 v[56:71], v[36:39], v[128:135], v6
  v_exp_f32 v139, v139
  v_exp_f32 v140, v140
  v_exp_f32 v141, v141
  v_mfma_f32_32x32x16_bf16 v[104:119], v[96:99], v[72:75], v[168:183]
  v_exp_f32 v142, v142
  v_exp_f32 v143, v143
  v_exp_f32 v144, v144
  v_exp_f32 v145, v145
  v_mfma_f32_32x32x16_bf16 v[120:135], v[100:103], v[72:75], v[168:183]
  v_exp_f32 v146, v146
  v_exp_f32 v147, v147
  v_exp_f32 v148, v148
  ds_read_b128 v[88:91], v7 offset:22528
  ds_read_b128 v[92:95], v7 offset:23552
  v_exp_f32 v149, v149
  v_smfmac_f32_32x32x32_bf16 v[56:71], v[40:43], v[136:143], v6
  v_exp_f32 v150, v150
  v_exp_f32 v151, v151
  v_exp_f32 v152, v152
  v_exp_f32 v153, v153
  v_exp_f32 v154, v154
  v_mfma_f32_32x32x4_2b_bf16 v[104:135], v[80:81], v[76:77], v[104:135]
  v_exp_f32 v155, v155
  v_exp_f32 v156, v156
  v_exp_f32 v157, v157
  v_exp_f32 v158, v158
  v_exp_f32 v159, v159
  v_exp_f32 v160, v160
  v_exp_f32 v161, v161
  s_mov_b64 exec, s[54:55]
  ds_read_b128 v[24:27], v10 offset:20480
  ds_read_b128 v[28:31], v10 offset:21120
  ds_read_b128 v[32:35], v10 offset:21760
  ds_read_b128 v[36:39], v10 offset:22400
  s_mov_b64 exec, -1
  v_exp_f32 v162, v162
  v_smfmac_f32_32x32x32_bf16 v[56:71], v[44:47], v[144:151], v6
  v_exp_f32 v163, v163
  v_exp_f32 v164, v164
  v_exp_f32 v165, v165
  v_smfmac_f32_32x32x32_bf16 v[56:71], v[48:51], v[152:159], v6
  v_exp_f32 v166, v166
  v_exp_f32 v167, v167
  s_waitcnt lgkmcnt(0)
  v_exp_f32 v104, v104
  v_exp_f32 v105, v105
  v_exp_f32 v106, v106
  v_smfmac_f32_32x32x32_bf16 v[56:71], v[52:55], v[160:167], v6
  v_exp_f32 v107, v107
  v_exp_f32 v108, v108
  v_exp_f32 v109, v109
  v_mfma_f32_32x32x16_bf16 v[136:151], v[88:91], v[72:75], v[168:183]
  v_exp_f32 v110, v110
  v_exp_f32 v111, v111
  v_exp_f32 v112, v112
  v_exp_f32 v113, v113
  v_mfma_f32_32x32x16_bf16 v[152:167], v[92:95], v[72:75], v[168:183]
  v_exp_f32 v114, v114
  v_exp_f32 v115, v115
  v_exp_f32 v116, v116
  ds_read_b128 v[96:99], v7 offset:30720
  ds_read_b128 v[100:103], v7 offset:31744
  ds_read2st64_b64 v[84:87], v13 offset0:68 offset1:69
  v_exp_f32 v117, v117
  v_smfmac_f32_32x32x32_bf16 v[56:71], v[24:27], v[104:111], v6
  v_exp_f32 v118, v118
  v_exp_f32 v119, v119
  v_exp_f32 v120, v120
  v_exp_f32 v121, v121
  s_add_u32 m0, s58, 98304
  s_add_u32 s49, s58, 98304
  buffer_load_dwordx4 v7, s[44:47], s49 offen offset:0 sc1 lds
  buffer_load_dwordx4 v7, s[44:47], s49 offen offset:1024 sc1 lds
  buffer_load_dwordx4 v7, s[44:47], s49 offen offset:2048 sc1 lds
  buffer_load_dwordx4 v7, s[44:47], s49 offen offset:3072 sc1 lds
  v_exp_f32 v122, v122
  v_mfma_f32_32x32x4_2b_bf16 v[136:167], v[82:83], v[76:77], v[136:167]
  v_exp_f32 v123, v123
  v_exp_f32 v124, v124
  v_exp_f32 v125, v125
  v_exp_f32 v126, v126
  v_exp_f32 v127, v127
  v_exp_f32 v128, v128
  v_exp_f32 v129, v129
  s_mov_b64 exec, s[54:55]
  ds_read_b128 v[40:43], v10 offset:23040
  ds_read_b128 v[44:47], v10 offset:23680
  ds_read_b128 v[48:51], v10 offset:24320
  ds_read_b128 v[52:55], v10 offset:24960
  s_mov_b64 exec, -1
  v_exp_f32 v130, v130
  v_smfmac_f32_32x32x32_bf16 v[56:71], v[28:31], v[112:119], v6
  v_exp_f32 v131, v131
  v_exp_f32 v132, v132
  v_exp_f32 v133, v133
  v_smfmac_f32_32x32x32_bf16 v[56:71], v[32:35], v[120:127], v6
  v_exp_f32 v134, v134
  v_exp_f32 v135, v135
  s_waitcnt lgkmcnt(0)
  v_exp_f32 v136, v136
  v_exp_f32 v137, v137
  v_exp_f32 v138, v138
  v_smfmac_f32_32x32x32_bf16 v[56:71], v[36:39], v[128:135], v6
  v_exp_f32 v139, v139
  v_exp_f32 v140, v140
  v_exp_f32 v141, v141
  v_mfma_f32_32x32x16_bf16 v[104:119], v[96:99], v[72:75], v[168:183]
  v_exp_f32 v142, v142
  v_exp_f32 v143, v143
  v_exp_f32 v144, v144
  v_exp_f32 v145, v145
  v_mfma_f32_32x32x16_bf16 v[120:135], v[100:103], v[72:75], v[168:183]
  v_exp_f32 v146, v146
  v_exp_f32 v147, v147
  v_exp_f32 v148, v148
  ds_read_b128 v[88:91], v7 offset:32768
  ds_read_b128 v[92:95], v7 offset:33792
  v_exp_f32 v149, v149
  v_smfmac_f32_32x32x32_bf16 v[56:71], v[40:43], v[136:143], v6
  v_exp_f32 v150, v150
  v_exp_f32 v151, v151
  v_exp_f32 v152, v152
  v_exp_f32 v153, v153
  s_add_u32 m0, s58, 131072
  s_add_u32 s49, s58, 131072
  buffer_load_dwordx4 v7, s[44:47], s49 offen offset:0 sc1 lds
  buffer_load_dwordx4 v7, s[44:47], s49 offen offset:1024 sc1 lds
  buffer_load_dwordx4 v7, s[44:47], s49 offen offset:2048 sc1 lds
  buffer_load_dwordx4 v7, s[44:47], s49 offen offset:3072 sc1 lds
  v_exp_f32 v154, v154
  v_mfma_f32_32x32x4_2b_bf16 v[104:135], v[84:85], v[76:77], v[104:135]
  v_exp_f32 v155, v155
  v_exp_f32 v156, v156
  v_exp_f32 v157, v157
  v_exp_f32 v158, v158
  v_exp_f32 v159, v159
  v_exp_f32 v160, v160
  v_exp_f32 v161, v161
  s_mov_b64 exec, s[54:55]
  ds_read_b128 v[24:27], v10 offset:30720
  ds_read_b128 v[28:31], v10 offset:31360
  ds_read_b128 v[32:35], v10 offset:32000
  ds_read_b128 v[36:39], v10 offset:32640
  s_mov_b64 exec, -1
  v_exp_f32 v162, v162
  v_smfmac_f32_32x32x32_bf16 v[56:71], v[44:47], v[144:151], v6
  v_exp_f32 v163, v163
  v_exp_f32 v164, v164
  v_exp_f32 v165, v165
  v_smfmac_f32_32x32x32_bf16 v[56:71], v[48:51], v[152:159], v6
  v_exp_f32 v166, v166
  v_exp_f32 v167, v167
  s_waitcnt lgkmcnt(0)
  v_exp_f32 v104, v104
  v_exp_f32 v105, v105
  v_exp_f32 v106, v106
  v_smfmac_f32_32x32x32_bf16 v[56:71], v[52:55], v[160:167], v6
  v_exp_f32 v107, v107
  v_exp_f32 v108, v108
  v_exp_f32 v109, v109
  v_mfma_f32_32x32x16_bf16 v[136:151], v[88:91], v[72:75], v[168:183]
  v_exp_f32 v110, v110
  v_exp_f32 v111, v111
  v_exp_f32 v112, v112
  v_exp_f32 v113, v113
  v_mfma_f32_32x32x16_bf16 v[152:167], v[92:95], v[72:75], v[168:183]
  v_exp_f32 v114, v114
  v_exp_f32 v115, v115
  v_exp_f32 v116, v116
  ds_read_b128 v[96:99], v7 offset:40960
  ds_read_b128 v[100:103], v7 offset:41984
  ds_read2st64_b64 v[80:83], v13 offset0:88 offset1:89
  v_exp_f32 v117, v117
  v_smfmac_f32_32x32x32_bf16 v[56:71], v[24:27], v[104:111], v6
  v_exp_f32 v118, v118
  v_exp_f32 v119, v119
  v_exp_f32 v120, v120
  v_exp_f32 v121, v121
  v_exp_f32 v122, v122
  v_mfma_f32_32x32x4_2b_bf16 v[136:167], v[86:87], v[76:77], v[136:167]
  v_exp_f32 v123, v123
  v_exp_f32 v124, v124
  v_exp_f32 v125, v125
  v_exp_f32 v126, v126
  v_exp_f32 v127, v127
  v_exp_f32 v128, v128
  v_exp_f32 v129, v129
  s_mov_b64 exec, s[54:55]
  ds_read_b128 v[40:43], v10 offset:33280
  ds_read_b128 v[44:47], v10 offset:33920
  ds_read_b128 v[48:51], v10 offset:34560
  ds_read_b128 v[52:55], v10 offset:35200
  s_mov_b64 exec, -1
  v_exp_f32 v130, v130
  v_frexp_exp_i32_f32 v78, v68
  v_sub_u32 v78, -75, v78
  v_max_i32 v78, 0xffffff88, v78
  v_cvt_f32_i32 v79, v78
  v_ldexp_f32 v78, 1.0, v78
  v_pk_add_f32 v[168:169], v[168:169], v[78:79] op_sel:[0,1] op_sel_hi:[1,1]
  v_pk_add_f32 v[170:171], v[170:171], v[78:79] op_sel:[0,1] op_sel_hi:[1,1]
  v_pk_add_f32 v[172:173], v[172:173], v[78:79] op_sel:[0,1] op_sel_hi:[1,1]
  v_pk_add_f32 v[174:175], v[174:175], v[78:79] op_sel:[0,1] op_sel_hi:[1,1]
  v_pk_add_f32 v[176:177], v[176:177], v[78:79] op_sel:[0,1] op_sel_hi:[1,1]
  v_pk_add_f32 v[178:179], v[178:179], v[78:79] op_sel:[0,1] op_sel_hi:[1,1]
  v_pk_add_f32 v[180:181], v[180:181], v[78:79] op_sel:[0,1] op_sel_hi:[1,1]
  v_pk_add_f32 v[182:183], v[182:183], v[78:79] op_sel:[0,1] op_sel_hi:[1,1]
  v_smfmac_f32_32x32x32_bf16 v[56:71], v[28:31], v[112:119], v6
  v_exp_f32 v131, v131
  v_exp_f32 v132, v132
  v_exp_f32 v133, v133
  v_smfmac_f32_32x32x32_bf16 v[56:71], v[32:35], v[120:127], v6
  v_exp_f32 v134, v134
  v_exp_f32 v135, v135
  s_setprio 2
  s_waitcnt lgkmcnt(0)
  v_exp_f32 v136, v136
  v_exp_f32 v137, v137
  v_exp_f32 v138, v138
  v_smfmac_f32_32x32x32_bf16 v[56:71], v[36:39], v[128:135], v6
  v_exp_f32 v139, v139
  v_exp_f32 v140, v140
  v_exp_f32 v141, v141
  v_mfma_f32_32x32x16_bf16 v[104:119], v[96:99], v[72:75], v[168:183]
  v_exp_f32 v142, v142
  v_exp_f32 v143, v143
  v_exp_f32 v144, v144
  v_exp_f32 v145, v145
  v_mfma_f32_32x32x16_bf16 v[120:135], v[100:103], v[72:75], v[168:183]
  v_exp_f32 v146, v146
  v_exp_f32 v147, v147
  v_exp_f32 v148, v148
  ds_read_b128 v[88:91], v7 offset:43008
  ds_read_b128 v[92:95], v7 offset:44032
  v_exp_f32 v149, v149
  v_smfmac_f32_32x32x32_bf16 v[56:71], v[40:43], v[136:143], v6
  v_exp_f32 v150, v150
  v_exp_f32 v151, v151
  v_exp_f32 v152, v152
  v_exp_f32 v153, v153
  s_waitcnt vmcnt(8)
  v_lshl_or_b32 v224, v217, 16, v216
  v_lshl_or_b32 v225, v219, 16, v218
  v_lshl_or_b32 v226, v221, 16, v220
  v_lshl_or_b32 v227, v223, 16, v222
  buffer_store_dwordx4 v[224:227], v7, s[44:47], s14 offen sc1
  v_exp_f32 v154, v154
  v_mfma_f32_32x32x4_2b_bf16 v[104:135], v[80:81], v[76:77], v[104:135]
  v_exp_f32 v155, v155
  v_exp_f32 v156, v156
  v_exp_f32 v157, v157
  v_exp_f32 v158, v158
  v_exp_f32 v159, v159
  v_exp_f32 v160, v160
  v_exp_f32 v161, v161
  s_mov_b64 exec, s[54:55]
  ds_read_b128 v[24:27], v10 offset:40960
  ds_read_b128 v[28:31], v10 offset:41600
  ds_read_b128 v[32:35], v10 offset:42240
  ds_read_b128 v[36:39], v10 offset:42880
  s_mov_b64 exec, -1
  v_exp_f32 v162, v162
  v_smfmac_f32_32x32x32_bf16 v[56:71], v[44:47], v[144:151], v6
  v_exp_f32 v163, v163
  v_exp_f32 v164, v164
  v_exp_f32 v165, v165
  v_smfmac_f32_32x32x32_bf16 v[56:71], v[48:51], v[152:159], v6
  v_exp_f32 v166, v166
  v_exp_f32 v167, v167
  s_setprio 1
  s_waitcnt lgkmcnt(0)
  v_exp_f32 v104, v104
  v_exp_f32 v105, v105
  v_exp_f32 v106, v106
  v_smfmac_f32_32x32x32_bf16 v[56:71], v[52:55], v[160:167], v6
  v_exp_f32 v107, v107
  v_exp_f32 v108, v108
  v_exp_f32 v109, v109
  v_mfma_f32_32x32x16_bf16 v[136:151], v[88:91], v[72:75], v[168:183]
  v_exp_f32 v110, v110
  v_exp_f32 v111, v111
  v_exp_f32 v112, v112
  v_exp_f32 v113, v113
  v_mfma_f32_32x32x16_bf16 v[152:167], v[92:95], v[72:75], v[168:183]
  v_exp_f32 v114, v114
  v_exp_f32 v115, v115
  v_exp_f32 v116, v116
  ds_read_b128 v[96:99], v7 offset:51200
  ds_read_b128 v[100:103], v7 offset:52224
  ds_read2st64_b64 v[84:87], v13 offset0:108 offset1:109
  v_exp_f32 v117, v117
  v_exp_f32 v118, v118
  v_exp_f32 v119, v119
  v_pk_mul_f32 v[56:57], v[56:57], v[78:79] op_sel_hi:[1,0]
  v_pk_mul_f32 v[58:59], v[58:59], v[78:79] op_sel_hi:[1,0]
  v_pk_mul_f32 v[60:61], v[60:61], v[78:79] op_sel_hi:[1,0]
  v_pk_mul_f32 v[62:63], v[62:63], v[78:79] op_sel_hi:[1,0]
  v_pk_mul_f32 v[64:65], v[64:65], v[78:79] op_sel_hi:[1,0]
  v_pk_mul_f32 v[66:67], v[66:67], v[78:79] op_sel_hi:[1,0]
  v_pk_mul_f32 v[68:69], v[68:69], v[78:79] op_sel_hi:[1,0]
  v_exp_f32 v120, v120
  v_exp_f32 v121, v121
  v_lshlrev_b32 v2, 7, v1
  s_mov_b64 exec, 0xff
  buffer_load_dword v0, v2, s[44:47], s66 offen sc1
  s_mov_b64 exec, 3
  buffer_load_dword v0, v2, s[44:47], s67 offen sc1
  s_mov_b64 exec, -1
  v_smfmac_f32_32x32x32_bf16 v[56:71], v[24:27], v[104:111], v6
  v_exp_f32 v122, v122
  v_mfma_f32_32x32x4_2b_bf16 v[136:167], v[82:83], v[76:77], v[136:167]
  v_exp_f32 v123, v123
  v_exp_f32 v124, v124
  v_exp_f32 v125, v125
  v_exp_f32 v126, v126
  v_exp_f32 v127, v127
  v_exp_f32 v128, v128
  v_exp_f32 v129, v129
  s_mov_b64 exec, s[54:55]
  ds_read_b128 v[40:43], v10 offset:43520
  ds_read_b128 v[44:47], v10 offset:44160
  ds_read_b128 v[48:51], v10 offset:44800
  ds_read_b128 v[52:55], v10 offset:45440
  s_mov_b64 exec, -1
  v_exp_f32 v130, v130
  v_smfmac_f32_32x32x32_bf16 v[56:71], v[28:31], v[112:119], v6
  v_exp_f32 v131, v131
  v_exp_f32 v132, v132
  v_exp_f32 v133, v133
  v_smfmac_f32_32x32x32_bf16 v[56:71], v[32:35], v[120:127], v6
  v_exp_f32 v134, v134
  v_exp_f32 v135, v135
  s_setprio 0
  s_waitcnt lgkmcnt(0)
  v_exp_f32 v136, v136
  v_exp_f32 v137, v137
  v_exp_f32 v138, v138
  v_smfmac_f32_32x32x32_bf16 v[56:71], v[36:39], v[128:135], v6
  v_exp_f32 v139, v139
  v_exp_f32 v140, v140
  v_exp_f32 v141, v141
  v_mfma_f32_32x32x16_bf16 v[104:119], v[96:99], v[72:75], v[168:183]
  v_exp_f32 v142, v142
  v_exp_f32 v143, v143
  v_exp_f32 v144, v144
  v_exp_f32 v145, v145
  v_mfma_f32_32x32x16_bf16 v[120:135], v[100:103], v[72:75], v[168:183]
  v_exp_f32 v146, v146
  v_exp_f32 v147, v147
  v_exp_f32 v148, v148
  s_waitcnt vmcnt(2)
  s_barrier
  ds_read_b128 v[88:91], v7 offset:53248
  ds_read_b128 v[92:95], v7 offset:54272
  v_exp_f32 v149, v149
  v_smfmac_f32_32x32x32_bf16 v[56:71], v[40:43], v[136:143], v6
  v_exp_f32 v150, v150
  v_exp_f32 v151, v151
  v_exp_f32 v152, v152
  v_exp_f32 v153, v153
  v_exp_f32 v154, v154
  v_mfma_f32_32x32x4_2b_bf16 v[104:135], v[84:85], v[76:77], v[104:135]
  v_exp_f32 v155, v155
  v_exp_f32 v156, v156
  v_exp_f32 v157, v157
  v_exp_f32 v158, v158
  v_exp_f32 v159, v159
  v_exp_f32 v160, v160
  v_exp_f32 v161, v161
  s_mov_b64 exec, s[54:55]
  ds_read_b128 v[24:27], v10 offset:51200
  ds_read_b128 v[28:31], v10 offset:51840
  ds_read_b128 v[32:35], v10 offset:52480
  ds_read_b128 v[36:39], v10 offset:53120
  s_mov_b64 exec, -1
  v_exp_f32 v162, v162
  v_smfmac_f32_32x32x32_bf16 v[56:71], v[44:47], v[144:151], v6
  v_exp_f32 v163, v163
  v_exp_f32 v164, v164
  v_exp_f32 v165, v165
  v_smfmac_f32_32x32x32_bf16 v[56:71], v[48:51], v[152:159], v6
  v_exp_f32 v166, v166
  v_exp_f32 v167, v167
  s_setprio 3
  s_waitcnt lgkmcnt(0)
  v_exp_f32 v104, v104
  v_exp_f32 v105, v105
  v_exp_f32 v106, v106
  v_smfmac_f32_32x32x32_bf16 v[56:71], v[52:55], v[160:167], v6
  v_exp_f32 v107, v107
  v_exp_f32 v108, v108
  v_exp_f32 v109, v109
  v_mfma_f32_32x32x16_bf16 v[136:151], v[88:91], v[72:75], v[168:183]
  v_exp_f32 v110, v110
  v_exp_f32 v111, v111
  v_exp_f32 v112, v112
  v_exp_f32 v113, v113
  v_mfma_f32_32x32x16_bf16 v[152:167], v[92:95], v[72:75], v[168:183]
  v_exp_f32 v114, v114
  v_exp_f32 v115, v115
  v_exp_f32 v116, v116
  ds_read_b128 v[96:99], v8 offset:0
  ds_read_b128 v[100:103], v8 offset:1024
  ds_read2st64_b64 v[80:83], v13 offset0:128 offset1:129
  v_exp_f32 v117, v117
  v_smfmac_f32_32x32x32_bf16 v[56:71], v[24:27], v[104:111], v6
  v_exp_f32 v118, v118
  v_exp_f32 v119, v119
  v_exp_f32 v120, v120
  v_exp_f32 v121, v121
  v_exp_f32 v122, v122
  v_mfma_f32_32x32x4_2b_bf16 v[136:167], v[86:87], v[76:77], v[136:167]
  v_exp_f32 v123, v123
  v_exp_f32 v124, v124
  v_exp_f32 v125, v125
  v_exp_f32 v126, v126
  v_exp_f32 v127, v127
  v_exp_f32 v128, v128
  v_exp_f32 v129, v129
  s_mov_b64 exec, s[54:55]
  ds_read_b128 v[40:43], v10 offset:53760
  ds_read_b128 v[44:47], v10 offset:54400
  ds_read_b128 v[48:51], v10 offset:55040
  ds_read_b128 v[52:55], v10 offset:55680
  s_mov_b64 exec, -1
  v_exp_f32 v130, v130
  v_smfmac_f32_32x32x32_bf16 v[56:71], v[28:31], v[112:119], v6
  v_exp_f32 v131, v131
  v_exp_f32 v132, v132
  v_exp_f32 v133, v133
  v_smfmac_f32_32x32x32_bf16 v[56:71], v[32:35], v[120:127], v6
  v_exp_f32 v134, v134
  v_exp_f32 v135, v135
  s_waitcnt lgkmcnt(0)
  v_exp_f32 v136, v136
  v_exp_f32 v137, v137
  v_exp_f32 v138, v138
  v_smfmac_f32_32x32x32_bf16 v[56:71], v[36:39], v[128:135], v6
  v_exp_f32 v139, v139
  v_exp_f32 v140, v140
  v_exp_f32 v141, v141
  v_mfma_f32_32x32x16_bf16 v[104:119], v[96:99], v[72:75], v[168:183]
  v_exp_f32 v142, v142
  v_exp_f32 v143, v143
  v_exp_f32 v144, v144
  v_exp_f32 v145, v145
  v_mfma_f32_32x32x16_bf16 v[120:135], v[100:103], v[72:75], v[168:183]
  v_exp_f32 v146, v146
  v_exp_f32 v147, v147
  v_exp_f32 v148, v148
  ds_read_b128 v[88:91], v8 offset:2048
  ds_read_b128 v[92:95], v8 offset:3072
  v_exp_f32 v149, v149
  v_smfmac_f32_32x32x32_bf16 v[56:71], v[40:43], v[136:143], v6
  v_exp_f32 v150, v150
  v_exp_f32 v151, v151
  v_exp_f32 v152, v152
  v_exp_f32 v153, v153
  v_exp_f32 v154, v154
  v_mfma_f32_32x32x4_2b_bf16 v[104:135], v[80:81], v[76:77], v[104:135]
  v_exp_f32 v155, v155
  v_exp_f32 v156, v156
  v_exp_f32 v157, v157
  v_exp_f32 v158, v158
  v_exp_f32 v159, v159
  v_exp_f32 v160, v160
  v_exp_f32 v161, v161
  s_mov_b64 exec, s[54:55]
  ds_read_b128 v[24:27], v11 offset:0
  ds_read_b128 v[28:31], v11 offset:640
  ds_read_b128 v[32:35], v11 offset:1280
  ds_read_b128 v[36:39], v11 offset:1920
  s_mov_b64 exec, -1
  v_exp_f32 v162, v162
  v_smfmac_f32_32x32x32_bf16 v[56:71], v[44:47], v[144:151], v6
  v_exp_f32 v163, v163
  v_exp_f32 v164, v164
  v_exp_f32 v165, v165
  v_smfmac_f32_32x32x32_bf16 v[56:71], v[48:51], v[152:159], v6
  v_exp_f32 v166, v166
  v_exp_f32 v167, v167
  s_waitcnt lgkmcnt(0)
  v_exp_f32 v104, v104
  v_exp_f32 v105, v105
  v_exp_f32 v106, v106
  v_smfmac_f32_32x32x32_bf16 v[56:71], v[52:55], v[160:167], v6
  v_exp_f32 v107, v107
  v_exp_f32 v108, v108
  v_exp_f32 v109, v109
  v_mfma_f32_32x32x16_bf16 v[136:151], v[88:91], v[72:75], v[168:183]
  v_exp_f32 v110, v110
  v_exp_f32 v111, v111
  v_exp_f32 v112, v112
  v_exp_f32 v113, v113
  v_mfma_f32_32x32x16_bf16 v[152:167], v[92:95], v[72:75], v[168:183]
  v_exp_f32 v114, v114
  v_exp_f32 v115, v115
  v_exp_f32 v116, v116
  ds_read_b128 v[96:99], v8 offset:10240
  ds_read_b128 v[100:103], v8 offset:11264
  ds_read2st64_b64 v[84:87], v13 offset0:148 offset1:149
  v_exp_f32 v117, v117
  v_smfmac_f32_32x32x32_bf16 v[56:71], v[24:27], v[104:111], v6
  v_exp_f32 v118, v118
  v_exp_f32 v119, v119
  v_exp_f32 v120, v120
  v_exp_f32 v121, v121
  v_exp_f32 v122, v122
  v_mfma_f32_32x32x4_2b_bf16 v[136:167], v[82:83], v[76:77], v[136:167]
  v_exp_f32 v123, v123
  v_exp_f32 v124, v124
  v_exp_f32 v125, v125
  v_exp_f32 v126, v126
  v_exp_f32 v127, v127
  v_exp_f32 v128, v128
  v_exp_f32 v129, v129
  s_mov_b64 exec, s[54:55]
  ds_read_b128 v[40:43], v11 offset:2560
  ds_read_b128 v[44:47], v11 offset:3200
  ds_read_b128 v[48:51], v11 offset:3840
  ds_read_b128 v[52:55], v11 offset:4480
  s_mov_b64 exec, -1
  v_exp_f32 v130, v130
  v_smfmac_f32_32x32x32_bf16 v[56:71], v[28:31], v[112:119], v6
  v_exp_f32 v131, v131
  v_exp_f32 v132, v132
  v_exp_f32 v133, v133
  v_smfmac_f32_32x32x32_bf16 v[56:71], v[32:35], v[120:127], v6
  v_exp_f32 v134, v134
  v_exp_f32 v135, v135
  s_waitcnt lgkmcnt(0)
  v_exp_f32 v136, v136
  v_exp_f32 v137, v137
  v_exp_f32 v138, v138
  v_smfmac_f32_32x32x32_bf16 v[56:71], v[36:39], v[128:135], v6
  v_exp_f32 v139, v139
  v_exp_f32 v140, v140
  v_exp_f32 v141, v141
  v_mfma_f32_32x32x16_bf16 v[104:119], v[96:99], v[72:75], v[168:183]
  v_exp_f32 v142, v142
  v_exp_f32 v143, v143
  v_exp_f32 v144, v144
  v_exp_f32 v145, v145
  v_mfma_f32_32x32x16_bf16 v[120:135], v[100:103], v[72:75], v[168:183]
  v_exp_f32 v146, v146
  v_exp_f32 v147, v147
  v_exp_f32 v148, v148
  ds_read_b128 v[88:91], v8 offset:12288
  ds_read_b128 v[92:95], v8 offset:13312
  v_exp_f32 v149, v149
  v_smfmac_f32_32x32x32_bf16 v[56:71], v[40:43], v[136:143], v6
  v_exp_f32 v150, v150
  v_exp_f32 v151, v151
  v_exp_f32 v152, v152
  v_exp_f32 v153, v153
  v_exp_f32 v154, v154
  v_mfma_f32_32x32x4_2b_bf16 v[104:135], v[84:85], v[76:77], v[104:135]
  v_exp_f32 v155, v155
  v_exp_f32 v156, v156
  v_exp_f32 v157, v157
  v_exp_f32 v158, v158
  v_exp_f32 v159, v159
  v_exp_f32 v160, v160
  v_exp_f32 v161, v161
  s_mov_b64 exec, s[54:55]
  ds_read_b128 v[24:27], v11 offset:10240
  ds_read_b128 v[28:31], v11 offset:10880
  ds_read_b128 v[32:35], v11 offset:11520
  ds_read_b128 v[36:39], v11 offset:12160
  s_mov_b64 exec, -1
  v_exp_f32 v162, v162
  v_smfmac_f32_32x32x32_bf16 v[56:71], v[44:47], v[144:151], v6
  v_exp_f32 v163, v163
  v_exp_f32 v164, v164
  v_exp_f32 v165, v165
  v_smfmac_f32_32x32x32_bf16 v[56:71], v[48:51], v[152:159], v6
  v_exp_f32 v166, v166
  v_exp_f32 v167, v167
  s_setprio 2
  s_waitcnt lgkmcnt(0)
  v_exp_f32 v104, v104
  v_exp_f32 v105, v105
  v_exp_f32 v106, v106
  v_smfmac_f32_32x32x32_bf16 v[56:71], v[52:55], v[160:167], v6
  v_exp_f32 v107, v107
  v_exp_f32 v108, v108
  v_exp_f32 v109, v109
  v_mfma_f32_32x32x16_bf16 v[136:151], v[88:91], v[72:75], v[168:183]
  v_exp_f32 v110, v110
  v_exp_f32 v111, v111
  v_exp_f32 v112, v112
  v_exp_f32 v113, v113
  v_mfma_f32_32x32x16_bf16 v[152:167], v[92:95], v[72:75], v[168:183]
  v_exp_f32 v114, v114
  v_exp_f32 v115, v115
  v_exp_f32 v116, v116
  ds_read_b128 v[96:99], v8 offset:20480
  ds_read_b128 v[100:103], v8 offset:21504
  ds_read2st64_b64 v[80:83], v14 offset0:8 offset1:9
  v_exp_f32 v117, v117
  v_smfmac_f32_32x32x32_bf16 v[56:71], v[24:27], v[104:111], v6
  v_exp_f32 v118, v118
  v_exp_f32 v119, v119
  v_exp_f32 v120, v120
  v_exp_f32 v121, v121
  v_exp_f32 v122, v122
  v_mfma_f32_32x32x4_2b_bf16 v[136:167], v[86:87], v[76:77], v[136:167]
  v_exp_f32 v123, v123
  v_exp_f32 v124, v124
  v_exp_f32 v125, v125
  v_exp_f32 v126, v126
  v_exp_f32 v127, v127
  v_exp_f32 v128, v128
  v_exp_f32 v129, v129
  s_mov_b64 exec, s[54:55]
  ds_read_b128 v[40:43], v11 offset:12800
  ds_read_b128 v[44:47], v11 offset:13440
  ds_read_b128 v[48:51], v11 offset:14080
  ds_read_b128 v[52:55], v11 offset:14720
  s_mov_b64 exec, -1
  v_exp_f32 v130, v130
  v_smfmac_f32_32x32x32_bf16 v[56:71], v[28:31], v[112:119], v6
  v_exp_f32 v131, v131
  v_exp_f32 v132, v132
  v_exp_f32 v133, v133
  v_smfmac_f32_32x32x32_bf16 v[56:71], v[32:35], v[120:127], v6
  v_exp_f32 v134, v134
  v_exp_f32 v135, v135
  s_waitcnt lgkmcnt(0)
  v_exp_f32 v136, v136
  v_exp_f32 v137, v137
  v_exp_f32 v138, v138
  v_smfmac_f32_32x32x32_bf16 v[56:71], v[36:39], v[128:135], v6
  v_exp_f32 v139, v139
  v_exp_f32 v140, v140
  v_exp_f32 v141, v141
  v_mfma_f32_32x32x16_bf16 v[104:119], v[96:99], v[72:75], v[168:183]
  v_exp_f32 v142, v142
  v_exp_f32 v143, v143
  v_exp_f32 v144, v144
  v_exp_f32 v145, v145
  v_mfma_f32_32x32x16_bf16 v[120:135], v[100:103], v[72:75], v[168:183]
  v_exp_f32 v146, v146
  v_exp_f32 v147, v147
  v_exp_f32 v148, v148
  ds_read_b128 v[88:91], v8 offset:22528
  ds_read_b128 v[92:95], v8 offset:23552
  v_exp_f32 v149, v149
  v_smfmac_f32_32x32x32_bf16 v[56:71], v[40:43], v[136:143], v6
  v_exp_f32 v150, v150
  v_exp_f32 v151, v151
  v_exp_f32 v152, v152
  v_exp_f32 v153, v153
  v_exp_f32 v154, v154
  v_mfma_f32_32x32x4_2b_bf16 v[104:135], v[80:81], v[76:77], v[104:135]
  v_exp_f32 v155, v155
  v_exp_f32 v156, v156
  v_exp_f32 v157, v157
  v_exp_f32 v158, v158
  v_exp_f32 v159, v159
  v_exp_f32 v160, v160
  v_exp_f32 v161, v161
  s_mov_b64 exec, s[54:55]
  ds_read_b128 v[24:27], v11 offset:20480
  ds_read_b128 v[28:31], v11 offset:21120
  ds_read_b128 v[32:35], v11 offset:21760
  ds_read_b128 v[36:39], v11 offset:22400
  s_mov_b64 exec, -1
  v_exp_f32 v162, v162
  v_smfmac_f32_32x32x32_bf16 v[56:71], v[44:47], v[144:151], v6
  v_exp_f32 v163, v163
  v_exp_f32 v164, v164
  v_exp_f32 v165, v165
  v_smfmac_f32_32x32x32_bf16 v[56:71], v[48:51], v[152:159], v6
  v_exp_f32 v166, v166
  v_exp_f32 v167, v167
  s_waitcnt lgkmcnt(0)
  v_exp_f32 v104, v104
  v_exp_f32 v105, v105
  v_exp_f32 v106, v106
  v_smfmac_f32_32x32x32_bf16 v[56:71], v[52:55], v[160:167], v6
  v_exp_f32 v107, v107
  v_exp_f32 v108, v108
  v_exp_f32 v109, v109
  v_mfma_f32_32x32x16_bf16 v[136:151], v[88:91], v[72:75], v[168:183]
  v_exp_f32 v110, v110
  v_exp_f32 v111, v111
  v_exp_f32 v112, v112
  v_exp_f32 v113, v113
  v_mfma_f32_32x32x16_bf16 v[152:167], v[92:95], v[72:75], v[168:183]
  v_exp_f32 v114, v114
  v_exp_f32 v115, v115
  v_exp_f32 v116, v116
  ds_read_b128 v[96:99], v8 offset:30720
  ds_read_b128 v[100:103], v8 offset:31744
  ds_read2st64_b64 v[84:87], v14 offset0:28 offset1:29
  v_exp_f32 v117, v117
  v_smfmac_f32_32x32x32_bf16 v[56:71], v[24:27], v[104:111], v6
  v_exp_f32 v118, v118
  v_exp_f32 v119, v119
  v_exp_f32 v120, v120
  v_exp_f32 v121, v121
  v_exp_f32 v122, v122
  v_mfma_f32_32x32x4_2b_bf16 v[136:167], v[82:83], v[76:77], v[136:167]
  v_exp_f32 v123, v123
  v_exp_f32 v124, v124
  v_exp_f32 v125, v125
  v_exp_f32 v126, v126
  v_exp_f32 v127, v127
  v_exp_f32 v128, v128
  v_exp_f32 v129, v129
  s_mov_b64 exec, s[54:55]
  ds_read_b128 v[40:43], v11 offset:23040
  ds_read_b128 v[44:47], v11 offset:23680
  ds_read_b128 v[48:51], v11 offset:24320
  ds_read_b128 v[52:55], v11 offset:24960
  s_mov_b64 exec, -1
  v_exp_f32 v130, v130
  v_smfmac_f32_32x32x32_bf16 v[56:71], v[28:31], v[112:119], v6
  v_exp_f32 v131, v131
  v_exp_f32 v132, v132
  v_exp_f32 v133, v133
  v_smfmac_f32_32x32x32_bf16 v[56:71], v[32:35], v[120:127], v6
  v_exp_f32 v134, v134
  v_exp_f32 v135, v135
  s_waitcnt lgkmcnt(0)
  v_exp_f32 v136, v136
  v_exp_f32 v137, v137
  v_exp_f32 v138, v138
  v_smfmac_f32_32x32x32_bf16 v[56:71], v[36:39], v[128:135], v6
  v_exp_f32 v139, v139
  v_exp_f32 v140, v140
  v_exp_f32 v141, v141
  v_mfma_f32_32x32x16_bf16 v[104:119], v[96:99], v[72:75], v[168:183]
  v_exp_f32 v142, v142
  v_exp_f32 v143, v143
  v_exp_f32 v144, v144
  v_exp_f32 v145, v145
  v_mfma_f32_32x32x16_bf16 v[120:135], v[100:103], v[72:75], v[168:183]
  v_exp_f32 v146, v146
  v_exp_f32 v147, v147
  v_exp_f32 v148, v148
  ds_read_b128 v[88:91], v8 offset:32768
  ds_read_b128 v[92:95], v8 offset:33792
  v_exp_f32 v149, v149
  v_smfmac_f32_32x32x32_bf16 v[56:71], v[40:43], v[136:143], v6
  v_exp_f32 v150, v150
  v_exp_f32 v151, v151
L_pad5:
  s_cbranch_execz L_pad7
  v_exp_f32 v152, v152
  v_exp_f32 v153, v153
  v_exp_f32 v154, v154
  v_mfma_f32_32x32x4_2b_bf16 v[104:135], v[84:85], v[76:77], v[104:135]
  v_exp_f32 v155, v155
  v_exp_f32 v156, v156
  v_exp_f32 v157, v157
  v_exp_f32 v158, v158
  v_exp_f32 v159, v159
  v_exp_f32 v160, v160
  v_exp_f32 v161, v161
  s_mov_b64 exec, s[54:55]
  ds_read_b128 v[24:27], v11 offset:30720
  ds_read_b128 v[28:31], v11 offset:31360
  ds_read_b128 v[32:35], v11 offset:32000
  ds_read_b128 v[36:39], v11 offset:32640
  s_mov_b64 exec, -1
  v_exp_f32 v162, v162
  v_smfmac_f32_32x32x32_bf16 v[56:71], v[44:47], v[144:151], v6
  v_exp_f32 v163, v163
  v_exp_f32 v164, v164
  v_exp_f32 v165, v165
  v_smfmac_f32_32x32x32_bf16 v[56:71], v[48:51], v[152:159], v6
  v_exp_f32 v166, v166
  v_exp_f32 v167, v167
  s_waitcnt lgkmcnt(0)
  v_exp_f32 v104, v104
  v_exp_f32 v105, v105
  v_exp_f32 v106, v106
  v_smfmac_f32_32x32x32_bf16 v[56:71], v[52:55], v[160:167], v6
  v_exp_f32 v107, v107
  v_exp_f32 v108, v108
  v_exp_f32 v109, v109
  v_mfma_f32_32x32x16_bf16 v[136:151], v[88:91], v[72:75], v[168:183]
  v_exp_f32 v110, v110
  v_exp_f32 v111, v111
  v_exp_f32 v112, v112
  v_exp_f32 v113, v113
  v_mfma_f32_32x32x16_bf16 v[152:167], v[92:95], v[72:75], v[168:183]
  v_exp_f32 v114, v114
  v_exp_f32 v115, v115
  v_exp_f32 v116, v116
  ds_read_b128 v[96:99], v8 offset:40960
  ds_read_b128 v[100:103], v8 offset:41984
  ds_read2st64_b64 v[80:83], v14 offset0:48 offset1:49
  v_exp_f32 v117, v117
  v_smfmac_f32_32x32x32_bf16 v[56:71], v[24:27], v[104:111], v6
  v_exp_f32 v118, v118
  v_exp_f32 v119, v119
  v_exp_f32 v120, v120
  v_exp_f32 v121, v121
  v_lshlrev_b32 v5, 5, v1
  s_mov_b32 s49, 0x35000
  v_and_b32 v5, 0x780, v5
  buffer_load_dword v5, v5, s[44:47], s49 offen sc1
  v_exp_f32 v122, v122
  v_mfma_f32_32x32x4_2b_bf16 v[136:167], v[86:87], v[76:77], v[136:167]
  v_exp_f32 v123, v123
  v_exp_f32 v124, v124
  v_exp_f32 v125, v125
  v_exp_f32 v126, v126
  v_exp_f32 v127, v127
  v_exp_f32 v128, v128
  v_exp_f32 v129, v129
  s_mov_b64 exec, s[54:55]
  ds_read_b128 v[40:43], v11 offset:33280
  ds_read_b128 v[44:47], v11 offset:33920
  ds_read_b128 v[48:51], v11 offset:34560
  ds_read_b128 v[52:55], v11 offset:35200
  s_mov_b64 exec, -1
  v_exp_f32 v130, v130
  v_smfmac_f32_32x32x32_bf16 v[56:71], v[28:31], v[112:119], v6
  v_exp_f32 v131, v131
  v_exp_f32 v132, v132
  v_exp_f32 v133, v133
  v_smfmac_f32_32x32x32_bf16 v[56:71], v[32:35], v[120:127], v6
  v_exp_f32 v134, v134
  v_exp_f32 v135, v135
  s_setprio 1
  s_waitcnt lgkmcnt(0)
  v_exp_f32 v136, v136
  v_exp_f32 v137, v137
  v_exp_f32 v138, v138
  v_smfmac_f32_32x32x32_bf16 v[56:71], v[36:39], v[128:135], v6
  v_exp_f32 v139, v139
  v_exp_f32 v140, v140
  v_exp_f32 v141, v141
  v_mfma_f32_32x32x16_bf16 v[104:119], v[96:99], v[72:75], v[168:183]
  v_exp_f32 v142, v142
  v_exp_f32 v143, v143
  v_exp_f32 v144, v144
  v_exp_f32 v145, v145
  v_mfma_f32_32x32x16_bf16 v[120:135], v[100:103], v[72:75], v[168:183]
  v_exp_f32 v146, v146
  v_exp_f32 v147, v147
  v_exp_f32 v148, v148
  ds_read_b128 v[88:91], v8 offset:43008
  ds_read_b128 v[92:95], v8 offset:44032
  v_exp_f32 v149, v149
  v_smfmac_f32_32x32x32_bf16 v[56:71], v[40:43], v[136:143], v6
  v_exp_f32 v150, v150
  v_exp_f32 v151, v151
  v_exp_f32 v152, v152
  v_exp_f32 v153, v153
  s_waitcnt vmcnt(0)
  v_cmp_gt_u32 vcc, 16, v5
  s_cbranch_vccz L_toko
  s_mov_b32 s53, 0x40000
L_tpo:
  s_sleep 8
  v_lshlrev_b32 v5, 5, v1
  s_mov_b32 s49, 0x35000
  v_and_b32 v5, 0x780, v5
  buffer_load_dword v5, v5, s[44:47], s49 offen sc1
  s_sub_u32 s53, s53, 1
  s_cbranch_scc1 L_tpox
  s_waitcnt vmcnt(0)
  v_cmp_gt_u32 vcc, 16, v5
  s_cbranch_vccnz L_tpo
L_tpox:
L_toko:
  s_and_b32 s49, s48, 0xffffff80
  buffer_load_dword v23, v13, s[44:47], s49 offen sc1
  v_exp_f32 v154, v154
  v_mfma_f32_32x32x4_2b_bf16 v[104:135], v[80:81], v[76:77], v[104:135]
  v_exp_f32 v155, v155
  v_exp_f32 v156, v156
  v_exp_f32 v157, v157
  v_exp_f32 v158, v158
  v_exp_f32 v159, v159
  v_exp_f32 v160, v160
  v_exp_f32 v161, v161
  s_mov_b64 exec, s[54:55]
  ds_read_b128 v[24:27], v11 offset:40960
  ds_read_b128 v[28:31], v11 offset:41600
  ds_read_b128 v[32:35], v11 offset:42240
  ds_read_b128 v[36:39], v11 offset:42880
  s_mov_b64 exec, -1
  v_exp_f32 v162, v162
  v_smfmac_f32_32x32x32_bf16 v[56:71], v[44:47], v[144:151], v6
  v_exp_f32 v163, v163
  v_exp_f32 v164, v164
  v_exp_f32 v165, v165
  v_smfmac_f32_32x32x32_bf16 v[56:71], v[48:51], v[152:159], v6
  v_exp_f32 v166, v166
  v_exp_f32 v167, v167
  s_setprio 0
  s_waitcnt lgkmcnt(0)
  v_exp_f32 v104, v104
  v_exp_f32 v105, v105
  v_exp_f32 v106, v106
  v_smfmac_f32_32x32x32_bf16 v[56:71], v[52:55], v[160:167], v6
  v_exp_f32 v107, v107
  v_exp_f32 v108, v108
  v_exp_f32 v109, v109
  v_mfma_f32_32x32x16_bf16 v[136:151], v[88:91], v[72:75], v[168:183]
  v_exp_f32 v110, v110
  v_exp_f32 v111, v111
  v_exp_f32 v112, v112
  v_exp_f32 v113, v113
  v_mfma_f32_32x32x16_bf16 v[152:167], v[92:95], v[72:75], v[168:183]
  v_exp_f32 v114, v114
  v_exp_f32 v115, v115
  v_exp_f32 v116, v116
  ds_read_b128 v[96:99], v8 offset:51200
  ds_read_b128 v[100:103], v8 offset:52224
  ds_read2st64_b64 v[84:87], v14 offset0:68 offset1:69
  v_exp_f32 v117, v117
  v_smfmac_f32_32x32x32_bf16 v[56:71], v[24:27], v[104:111], v6
  v_exp_f32 v118, v118
  v_exp_f32 v119, v119
  v_exp_f32 v120, v120
  v_exp_f32 v121, v121
  v_mov_b32 v2, 0
  v_mov_b32 v3, s3
  v_lshlrev_b32 v3, 2, v3
  ds_write_b32 v3, v2
  s_lshl2_add_u32 s49, s5, s3
  s_mulk_i32 s49, 6400
  s_add_u32 s49, s49, 0x720000
  v_min_u32 v2, 49, v1
  v_lshlrev_b32 v2, 7, v2
  buffer_load_dword v0, v2, s[44:47], s49 offen sc1
  v_exp_f32 v122, v122
  v_mfma_f32_32x32x4_2b_bf16 v[136:167], v[82:83], v[76:77], v[136:167]
  v_exp_f32 v123, v123
  v_exp_f32 v124, v124
  v_exp_f32 v125, v125
  v_exp_f32 v126, v126
  v_exp_f32 v127, v127
  v_exp_f32 v128, v128
  v_exp_f32 v129, v129
  s_mov_b64 exec, s[54:55]
  ds_read_b128 v[40:43], v11 offset:43520
  ds_read_b128 v[44:47], v11 offset:44160
  ds_read_b128 v[48:51], v11 offset:44800
  ds_read_b128 v[52:55], v11 offset:45440
  s_mov_b64 exec, -1
  v_exp_f32 v130, v130
  v_smfmac_f32_32x32x32_bf16 v[56:71], v[28:31], v[112:119], v6
  v_exp_f32 v131, v131
  v_exp_f32 v132, v132
  v_exp_f32 v133, v133
  v_smfmac_f32_32x32x32_bf16 v[56:71], v[32:35], v[120:127], v6
  v_exp_f32 v134, v134
  v_exp_f32 v135, v135
  s_setprio 3
  s_waitcnt lgkmcnt(0)
  s_barrier
  v_exp_f32 v136, v136
  v_exp_f32 v137, v137
  v_exp_f32 v138, v138
  v_smfmac_f32_32x32x32_bf16 v[56:71], v[36:39], v[128:135], v6
  v_exp_f32 v139, v139
  v_exp_f32 v140, v140
  v_exp_f32 v141, v141
  v_mfma_f32_32x32x16_bf16 v[104:119], v[96:99], v[72:75], v[168:183]
  v_exp_f32 v142, v142
  v_exp_f32 v143, v143
  v_exp_f32 v144, v144
  v_exp_f32 v145, v145
  v_mfma_f32_32x32x16_bf16 v[120:135], v[100:103], v[72:75], v[168:183]
  v_exp_f32 v146, v146
  v_exp_f32 v147, v147
  v_exp_f32 v148, v148
  ds_read_b128 v[88:91], v8 offset:53248
  ds_read_b128 v[92:95], v8 offset:54272
  v_exp_f32 v149, v149
  v_smfmac_f32_32x32x32_bf16 v[56:71], v[40:43], v[136:143], v6
  v_exp_f32 v150, v150
  v_exp_f32 v151, v151
  v_exp_f32 v152, v152
  v_exp_f32 v153, v153
  s_add_u32 m0, s65, 0
  s_add_u32 s49, s64, 0
  buffer_load_dwordx4 v7, s[44:47], s49 offen offset:0 sc1 lds
  buffer_load_dwordx4 v7, s[44:47], s49 offen offset:1024 sc1 lds
  buffer_load_dwordx4 v7, s[44:47], s49 offen offset:2048 sc1 lds
  buffer_load_dwordx4 v7, s[44:47], s49 offen offset:3072 sc1 lds
  v_exp_f32 v154, v154
  v_mfma_f32_32x32x4_2b_bf16 v[104:135], v[84:85], v[76:77], v[104:135]
  v_exp_f32 v155, v155
  v_exp_f32 v156, v156
  v_exp_f32 v157, v157
  v_exp_f32 v158, v158
  v_exp_f32 v159, v159
  v_exp_f32 v160, v160
  v_exp_f32 v161, v161
  s_mov_b64 exec, s[54:55]
  ds_read_b128 v[24:27], v11 offset:51200
  ds_read_b128 v[28:31], v11 offset:51840
  ds_read_b128 v[32:35], v11 offset:52480
  ds_read_b128 v[36:39], v11 offset:53120
  s_mov_b64 exec, -1
  v_exp_f32 v162, v162
  v_smfmac_f32_32x32x32_bf16 v[56:71], v[44:47], v[144:151], v6
  v_exp_f32 v163, v163
  v_exp_f32 v164, v164
  v_exp_f32 v165, v165
  v_smfmac_f32_32x32x32_bf16 v[56:71], v[48:51], v[152:159], v6
  v_exp_f32 v166, v166
  v_exp_f32 v167, v167
  s_waitcnt lgkmcnt(0)
  v_exp_f32 v104, v104
  v_exp_f32 v105, v105
  v_exp_f32 v106, v106
  v_smfmac_f32_32x32x32_bf16 v[56:71], v[52:55], v[160:167], v6
  v_exp_f32 v107, v107
  v_exp_f32 v108, v108
  v_exp_f32 v109, v109
  v_mfma_f32_32x32x16_bf16 v[136:151], v[88:91], v[72:75], v[168:183]
  v_exp_f32 v110, v110
  v_exp_f32 v111, v111
  v_exp_f32 v112, v112
  v_exp_f32 v113, v113
  v_mfma_f32_32x32x16_bf16 v[152:167], v[92:95], v[72:75], v[168:183]
  v_exp_f32 v114, v114
  v_exp_f32 v115, v115
  v_exp_f32 v116, v116
  ds_read_b128 v[96:99], v9 offset:0
  ds_read_b128 v[100:103], v9 offset:1024
  ds_read2st64_b64 v[80:83], v14 offset0:88 offset1:89
  v_exp_f32 v117, v117
  v_smfmac_f32_32x32x32_bf16 v[56:71], v[24:27], v[104:111], v6
  v_exp_f32 v118, v118
  v_exp_f32 v119, v119
  v_exp_f32 v120, v120
  v_exp_f32 v121, v121
  s_add_u32 m0, s65, 4096
  s_add_u32 s49, s64, 4096
  buffer_load_dwordx4 v7, s[44:47], s49 offen offset:0 sc1 lds
  buffer_load_dwordx4 v7, s[44:47], s49 offen offset:1024 sc1 lds
  buffer_load_dwordx4 v7, s[44:47], s49 offen offset:2048 sc1 lds
  buffer_load_dwordx4 v7, s[44:47], s49 offen offset:3072 sc1 lds
  v_exp_f32 v122, v122
  v_mfma_f32_32x32x4_2b_bf16 v[136:167], v[86:87], v[76:77], v[136:167]
  v_exp_f32 v123, v123
  v_exp_f32 v124, v124
  v_exp_f32 v125, v125
  v_exp_f32 v126, v126
  v_exp_f32 v127, v127
  v_exp_f32 v128, v128
  v_exp_f32 v129, v129
  s_mov_b64 exec, s[54:55]
  ds_read_b128 v[40:43], v11 offset:53760
  ds_read_b128 v[44:47], v11 offset:54400
  ds_read_b128 v[48:51], v11 offset:55040
  ds_read_b128 v[52:55], v11 offset:55680
  s_mov_b64 exec, -1
  v_exp_f32 v130, v130
  v_smfmac_f32_32x32x32_bf16 v[56:71], v[28:31], v[112:119], v6
  v_exp_f32 v131, v131
  v_exp_f32 v132, v132
  v_exp_f32 v133, v133
  v_smfmac_f32_32x32x32_bf16 v[56:71], v[32:35], v[120:127], v6
  v_exp_f32 v134, v134
  v_exp_f32 v135, v135
  s_waitcnt lgkmcnt(0)
  v_exp_f32 v136, v136
  v_exp_f32 v137, v137
  v_exp_f32 v138, v138
  v_smfmac_f32_32x32x32_bf16 v[56:71], v[36:39], v[128:135], v6
  v_exp_f32 v139, v139
  v_exp_f32 v140, v140
  v_exp_f32 v141, v141
  v_mfma_f32_32x32x16_bf16 v[104:119], v[96:99], v[72:75], v[168:183]
  v_exp_f32 v142, v142
  v_exp_f32 v143, v143
  v_exp_f32 v144, v144
  v_exp_f32 v145, v145
  v_mfma_f32_32x32x16_bf16 v[120:135], v[100:103], v[72:75], v[168:183]
  v_exp_f32 v146, v146
  v_exp_f32 v147, v147
  v_exp_f32 v148, v148
  ds_read_b128 v[88:91], v9 offset:2048
  ds_read_b128 v[92:95], v9 offset:3072
  v_exp_f32 v149, v149
  v_smfmac_f32_32x32x32_bf16 v[56:71], v[40:43], v[136:143], v6
  v_exp_f32 v150, v150
  v_exp_f32 v151, v151
  v_exp_f32 v152, v152
  v_exp_f32 v153, v153
  s_add_u32 m0, s65, 8192
  s_add_u32 s49, s64, 8192
  buffer_load_dwordx4 v7, s[44:47], s49 offen offset:0 sc1 lds
  buffer_load_dwordx4 v7, s[44:47], s49 offen offset:1024 sc1 lds
  buffer_load_dwordx4 v7, s[44:47], s49 offen offset:2048 sc1 lds
  buffer_load_dwordx4 v7, s[44:47], s49 offen offset:3072 sc1 lds
  v_exp_f32 v154, v154
  v_mfma_f32_32x32x4_2b_bf16 v[104:135], v[80:81], v[76:77], v[104:135]
  v_exp_f32 v155, v155
  v_exp_f32 v156, v156
  v_exp_f32 v157, v157
  v_exp_f32 v158, v158
  v_exp_f32 v159, v159
  v_exp_f32 v160, v160
  v_exp_f32 v161, v161
  s_mov_b64 exec, s[54:55]
  ds_read_b128 v[24:27], v12 offset:0
  ds_read_b128 v[28:31], v12 offset:640
  ds_read_b128 v[32:35], v12 offset:1280
  ds_read_b128 v[36:39], v12 offset:1920
  s_mov_b64 exec, -1
  v_exp_f32 v162, v162
  v_smfmac_f32_32x32x32_bf16 v[56:71], v[44:47], v[144:151], v6
  v_exp_f32 v163, v163
  v_exp_f32 v164, v164
  v_exp_f32 v165, v165
  v_smfmac_f32_32x32x32_bf16 v[56:71], v[48:51], v[152:159], v6
  v_exp_f32 v166, v166
  v_exp_f32 v167, v167
  s_waitcnt lgkmcnt(0)
  v_exp_f32 v104, v104
  v_exp_f32 v105, v105
  v_exp_f32 v106, v106
  v_smfmac_f32_32x32x32_bf16 v[56:71], v[52:55], v[160:167], v6
  v_exp_f32 v107, v107
  v_exp_f32 v108, v108
  v_exp_f32 v109, v109
  v_mfma_f32_32x32x16_bf16 v[136:151], v[88:91], v[72:75], v[168:183]
  v_exp_f32 v110, v110
  v_exp_f32 v111, v111
  v_exp_f32 v112, v112
  v_exp_f32 v113, v113
  v_mfma_f32_32x32x16_bf16 v[152:167], v[92:95], v[72:75], v[168:183]
  v_exp_f32 v114, v114
  v_exp_f32 v115, v115
  v_exp_f32 v116, v116
  ds_read_b128 v[96:99], v9 offset:10240
  ds_read_b128 v[100:103], v9 offset:11264
  ds_read2st64_b64 v[84:87], v14 offset0:108 offset1:109
  v_exp_f32 v117, v117
  v_smfmac_f32_32x32x32_bf16 v[56:71], v[24:27], v[104:111], v6
  v_exp_f32 v118, v118
  v_exp_f32 v119, v119
  v_exp_f32 v120, v120
  v_exp_f32 v121, v121
  s_add_u32 m0, s65, 12288
  s_add_u32 s49, s64, 12288
  buffer_load_dwordx4 v7, s[44:47], s49 offen offset:0 sc1 lds
  buffer_load_dwordx4 v7, s[44:47], s49 offen offset:1024 sc1 lds
  buffer_load_dwordx4 v7, s[44:47], s49 offen offset:2048 sc1 lds
  buffer_load_dwordx4 v7, s[44:47], s49 offen offset:3072 sc1 lds
  v_exp_f32 v122, v122
  v_mfma_f32_32x32x4_2b_bf16 v[136:167], v[82:83], v[76:77], v[136:167]
  v_exp_f32 v123, v123
  v_exp_f32 v124, v124
  v_exp_f32 v125, v125
  v_exp_f32 v126, v126
  v_exp_f32 v127, v127
  v_exp_f32 v128, v128
  v_exp_f32 v129, v129
  s_mov_b64 exec, s[54:55]
  ds_read_b128 v[40:43], v12 offset:2560
  ds_read_b128 v[44:47], v12 offset:3200
  ds_read_b128 v[48:51], v12 offset:3840
  ds_read_b128 v[52:55], v12 offset:4480
  s_mov_b64 exec, -1
  v_exp_f32 v130, v130
  v_smfmac_f32_32x32x32_bf16 v[56:71], v[28:31], v[112:119], v6
  v_exp_f32 v131, v131
  v_exp_f32 v132, v132
  v_exp_f32 v133, v133
  v_smfmac_f32_32x32x32_bf16 v[56:71], v[32:35], v[120:127], v6
  v_exp_f32 v134, v134
  v_exp_f32 v135, v135
  s_waitcnt lgkmcnt(0)
  v_exp_f32 v136, v136
  v_exp_f32 v137, v137
  v_exp_f32 v138, v138
  v_smfmac_f32_32x32x32_bf16 v[56:71], v[36:39], v[128:135], v6
  v_exp_f32 v139, v139
  v_exp_f32 v140, v140
  v_exp_f32 v141, v141
  v_mfma_f32_32x32x16_bf16 v[104:119], v[96:99], v[72:75], v[168:183]
  v_exp_f32 v142, v142
  v_exp_f32 v143, v143
  v_exp_f32 v144, v144
  v_exp_f32 v145, v145
  v_mfma_f32_32x32x16_bf16 v[120:135], v[100:103], v[72:75], v[168:183]
  v_exp_f32 v146, v146
  v_exp_f32 v147, v147
  v_exp_f32 v148, v148
  ds_read_b128 v[88:91], v9 offset:12288
  ds_read_b128 v[92:95], v9 offset:13312
  v_exp_f32 v149, v149
  v_smfmac_f32_32x32x32_bf16 v[56:71], v[40:43], v[136:143], v6
  v_exp_f32 v150, v150
  v_exp_f32 v151, v151
  v_exp_f32 v152, v152
  v_exp_f32 v153, v153
  s_add_u32 m0, s65, 16384
  s_add_u32 s49, s64, 16384
  buffer_load_dwordx4 v7, s[44:47], s49 offen offset:0 sc1 lds
  buffer_load_dwordx4 v7, s[44:47], s49 offen offset:1024 sc1 lds
  buffer_load_dwordx4 v7, s[44:47], s49 offen offset:2048 sc1 lds
  buffer_load_dwordx4 v7, s[44:47], s49 offen offset:3072 sc1 lds
  v_exp_f32 v154, v154
  v_mfma_f32_32x32x4_2b_bf16 v[104:135], v[84:85], v[76:77], v[104:135]
  v_exp_f32 v155, v155
  v_exp_f32 v156, v156
  v_exp_f32 v157, v157
  v_exp_f32 v158, v158
  v_exp_f32 v159, v159
  v_exp_f32 v160, v160
  v_exp_f32 v161, v161
  s_mov_b64 exec, s[54:55]
  ds_read_b128 v[24:27], v12 offset:10240
  ds_read_b128 v[28:31], v12 offset:10880
  ds_read_b128 v[32:35], v12 offset:11520
  ds_read_b128 v[36:39], v12 offset:12160
  s_mov_b64 exec, -1
  v_exp_f32 v162, v162
  v_smfmac_f32_32x32x32_bf16 v[56:71], v[44:47], v[144:151], v6
  v_exp_f32 v163, v163
  v_exp_f32 v164, v164
  v_exp_f32 v165, v165
  v_smfmac_f32_32x32x32_bf16 v[56:71], v[48:51], v[152:159], v6
  v_exp_f32 v166, v166
  v_exp_f32 v167, v167
  s_waitcnt lgkmcnt(0)
  v_exp_f32 v104, v104
  v_exp_f32 v105, v105
  v_exp_f32 v106, v106
  v_smfmac_f32_32x32x32_bf16 v[56:71], v[52:55], v[160:167], v6
  v_exp_f32 v107, v107
  v_exp_f32 v108, v108
  v_exp_f32 v109, v109
  v_mfma_f32_32x32x16_bf16 v[136:151], v[88:91], v[72:75], v[168:183]
  v_exp_f32 v110, v110
  v_exp_f32 v111, v111
  v_exp_f32 v112, v112
  v_exp_f32 v113, v113
  v_mfma_f32_32x32x16_bf16 v[152:167], v[92:95], v[72:75], v[168:183]
  v_exp_f32 v114, v114
  v_exp_f32 v115, v115
  v_exp_f32 v116, v116
  ds_read_b128 v[96:99], v9 offset:20480
  ds_read_b128 v[100:103], v9 offset:21504
  ds_read2st64_b64 v[80:83], v14 offset0:128 offset1:129
  v_exp_f32 v117, v117
  v_smfmac_f32_32x32x32_bf16 v[56:71], v[24:27], v[104:111], v6
  v_exp_f32 v118, v118
  v_exp_f32 v119, v119
  v_exp_f32 v120, v120
  v_exp_f32 v121, v121
  s_add_u32 m0, s65, 20480
  s_add_u32 s49, s64, 20480
  buffer_load_dwordx4 v7, s[44:47], s49 offen offset:0 sc1 lds
  buffer_load_dwordx4 v7, s[44:47], s49 offen offset:1024 sc1 lds
  buffer_load_dwordx4 v7, s[44:47], s49 offen offset:2048 sc1 lds
  buffer_load_dwordx4 v7, s[44:47], s49 offen offset:3072 sc1 lds
  s_add_u32 m0, s65, 24576
  s_add_u32 s49, s64, 24576
  buffer_load_dwordx4 v7, s[44:47], s49 offen offset:0 sc1 lds
  v_exp_f32 v122, v122
  v_mfma_f32_32x32x4_2b_bf16 v[136:167], v[86:87], v[76:77], v[136:167]
  v_exp_f32 v123, v123
  v_exp_f32 v124, v124
  v_exp_f32 v125, v125
  v_exp_f32 v126, v126
  v_exp_f32 v127, v127
  v_exp_f32 v128, v128
  v_exp_f32 v129, v129
  s_mov_b64 exec, s[54:55]
  ds_read_b128 v[40:43], v12 offset:12800
  ds_read_b128 v[44:47], v12 offset:13440
  ds_read_b128 v[48:51], v12 offset:14080
  ds_read_b128 v[52:55], v12 offset:14720
  s_mov_b64 exec, -1
  v_exp_f32 v130, v130
  v_smfmac_f32_32x32x32_bf16 v[56:71], v[28:31], v[112:119], v6
  v_exp_f32 v131, v131
  v_exp_f32 v132, v132
  v_exp_f32 v133, v133
  v_smfmac_f32_32x32x32_bf16 v[56:71], v[32:35], v[120:127], v6
  v_exp_f32 v134, v134
  v_exp_f32 v135, v135
  s_waitcnt lgkmcnt(0)
  v_exp_f32 v136, v136
  v_exp_f32 v137, v137
  v_exp_f32 v138, v138
  v_smfmac_f32_32x32x32_bf16 v[56:71], v[36:39], v[128:135], v6
  v_exp_f32 v139, v139
  v_exp_f32 v140, v140
  v_exp_f32 v141, v141
  v_mfma_f32_32x32x16_bf16 v[104:119], v[96:99], v[72:75], v[168:183]
  v_exp_f32 v142, v142
  v_exp_f32 v143, v143
  v_exp_f32 v144, v144
  v_exp_f32 v145, v145
  v_mfma_f32_32x32x16_bf16 v[120:135], v[100:103], v[72:75], v[168:183]
  v_exp_f32 v146, v146
  v_exp_f32 v147, v147
  v_exp_f32 v148, v148
  ds_read_b128 v[88:91], v9 offset:22528
  ds_read_b128 v[92:95], v9 offset:23552
  v_exp_f32 v149, v149
  v_smfmac_f32_32x32x32_bf16 v[56:71], v[40:43], v[136:143], v6
  v_exp_f32 v150, v150
  v_exp_f32 v151, v151
  v_exp_f32 v152, v152
  v_exp_f32 v153, v153
  v_exp_f32 v154, v154
  v_mfma_f32_32x32x4_2b_bf16 v[104:135], v[80:81], v[76:77], v[104:135]
  v_exp_f32 v155, v155
  v_exp_f32 v156, v156
  v_exp_f32 v157, v157
  v_exp_f32 v158, v158
  v_exp_f32 v159, v159
  v_exp_f32 v160, v160
  v_exp_f32 v161, v161
  s_mov_b64 exec, s[54:55]
  ds_read_b128 v[24:27], v12 offset:20480
  ds_read_b128 v[28:31], v12 offset:21120
  ds_read_b128 v[32:35], v12 offset:21760
  ds_read_b128 v[36:39], v12 offset:22400
  s_mov_b64 exec, -1
  v_exp_f32 v162, v162
  v_smfmac_f32_32x32x32_bf16 v[56:71], v[44:47], v[144:151], v6
  v_exp_f32 v163, v163
  v_exp_f32 v164, v164
  v_exp_f32 v165, v165
  v_smfmac_f32_32x32x32_bf16 v[56:71], v[48:51], v[152:159], v6
  v_exp_f32 v166, v166
  v_exp_f32 v167, v167
  s_setprio 2
  s_waitcnt lgkmcnt(0)
  v_exp_f32 v104, v104
  v_exp_f32 v105, v105
  v_exp_f32 v106, v106
  v_smfmac_f32_32x32x32_bf16 v[56:71], v[52:55], v[160:167], v6
  v_exp_f32 v107, v107
  v_exp_f32 v108, v108
  v_exp_f32 v109, v109
  v_mfma_f32_32x32x16_bf16 v[136:151], v[88:91], v[72:75], v[168:183]
  v_exp_f32 v110, v110
  v_exp_f32 v111, v111
  v_exp_f32 v112, v112
  v_exp_f32 v113, v113
  v_mfma_f32_32x32x16_bf16 v[152:167], v[92:95], v[72:75], v[168:183]
  v_exp_f32 v114, v114
  v_exp_f32 v115, v115
  v_exp_f32 v116, v116
  ds_read_b128 v[96:99], v9 offset:30720
  ds_read_b128 v[100:103], v9 offset:31744
  ds_read2st64_b64 v[84:87], v14 offset0:148 offset1:149
  v_exp_f32 v117, v117
  v_smfmac_f32_32x32x32_bf16 v[56:71], v[24:27], v[104:111], v6
  v_exp_f32 v118, v118
  v_exp_f32 v119, v119
  v_exp_f32 v120, v120
  v_exp_f32 v121, v121
  v_exp_f32 v122, v122
  v_mfma_f32_32x32x4_2b_bf16 v[136:167], v[82:83], v[76:77], v[136:167]
  v_exp_f32 v123, v123
  v_exp_f32 v124, v124
  v_exp_f32 v125, v125
  v_exp_f32 v126, v126
  v_exp_f32 v127, v127
  v_exp_f32 v128, v128
  v_exp_f32 v129, v129
  s_mov_b64 exec, s[54:55]
  ds_read_b128 v[40:43], v12 offset:23040
  ds_read_b128 v[44:47], v12 offset:23680
  ds_read_b128 v[48:51], v12 offset:24320
  ds_read_b128 v[52:55], v12 offset:24960
  s_mov_b64 exec, -1
  v_exp_f32 v130, v130
  v_smfmac_f32_32x32x32_bf16 v[56:71], v[28:31], v[112:119], v6
  v_exp_f32 v131, v131
  v_exp_f32 v132, v132
  v_exp_f32 v133, v133
  v_smfmac_f32_32x32x32_bf16 v[56:71], v[32:35], v[120:127], v6
  v_exp_f32 v134, v134
  v_exp_f32 v135, v135
  s_waitcnt lgkmcnt(0)
  v_exp_f32 v136, v136
  v_exp_f32 v137, v137
  v_exp_f32 v138, v138
  v_smfmac_f32_32x32x32_bf16 v[56:71], v[36:39], v[128:135], v6
  v_exp_f32 v139, v139
  v_exp_f32 v140, v140
  v_exp_f32 v141, v141
  v_mfma_f32_32x32x16_bf16 v[104:119], v[96:99], v[72:75], v[168:183]
  v_exp_f32 v142, v142
  v_exp_f32 v143, v143
  v_exp_f32 v144, v144
  v_exp_f32 v145, v145
  v_mfma_f32_32x32x16_bf16 v[120:135], v[100:103], v[72:75], v[168:183]
  v_exp_f32 v146, v146
  v_exp_f32 v147, v147
  v_exp_f32 v148, v148
  ds_read_b128 v[88:91], v9 offset:32768
  ds_read_b128 v[92:95], v9 offset:33792
  v_exp_f32 v149, v149
  v_smfmac_f32_32x32x32_bf16 v[56:71], v[40:43], v[136:143], v6
  v_exp_f32 v150, v150
  v_exp_f32 v151, v151
  v_exp_f32 v152, v152
  v_exp_f32 v153, v153
  s_waitcnt vmcnt(0)
  ds_write_b32 v3, v6
  s_waitcnt vmcnt(0)
  v_and_b32 v23, 15, v23
  v_cmp_ne_u32 vcc, s81, v23
  s_and_b32 s80, vcc_lo, 0xff
  v_exp_f32 v154, v154
  v_mfma_f32_32x32x4_2b_bf16 v[104:135], v[84:85], v[76:77], v[104:135]
  v_exp_f32 v155, v155
  v_exp_f32 v156, v156
  v_exp_f32 v157, v157
  v_exp_f32 v158, v158
  v_exp_f32 v159, v159
  v_exp_f32 v160, v160
  v_exp_f32 v161, v161
  s_mov_b64 exec, s[54:55]
  ds_read_b128 v[24:27], v12 offset:30720
  ds_read_b128 v[28:31], v12 offset:31360
  ds_read_b128 v[32:35], v12 offset:32000
  ds_read_b128 v[36:39], v12 offset:32640
  s_mov_b64 exec, -1
  v_exp_f32 v162, v162
  v_smfmac_f32_32x32x32_bf16 v[56:71], v[44:47], v[144:151], v6
  v_exp_f32 v163, v163
  v_exp_f32 v164, v164
  v_exp_f32 v165, v165
  v_smfmac_f32_32x32x32_bf16 v[56:71], v[48:51], v[152:159], v6
  v_exp_f32 v166, v166
  v_exp_f32 v167, v167
  s_waitcnt lgkmcnt(0)
  v_exp_f32 v104, v104
  v_exp_f32 v105, v105
  v_exp_f32 v106, v106
  v_smfmac_f32_32x32x32_bf16 v[56:71], v[52:55], v[160:167], v6
  v_exp_f32 v107, v107
  v_exp_f32 v108, v108
  v_exp_f32 v109, v109
  v_mfma_f32_32x32x16_bf16 v[136:151], v[88:91], v[72:75], v[168:183]
  v_exp_f32 v110, v110
  v_exp_f32 v111, v111
  v_exp_f32 v112, v112
  v_exp_f32 v113, v113
  v_mfma_f32_32x32x16_bf16 v[152:167], v[92:95], v[72:75], v[168:183]
  v_exp_f32 v114, v114
  v_exp_f32 v115, v115
  v_exp_f32 v116, v116
  v_exp_f32 v117, v117
  v_smfmac_f32_32x32x32_bf16 v[56:71], v[24:27], v[104:111], v6
  v_exp_f32 v118, v118
  v_exp_f32 v119, v119
  v_exp_f32 v120, v120
  v_exp_f32 v121, v121
  v_exp_f32 v122, v122
  v_mfma_f32_32x32x4_2b_bf16 v[136:167], v[86:87], v[76:77], v[136:167]
  v_exp_f32 v123, v123
  v_exp_f32 v124, v124
  v_exp_f32 v125, v125
  v_exp_f32 v126, v126
  v_exp_f32 v127, v127
  v_exp_f32 v128, v128
  v_exp_f32 v129, v129
  s_mov_b64 exec, s[54:55]
  ds_read_b128 v[40:43], v12 offset:33280
  ds_read_b128 v[44:47], v12 offset:33920
  ds_read_b128 v[48:51], v12 offset:34560
  ds_read_b128 v[52:55], v12 offset:35200
  s_mov_b64 exec, -1
  v_exp_f32 v130, v130
  v_smfmac_f32_32x32x32_bf16 v[56:71], v[28:31], v[112:119], v6
  v_exp_f32 v131, v131
  v_exp_f32 v132, v132
  v_exp_f32 v133, v133
  v_smfmac_f32_32x32x32_bf16 v[56:71], v[32:35], v[120:127], v6
  v_exp_f32 v134, v134
  v_exp_f32 v135, v135
  s_waitcnt lgkmcnt(0)
  v_exp_f32 v136, v136
  v_exp_f32 v137, v137
  v_exp_f32 v138, v138
  v_smfmac_f32_32x32x32_bf16 v[56:71], v[36:39], v[128:135], v6
  v_exp_f32 v139, v139
  v_exp_f32 v140, v140
  v_exp_f32 v141, v141
  v_exp_f32 v142, v142
  v_exp_f32 v143, v143
  v_exp_f32 v144, v144
  v_exp_f32 v145, v145
  v_exp_f32 v146, v146
  v_exp_f32 v147, v147
  v_exp_f32 v148, v148
  v_exp_f32 v149, v149
  v_smfmac_f32_32x32x32_bf16 v[56:71], v[40:43], v[136:143], v6
  v_exp_f32 v150, v150
  v_exp_f32 v151, v151
  v_exp_f32 v152, v152
  v_exp_f32 v153, v153
  v_exp_f32 v154, v154
  v_exp_f32 v155, v155
  v_exp_f32 v156, v156
  v_exp_f32 v157, v157
  v_exp_f32 v158, v158
  v_exp_f32 v159, v159
  v_exp_f32 v160, v160
  v_exp_f32 v161, v161
  v_exp_f32 v162, v162
  v_smfmac_f32_32x32x32_bf16 v[56:71], v[44:47], v[144:151], v6
  v_exp_f32 v163, v163
  v_exp_f32 v164, v164
  v_exp_f32 v165, v165
  v_smfmac_f32_32x32x32_bf16 v[56:71], v[48:51], v[152:159], v6
  v_exp_f32 v166, v166
  v_exp_f32 v167, v167
  s_branch L_lend
L_young:
L_pad6:
  s_cbranch_execz L_pad8
  s_setprio 2
  s_waitcnt lgkmcnt(0)
  v_exp_f32 v104, v104
  v_exp_f32 v105, v105
  v_exp_f32 v106, v106
  v_exp_f32 v107, v107
  v_exp_f32 v108, v108
  v_exp_f32 v109, v109
  v_mfma_f32_32x32x16_bf16 v[136:151], v[88:91], v[72:75], v[168:183]
  v_exp_f32 v110, v110
  v_exp_f32 v111, v111
  v_exp_f32 v112, v112
  v_exp_f32 v113, v113
  v_mfma_f32_32x32x16_bf16 v[152:167], v[92:95], v[72:75], v[168:183]
L_pad7:
  s_cbranch_execz L_pad9
  v_exp_f32 v114, v114
  v_exp_f32 v115, v115
  v_exp_f32 v116, v116
  ds_read_b128 v[96:99], v7 offset:10240
  ds_read_b128 v[100:103], v7 offset:11264
  ds_read2st64_b64 v[84:87], v13 offset0:28 offset1:29
  v_exp_f32 v117, v117
  v_smfmac_f32_32x32x32_bf16 v[56:71], v[24:27], v[104:111], v6
  v_exp_f32 v118, v118
  v_exp_f32 v119, v119
  v_exp_f32 v120, v120
  v_exp_f32 v121, v121
  s_add_u32 m0, s58, 32768
  s_add_u32 s49, s58, 32768
  buffer_load_dwordx4 v7, s[44:47], s49 offen offset:0 sc1 lds
  buffer_load_dwordx4 v7, s[44:47], s49 offen offset:1024 sc1 lds
  buffer_load_dwordx4 v7, s[44:47], s49 offen offset:2048 sc1 lds
  buffer_load_dwordx4 v7, s[44:47], s49 offen offset:3072 sc1 lds
  v_exp_f32 v122, v122
  v_mfma_f32_32x32x4_2b_bf16 v[136:167], v[82:83], v[76:77], v[136:167]
  v_exp_f32 v123, v123
  v_exp_f32 v124, v124
  v_exp_f32 v125, v125
  v_exp_f32 v126, v126
  v_exp_f32 v127, v127
  v_exp_f32 v128, v128
  v_exp_f32 v129, v129
  s_mov_b64 exec, s[54:55]
  ds_read_b128 v[40:43], v10 offset:2560
  ds_read_b128 v[44:47], v10 offset:3200
  ds_read_b128 v[48:51], v10 offset:3840
  ds_read_b128 v[52:55], v10 offset:4480
  s_mov_b64 exec, -1
  v_exp_f32 v130, v130
  v_smfmac_f32_32x32x32_bf16 v[56:71], v[28:31], v[112:119], v6
  v_exp_f32 v131, v131
  v_exp_f32 v132, v132
  v_exp_f32 v133, v133
  v_smfmac_f32_32x32x32_bf16 v[56:71], v[32:35], v[120:127], v6
  v_exp_f32 v134, v134
  v_exp_f32 v135, v135
  s_setprio 3
  s_waitcnt lgkmcnt(0)
  v_exp_f32 v136, v136
  v_exp_f32 v137, v137
  v_exp_f32 v138, v138
  v_smfmac_f32_32x32x32_bf16 v[56:71], v[36:39], v[128:135], v6
  v_exp_f32 v139, v139
  v_exp_f32 v140, v140
  v_exp_f32 v141, v141
  v_mfma_f32_32x32x16_bf16 v[104:119], v[96:99], v[72:75], v[168:183]
  v_exp_f32 v142, v142
  v_exp_f32 v143, v143
  v_exp_f32 v144, v144
  v_exp_f32 v145, v145
  v_mfma_f32_32x32x16_bf16 v[120:135], v[100:103], v[72:75], v[168:183]
  v_exp_f32 v146, v146
  v_exp_f32 v147, v147
  v_exp_f32 v148, v148
  ds_read_b128 v[88:91], v7 offset:12288
  ds_read_b128 v[92:95], v7 offset:13312
  v_exp_f32 v149, v149
  v_smfmac_f32_32x32x32_bf16 v[56:71], v[40:43], v[136:143], v6
  v_exp_f32 v150, v150
  v_exp_f32 v151, v151
  v_exp_f32 v152, v152
  v_exp_f32 v153, v153
  s_add_u32 m0, s58, 65536
  s_add_u32 s49, s58, 65536
  buffer_load_dwordx4 v7, s[44:47], s49 offen offset:0 sc1 lds
  buffer_load_dwordx4 v7, s[44:47], s49 offen offset:1024 sc1 lds
  buffer_load_dwordx4 v7, s[44:47], s49 offen offset:2048 sc1 lds
  buffer_load_dwordx4 v7, s[44:47], s49 offen offset:3072 sc1 lds
  v_exp_f32 v154, v154
  v_mfma_f32_32x32x4_2b_bf16 v[104:135], v[84:85], v[76:77], v[104:135]
  v_exp_f32 v155, v155
  v_exp_f32 v156, v156
  v_exp_f32 v157, v157
  v_exp_f32 v158, v158
  v_exp_f32 v159, v159
  v_exp_f32 v160, v160
  v_exp_f32 v161, v161
  s_mov_b64 exec, s[54:55]
  ds_read_b128 v[24:27], v10 offset:10240
  ds_read_b128 v[28:31], v10 offset:10880
  ds_read_b128 v[32:35], v10 offset:11520
  ds_read_b128 v[36:39], v10 offset:12160
  s_mov_b64 exec, -1
  v_exp_f32 v162, v162
  v_smfmac_f32_32x32x32_bf16 v[56:71], v[44:47], v[144:151], v6
  v_exp_f32 v163, v163
  v_exp_f32 v164, v164
  v_exp_f32 v165, v165
  v_smfmac_f32_32x32x32_bf16 v[56:71], v[48:51], v[152:159], v6
  v_exp_f32 v166, v166
  v_exp_f32 v167, v167
  s_setprio 1
  s_waitcnt lgkmcnt(0)
  v_exp_f32 v104, v104
  v_exp_f32 v105, v105
  v_exp_f32 v106, v106
  v_smfmac_f32_32x32x32_bf16 v[56:71], v[52:55], v[160:167], v6
  v_exp_f32 v107, v107
  v_exp_f32 v108, v108
  v_exp_f32 v109, v109
  v_mfma_f32_32x32x16_bf16 v[136:151], v[88:91], v[72:75], v[168:183]
  v_exp_f32 v110, v110
  v_exp_f32 v111, v111
  v_exp_f32 v112, v112
  v_exp_f32 v113, v113
  v_mfma_f32_32x32x16_bf16 v[152:167], v[92:95], v[72:75], v[168:183]
  v_exp_f32 v114, v114
  v_exp_f32 v115, v115
  v_exp_f32 v116, v116
  s_waitcnt vmcnt(4)
  s_barrier
  s_cmp_eq_u32 s3, 7
  s_cbranch_scc0 L_notf0
  s_bfe_u32 s49, s2, 0x40001
  s_lshl_b32 s49, s49, 7
  s_add_u32 s49, s49, 0x34800
  v_mov_b32 v4, 1
  s_mov_b64 exec, 1
  buffer_atomic_add v4, v7, s[44:47], s49 offen sc1
  s_mov_b64 exec, -1
L_notf0:
  ds_read_b128 v[96:99], v7 offset:20480
  ds_read_b128 v[100:103], v7 offset:21504
  ds_read2st64_b64 v[80:83], v13 offset0:48 offset1:49
  v_exp_f32 v117, v117
  v_smfmac_f32_32x32x32_bf16 v[56:71], v[24:27], v[104:111], v6
  v_exp_f32 v118, v118
  v_exp_f32 v119, v119
  v_exp_f32 v120, v120
  v_exp_f32 v121, v121
  v_exp_f32 v122, v122
  v_mfma_f32_32x32x4_2b_bf16 v[136:167], v[86:87], v[76:77], v[136:167]
  v_exp_f32 v123, v123
  v_exp_f32 v124, v124
  v_exp_f32 v125, v125
  v_exp_f32 v126, v126
  v_exp_f32 v127, v127
  v_exp_f32 v128, v128
  v_exp_f32 v129, v129
  s_mov_b64 exec, s[54:55]
  ds_read_b128 v[40:43], v10 offset:12800
  ds_read_b128 v[44:47], v10 offset:13440
  ds_read_b128 v[48:51], v10 offset:14080
  ds_read_b128 v[52:55], v10 offset:14720
  s_mov_b64 exec, -1
  v_exp_f32 v130, v130
  v_smfmac_f32_32x32x32_bf16 v[56:71], v[28:31], v[112:119], v6
  v_exp_f32 v131, v131
  v_exp_f32 v132, v132
  v_exp_f32 v133, v133
  v_smfmac_f32_32x32x32_bf16 v[56:71], v[32:35], v[120:127], v6
  v_exp_f32 v134, v134
  v_exp_f32 v135, v135
  s_setprio 3
  s_waitcnt lgkmcnt(0)
  v_exp_f32 v136, v136
  v_exp_f32 v137, v137
  v_exp_f32 v138, v138
  v_smfmac_f32_32x32x32_bf16 v[56:71], v[36:39], v[128:135], v6
  v_exp_f32 v139, v139
  v_exp_f32 v140, v140
  v_exp_f32 v141, v141
  v_mfma_f32_32x32x16_bf16 v[104:119], v[96:99], v[72:75], v[168:183]
  v_exp_f32 v142, v142
  v_exp_f32 v143, v143
  v_exp_f32 v144, v144
  v_exp_f32 v145, v145
  v_mfma_f32_32x32x16_bf16 v[120:135], v[100:103], v[72:75], v[168:183]
  v_exp_f32 v146, v146
  v_exp_f32 v147, v147
  v_exp_f32 v148, v148
  ds_read_b128 v[88:91], v7 offset:22528
  ds_read_b128 v[92:95], v7 offset:23552
  v_exp_f32 v149, v149
  v_smfmac_f32_32x32x32_bf16 v[56:71], v[40:43], v[136:143], v6
  v_exp_f32 v150, v150
  v_exp_f32 v151, v151
  v_exp_f32 v152, v152
  v_exp_f32 v153, v153
  v_exp_f32 v154, v154
  v_mfma_f32_32x32x4_2b_bf16 v[104:135], v[80:81], v[76:77], v[104:135]
  v_exp_f32 v155, v155
  v_exp_f32 v156, v156
  v_exp_f32 v157, v157
  v_exp_f32 v158, v158
  v_exp_f32 v159, v159
  v_exp_f32 v160, v160
  v_exp_f32 v161, v161
  s_mov_b64 exec, s[54:55]
  ds_read_b128 v[24:27], v10 offset:20480
  ds_read_b128 v[28:31], v10 offset:21120
  ds_read_b128 v[32:35], v10 offset:21760
  ds_read_b128 v[36:39], v10 offset:22400
  s_mov_b64 exec, -1
  v_exp_f32 v162, v162
  v_smfmac_f32_32x32x32_bf16 v[56:71], v[44:47], v[144:151], v6
  v_exp_f32 v163, v163
  v_exp_f32 v164, v164
  v_exp_f32 v165, v165
  v_smfmac_f32_32x32x32_bf16 v[56:71], v[48:51], v[152:159], v6
  v_exp_f32 v166, v166
  v_exp_f32 v167, v167
  s_waitcnt lgkmcnt(0)
  v_exp_f32 v104, v104
  v_exp_f32 v105, v105
  v_exp_f32 v106, v106
  v_smfmac_f32_32x32x32_bf16 v[56:71], v[52:55], v[160:167], v6
  v_exp_f32 v107, v107
  v_exp_f32 v108, v108
  v_exp_f32 v109, v109
  v_mfma_f32_32x32x16_bf16 v[136:151], v[88:91], v[72:75], v[168:183]
  v_exp_f32 v110, v110
  v_exp_f32 v111, v111
  v_exp_f32 v112, v112
  v_exp_f32 v113, v113
  v_mfma_f32_32x32x16_bf16 v[152:167], v[92:95], v[72:75], v[168:183]
  v_exp_f32 v114, v114
  v_exp_f32 v115, v115
  v_exp_f32 v116, v116
  ds_read_b128 v[96:99], v7 offset:30720
  ds_read_b128 v[100:103], v7 offset:31744
  ds_read2st64_b64 v[84:87], v13 offset0:68 offset1:69
  v_exp_f32 v117, v117
  v_smfmac_f32_32x32x32_bf16 v[56:71], v[24:27], v[104:111], v6
  v_exp_f32 v118, v118
  v_exp_f32 v119, v119
  v_exp_f32 v120, v120
  v_exp_f32 v121, v121
  s_add_u32 m0, s58, 98304
  s_add_u32 s49, s58, 98304
  buffer_load_dwordx4 v7, s[44:47], s49 offen offset:0 sc1 lds
  buffer_load_dwordx4 v7, s[44:47], s49 offen offset:1024 sc1 lds
  buffer_load_dwordx4 v7, s[44:47], s49 offen offset:2048 sc1 lds
  buffer_load_dwordx4 v7, s[44:47], s49 offen offset:3072 sc1 lds
  v_exp_f32 v122, v122
  v_mfma_f32_32x32x4_2b_bf16 v[136:167], v[82:83], v[76:77], v[136:167]
  v_exp_f32 v123, v123
  v_exp_f32 v124, v124
  v_exp_f32 v125, v125
  v_exp_f32 v126, v126
  v_exp_f32 v127, v127
  v_exp_f32 v128, v128
  v_exp_f32 v129, v129
  s_mov_b64 exec, s[54:55]
  ds_read_b128 v[40:43], v10 offset:23040
  ds_read_b128 v[44:47], v10 offset:23680
  ds_read_b128 v[48:51], v10 offset:24320
  ds_read_b128 v[52:55], v10 offset:24960
  s_mov_b64 exec, -1
  v_exp_f32 v130, v130
  v_smfmac_f32_32x32x32_bf16 v[56:71], v[28:31], v[112:119], v6
  v_exp_f32 v131, v131
  v_exp_f32 v132, v132
  v_exp_f32 v133, v133
  v_smfmac_f32_32x32x32_bf16 v[56:71], v[32:35], v[120:127], v6
  v_exp_f32 v134, v134
  v_exp_f32 v135, v135
  s_waitcnt lgkmcnt(0)
  v_exp_f32 v136, v136
  v_exp_f32 v137, v137
  v_exp_f32 v138, v138
  v_smfmac_f32_32x32x32_bf16 v[56:71], v[36:39], v[128:135], v6
  v_exp_f32 v139, v139
  v_exp_f32 v140, v140
  v_exp_f32 v141, v141
  v_mfma_f32_32x32x16_bf16 v[104:119], v[96:99], v[72:75], v[168:183]
  v_exp_f32 v142, v142
  v_exp_f32 v143, v143
  v_exp_f32 v144, v144
  v_exp_f32 v145, v145
  v_mfma_f32_32x32x16_bf16 v[120:135], v[100:103], v[72:75], v[168:183]
  v_exp_f32 v146, v146
  v_exp_f32 v147, v147
  v_exp_f32 v148, v148
  ds_read_b128 v[88:91], v7 offset:32768
  ds_read_b128 v[92:95], v7 offset:33792
  v_exp_f32 v149, v149
  v_smfmac_f32_32x32x32_bf16 v[56:71], v[40:43], v[136:143], v6
  v_exp_f32 v150, v150
  v_exp_f32 v151, v151
  v_exp_f32 v152, v152
  v_exp_f32 v153, v153
  s_add_u32 m0, s58, 131072
  s_add_u32 s49, s58, 131072
  buffer_load_dwordx4 v7, s[44:47], s49 offen offset:0 sc1 lds
  buffer_load_dwordx4 v7, s[44:47], s49 offen offset:1024 sc1 lds
  buffer_load_dwordx4 v7, s[44:47], s49 offen offset:2048 sc1 lds
  buffer_load_dwordx4 v7, s[44:47], s49 offen offset:3072 sc1 lds
  v_exp_f32 v154, v154
  v_mfma_f32_32x32x4_2b_bf16 v[104:135], v[84:85], v[76:77], v[104:135]
  v_exp_f32 v155, v155
  v_exp_f32 v156, v156
  v_exp_f32 v157, v157
  v_exp_f32 v158, v158
  v_exp_f32 v159, v159
  v_exp_f32 v160, v160
  v_exp_f32 v161, v161
  s_mov_b64 exec, s[54:55]
  ds_read_b128 v[24:27], v10 offset:30720
  ds_read_b128 v[28:31], v10 offset:31360
  ds_read_b128 v[32:35], v10 offset:32000
  ds_read_b128 v[36:39], v10 offset:32640
  s_mov_b64 exec, -1
  v_exp_f32 v162, v162
  v_smfmac_f32_32x32x32_bf16 v[56:71], v[44:47], v[144:151], v6
  v_exp_f32 v163, v163
  v_exp_f32 v164, v164
  v_exp_f32 v165, v165
  v_smfmac_f32_32x32x32_bf16 v[56:71], v[48:51], v[152:159], v6
  v_exp_f32 v166, v166
  v_exp_f32 v167, v167
  s_waitcnt lgkmcnt(0)
  v_exp_f32 v104, v104
  v_exp_f32 v105, v105
  v_exp_f32 v106, v106
  v_smfmac_f32_32x32x32_bf16 v[56:71], v[52:55], v[160:167], v6
  v_exp_f32 v107, v107
  v_exp_f32 v108, v108
  v_exp_f32 v109, v109
  v_mfma_f32_32x32x16_bf16 v[136:151], v[88:91], v[72:75], v[168:183]
  v_exp_f32 v110, v110
  v_exp_f32 v111, v111
  v_exp_f32 v112, v112
  v_exp_f32 v113, v113
  v_mfma_f32_32x32x16_bf16 v[152:167], v[92:95], v[72:75], v[168:183]
  v_exp_f32 v114, v114
  v_exp_f32 v115, v115
  v_exp_f32 v116, v116
  ds_read_b128 v[96:99], v7 offset:40960
  ds_read_b128 v[100:103], v7 offset:41984
  ds_read2st64_b64 v[80:83], v13 offset0:88 offset1:89
  v_exp_f32 v117, v117
  v_smfmac_f32_32x32x32_bf16 v[56:71], v[24:27], v[104:111], v6
  v_exp_f32 v118, v118
  v_exp_f32 v119, v119
  v_exp_f32 v120, v120
  v_exp_f32 v121, v121
  v_exp_f32 v122, v122
  v_mfma_f32_32x32x4_2b_bf16 v[136:167], v[86:87], v[76:77], v[136:167]
  v_exp_f32 v123, v123
  v_exp_f32 v124, v124
  v_exp_f32 v125, v125
  v_exp_f32 v126, v126
  v_exp_f32 v127, v127
  v_exp_f32 v128, v128
  v_exp_f32 v129, v129
  s_mov_b64 exec, s[54:55]
  ds_read_b128 v[40:43], v10 offset:33280
  ds_read_b128 v[44:47], v10 offset:33920
  ds_read_b128 v[48:51], v10 offset:34560
  ds_read_b128 v[52:55], v10 offset:35200
  s_mov_b64 exec, -1
  v_exp_f32 v130, v130
  v_frexp_exp_i32_f32 v78, v68
  v_sub_u32 v78, -75, v78
  v_max_i32 v78, 0xffffff88, v78
  v_cvt_f32_i32 v79, v78
  v_ldexp_f32 v78, 1.0, v78
  v_pk_add_f32 v[168:169], v[168:169], v[78:79] op_sel:[0,1] op_sel_hi:[1,1]
  v_pk_add_f32 v[170:171], v[170:171], v[78:79] op_sel:[0,1] op_sel_hi:[1,1]
  v_pk_add_f32 v[172:173], v[172:173], v[78:79] op_sel:[0,1] op_sel_hi:[1,1]
  v_pk_add_f32 v[174:175], v[174:175], v[78:79] op_sel:[0,1] op_sel_hi:[1,1]
  v_pk_add_f32 v[176:177], v[176:177], v[78:79] op_sel:[0,1] op_sel_hi:[1,1]
  v_pk_add_f32 v[178:179], v[178:179], v[78:79] op_sel:[0,1] op_sel_hi:[1,1]
  v_pk_add_f32 v[180:181], v[180:181], v[78:79] op_sel:[0,1] op_sel_hi:[1,1]
  v_pk_add_f32 v[182:183], v[182:183], v[78:79] op_sel:[0,1] op_sel_hi:[1,1]
  v_smfmac_f32_32x32x32_bf16 v[56:71], v[28:31], v[112:119], v6
  v_exp_f32 v131, v131
  v_exp_f32 v132, v132
  v_exp_f32 v133, v133
  v_smfmac_f32_32x32x32_bf16 v[56:71], v[32:35], v[120:127], v6
  v_exp_f32 v134, v134
  v_exp_f32 v135, v135
  s_setprio 2
  s_waitcnt lgkmcnt(0)
  v_exp_f32 v136, v136
  v_exp_f32 v137, v137
  v_exp_f32 v138, v138
  v_smfmac_f32_32x32x32_bf16 v[56:71], v[36:39], v[128:135], v6
  v_exp_f32 v139, v139
  v_exp_f32 v140, v140
  v_exp_f32 v141, v141
  v_mfma_f32_32x32x16_bf16 v[104:119], v[96:99], v[72:75], v[168:183]
  v_exp_f32 v142, v142
  v_exp_f32 v143, v143
  v_exp_f32 v144, v144
  v_exp_f32 v145, v145
  v_mfma_f32_32x32x16_bf16 v[120:135], v[100:103], v[72:75], v[168:183]
  v_exp_f32 v146, v146
  v_exp_f32 v147, v147
  v_exp_f32 v148, v148
  ds_read_b128 v[88:91], v7 offset:43008
  ds_read_b128 v[92:95], v7 offset:44032
  v_exp_f32 v149, v149
  v_smfmac_f32_32x32x32_bf16 v[56:71], v[40:43], v[136:143], v6
  v_exp_f32 v150, v150
  v_exp_f32 v151, v151
  v_exp_f32 v152, v152
  v_exp_f32 v153, v153
  v_exp_f32 v154, v154
  v_mfma_f32_32x32x4_2b_bf16 v[104:135], v[80:81], v[76:77], v[104:135]
  v_exp_f32 v155, v155
  v_exp_f32 v156, v156
  v_exp_f32 v157, v157
  v_exp_f32 v158, v158
  v_exp_f32 v159, v159
  v_exp_f32 v160, v160
  v_exp_f32 v161, v161
  s_mov_b64 exec, s[54:55]
  ds_read_b128 v[24:27], v10 offset:40960
  ds_read_b128 v[28:31], v10 offset:41600
  ds_read_b128 v[32:35], v10 offset:42240
  ds_read_b128 v[36:39], v10 offset:42880
  s_mov_b64 exec, -1
  v_exp_f32 v162, v162
  v_smfmac_f32_32x32x32_bf16 v[56:71], v[44:47], v[144:151], v6
  v_exp_f32 v163, v163
  v_exp_f32 v164, v164
  v_exp_f32 v165, v165
  v_smfmac_f32_32x32x32_bf16 v[56:71], v[48:51], v[152:159], v6
  v_exp_f32 v166, v166
  v_exp_f32 v167, v167
  s_setprio 1
  s_waitcnt lgkmcnt(0)
  v_exp_f32 v104, v104
  v_exp_f32 v105, v105
  v_exp_f32 v106, v106
  v_smfmac_f32_32x32x32_bf16 v[56:71], v[52:55], v[160:167], v6
  v_exp_f32 v107, v107
  v_exp_f32 v108, v108
  v_exp_f32 v109, v109
  v_mfma_f32_32x32x16_bf16 v[136:151], v[88:91], v[72:75], v[168:183]
  v_exp_f32 v110, v110
  v_exp_f32 v111, v111
  v_exp_f32 v112, v112
  v_exp_f32 v113, v113
  v_mfma_f32_32x32x16_bf16 v[152:167], v[92:95], v[72:75], v[168:183]
  v_exp_f32 v114, v114
  v_exp_f32 v115, v115
  v_exp_f32 v116, v116
  ds_read_b128 v[96:99], v7 offset:51200
  ds_read_b128 v[100:103], v7 offset:52224
  ds_read2st64_b64 v[84:87], v13 offset0:108 offset1:109
  v_exp_f32 v117, v117
  v_exp_f32 v118, v118
  v_exp_f32 v119, v119
  v_pk_mul_f32 v[56:57], v[56:57], v[78:79] op_sel_hi:[1,0]
  v_pk_mul_f32 v[58:59], v[58:59], v[78:79] op_sel_hi:[1,0]
  v_pk_mul_f32 v[60:61], v[60:61], v[78:79] op_sel_hi:[1,0]
  v_pk_mul_f32 v[62:63], v[62:63], v[78:79] op_sel_hi:[1,0]
  v_pk_mul_f32 v[64:65], v[64:65], v[78:79] op_sel_hi:[1,0]
  v_pk_mul_f32 v[66:67], v[66:67], v[78:79] op_sel_hi:[1,0]
  v_pk_mul_f32 v[68:69], v[68:69], v[78:79] op_sel_hi:[1,0]
  v_exp_f32 v120, v120
  v_exp_f32 v121, v121
  v_lshlrev_b32 v2, 7, v1
  s_mov_b64 exec, 0xff
  buffer_load_dword v0, v2, s[44:47], s66 offen sc1
  s_mov_b64 exec, 3
  buffer_load_dword v0, v2, s[44:47], s67 offen sc1
  s_mov_b64 exec, -1
  v_smfmac_f32_32x32x32_bf16 v[56:71], v[24:27], v[104:111], v6
  v_exp_f32 v122, v122
  v_mfma_f32_32x32x4_2b_bf16 v[136:167], v[82:83], v[76:77], v[136:167]
  v_exp_f32 v123, v123
  v_exp_f32 v124, v124
  v_exp_f32 v125, v125
  v_exp_f32 v126, v126
  v_exp_f32 v127, v127
  v_exp_f32 v128, v128
  v_exp_f32 v129, v129
  s_mov_b64 exec, s[54:55]
  ds_read_b128 v[40:43], v10 offset:43520
  ds_read_b128 v[44:47], v10 offset:44160
  ds_read_b128 v[48:51], v10 offset:44800
  ds_read_b128 v[52:55], v10 offset:45440
  s_mov_b64 exec, -1
  v_exp_f32 v130, v130
  v_smfmac_f32_32x32x32_bf16 v[56:71], v[28:31], v[112:119], v6
  v_exp_f32 v131, v131
  v_exp_f32 v132, v132
  v_exp_f32 v133, v133
  v_smfmac_f32_32x32x32_bf16 v[56:71], v[32:35], v[120:127], v6
  v_exp_f32 v134, v134
  v_exp_f32 v135, v135
  s_setprio 0
  s_waitcnt lgkmcnt(0)
  v_exp_f32 v136, v136
  v_exp_f32 v137, v137
  v_exp_f32 v138, v138
  v_smfmac_f32_32x32x32_bf16 v[56:71], v[36:39], v[128:135], v6
  v_exp_f32 v139, v139
  v_exp_f32 v140, v140
  v_exp_f32 v141, v141
  v_mfma_f32_32x32x16_bf16 v[104:119], v[96:99], v[72:75], v[168:183]
  v_exp_f32 v142, v142
  v_exp_f32 v143, v143
  v_exp_f32 v144, v144
  v_exp_f32 v145, v145
  v_mfma_f32_32x32x16_bf16 v[120:135], v[100:103], v[72:75], v[168:183]
  v_exp_f32 v146, v146
  v_exp_f32 v147, v147
  v_exp_f32 v148, v148
  s_waitcnt vmcnt(2)
  s_barrier
  s_cmp_eq_u32 s3, 7
  s_cbranch_scc0 L_notf1
  s_bfe_u32 s49, s2, 0x40001
  s_lshl_b32 s49, s49, 7
  s_add_u32 s49, s49, 0x35000
  v_mov_b32 v4, 1
  s_mov_b64 exec, 1
  buffer_atomic_add v4, v7, s[44:47], s49 offen sc1
  s_mov_b64 exec, -1
L_notf1:
  ds_read_b128 v[88:91], v7 offset:53248
  ds_read_b128 v[92:95], v7 offset:54272
  v_exp_f32 v149, v149
  v_smfmac_f32_32x32x32_bf16 v[56:71], v[40:43], v[136:143], v6
  v_exp_f32 v150, v150
  v_exp_f32 v151, v151
  v_exp_f32 v152, v152
  v_exp_f32 v153, v153
  v_lshlrev_b32 v5, 5, v1
  s_mov_b32 s49, 0x34800
  v_and_b32 v5, 0x780, v5
  buffer_load_dword v5, v5, s[44:47], s49 offen sc1
  v_exp_f32 v154, v154
  v_mfma_f32_32x32x4_2b_bf16 v[104:135], v[84:85], v[76:77], v[104:135]
  v_exp_f32 v155, v155
  v_exp_f32 v156, v156
  v_exp_f32 v157, v157
  v_exp_f32 v158, v158
  v_exp_f32 v159, v159
  v_exp_f32 v160, v160
  v_exp_f32 v161, v161
  s_mov_b64 exec, s[54:55]
  ds_read_b128 v[24:27], v10 offset:51200
  ds_read_b128 v[28:31], v10 offset:51840
  ds_read_b128 v[32:35], v10 offset:52480
  ds_read_b128 v[36:39], v10 offset:53120
  s_mov_b64 exec, -1
  v_exp_f32 v162, v162
  v_smfmac_f32_32x32x32_bf16 v[56:71], v[44:47], v[144:151], v6
  v_exp_f32 v163, v163
  v_exp_f32 v164, v164
  v_exp_f32 v165, v165
  v_smfmac_f32_32x32x32_bf16 v[56:71], v[48:51], v[152:159], v6
  v_exp_f32 v166, v166
  v_exp_f32 v167, v167
  s_setprio 3
  s_waitcnt lgkmcnt(0)
  v_exp_f32 v104, v104
  v_exp_f32 v105, v105
  v_exp_f32 v106, v106
  v_smfmac_f32_32x32x32_bf16 v[56:71], v[52:55], v[160:167], v6
  v_exp_f32 v107, v107
  v_exp_f32 v108, v108
  v_exp_f32 v109, v109
  v_mfma_f32_32x32x16_bf16 v[136:151], v[88:91], v[72:75], v[168:183]
  v_exp_f32 v110, v110
  v_exp_f32 v111, v111
  v_exp_f32 v112, v112
  v_exp_f32 v113, v113
  v_mfma_f32_32x32x16_bf16 v[152:167], v[92:95], v[72:75], v[168:183]
  v_exp_f32 v114, v114
  v_exp_f32 v115, v115
  v_exp_f32 v116, v116
  ds_read_b128 v[96:99], v8 offset:0
  ds_read_b128 v[100:103], v8 offset:1024
  ds_read2st64_b64 v[80:83], v13 offset0:128 offset1:129
  v_exp_f32 v117, v117
  v_smfmac_f32_32x32x32_bf16 v[56:71], v[24:27], v[104:111], v6
  v_exp_f32 v118, v118
  v_exp_f32 v119, v119
  v_exp_f32 v120, v120
  v_exp_f32 v121, v121
  s_waitcnt vmcnt(0)
  v_cmp_gt_u32 vcc, 16, v5
  s_cbranch_vccz L_toky
  s_mov_b32 s53, 0x40000
L_tpy:
  s_sleep 8
  v_lshlrev_b32 v5, 5, v1
  s_mov_b32 s49, 0x34800
  v_and_b32 v5, 0x780, v5
  buffer_load_dword v5, v5, s[44:47], s49 offen sc1
  s_sub_u32 s53, s53, 1
  s_cbranch_scc1 L_tpyx
  s_waitcnt vmcnt(0)
  v_cmp_gt_u32 vcc, 16, v5
  s_cbranch_vccnz L_tpy
L_tpyx:
L_toky:
  s_and_b32 s49, s48, 0xffffff80
  buffer_load_dword v23, v13, s[44:47], s49 offen sc1
  buffer_load_dwordx4 v[200:203], v7, s[44:47], s63 offen offset:0 sc1
  buffer_load_dword v204, v16, s[44:47], s62 offen offset:0 sc1
  buffer_load_dword v205, v16, s[44:47], s62 offen offset:1280 sc1
  buffer_load_dword v206, v16, s[44:47], s62 offen offset:2560 sc1
  buffer_load_dword v207, v16, s[44:47], s62 offen offset:3840 sc1
  buffer_load_dwordx4 v[208:211], v7, s[44:47], s63 offen offset:1024 sc1
  s_add_u32 s62, s62, 10240
  buffer_load_dword v212, v16, s[44:47], s62 offen offset:0 sc1
  buffer_load_dword v213, v16, s[44:47], s62 offen offset:1280 sc1
  buffer_load_dword v214, v16, s[44:47], s62 offen offset:2560 sc1
  buffer_load_dword v215, v16, s[44:47], s62 offen offset:3840 sc1
  v_exp_f32 v122, v122
  v_mfma_f32_32x32x4_2b_bf16 v[136:167], v[86:87], v[76:77], v[136:167]
  v_exp_f32 v123, v123
  v_exp_f32 v124, v124
  v_exp_f32 v125, v125
  v_exp_f32 v126, v126
  v_exp_f32 v127, v127
  v_exp_f32 v128, v128
  v_exp_f32 v129, v129
  s_mov_b64 exec, s[54:55]
  ds_read_b128 v[40:43], v10 offset:53760
  ds_read_b128 v[44:47], v10 offset:54400
  ds_read_b128 v[48:51], v10 offset:55040
  ds_read_b128 v[52:55], v10 offset:55680
  s_mov_b64 exec, -1
  v_exp_f32 v130, v130
  v_smfmac_f32_32x32x32_bf16 v[56:71], v[28:31], v[112:119], v6
  v_exp_f32 v131, v131
  v_exp_f32 v132, v132
  v_exp_f32 v133, v133
  v_smfmac_f32_32x32x32_bf16 v[56:71], v[32:35], v[120:127], v6
  v_exp_f32 v134, v134
  v_exp_f32 v135, v135
  s_waitcnt lgkmcnt(0)
  v_exp_f32 v136, v136
  v_exp_f32 v137, v137
  v_exp_f32 v138, v138
  v_smfmac_f32_32x32x32_bf16 v[56:71], v[36:39], v[128:135], v6
  v_exp_f32 v139, v139
  v_exp_f32 v140, v140
  v_exp_f32 v141, v141
  v_mfma_f32_32x32x16_bf16 v[104:119], v[96:99], v[72:75], v[168:183]
  v_exp_f32 v142, v142
  v_exp_f32 v143, v143
  v_exp_f32 v144, v144
  v_exp_f32 v145, v145
  v_mfma_f32_32x32x16_bf16 v[120:135], v[100:103], v[72:75], v[168:183]
  v_exp_f32 v146, v146
  v_exp_f32 v147, v147
  v_exp_f32 v148, v148
  ds_read_b128 v[88:91], v8 offset:2048
  ds_read_b128 v[92:95], v8 offset:3072
  v_exp_f32 v149, v149
  v_smfmac_f32_32x32x32_bf16 v[56:71], v[40:43], v[136:143], v6
  v_exp_f32 v150, v150
  v_exp_f32 v151, v151
  v_exp_f32 v152, v152
  v_exp_f32 v153, v153
  buffer_load_dwordx4 v[216:219], v7, s[44:47], s63 offen offset:2048 sc1
  s_add_u32 s62, s62, 10240
  buffer_load_dword v220, v16, s[44:47], s62 offen offset:0 sc1
  buffer_load_dword v221, v16, s[44:47], s62 offen offset:1280 sc1
  buffer_load_dword v222, v16, s[44:47], s62 offen offset:2560 sc1
  buffer_load_dword v223, v16, s[44:47], s62 offen offset:3840 sc1
  buffer_load_dwordx4 v[224:227], v7, s[44:47], s63 offen offset:3072 sc1
  s_add_u32 s62, s62, 10240
  buffer_load_dword v228, v16, s[44:47], s62 offen offset:0 sc1
  buffer_load_dword v229, v16, s[44:47], s62 offen offset:1280 sc1
  buffer_load_dword v230, v16, s[44:47], s62 offen offset:2560 sc1
  buffer_load_dword v231, v16, s[44:47], s62 offen offset:3840 sc1
  v_exp_f32 v154, v154
  v_mfma_f32_32x32x4_2b_bf16 v[104:135], v[80:81], v[76:77], v[104:135]
  v_exp_f32 v155, v155
  v_exp_f32 v156, v156
  v_exp_f32 v157, v157
  v_exp_f32 v158, v158
  v_exp_f32 v159, v159
  v_exp_f32 v160, v160
  v_exp_f32 v161, v161
  s_mov_b64 exec, s[54:55]
  ds_read_b128 v[24:27], v11 offset:0
  ds_read_b128 v[28:31], v11 offset:640
  ds_read_b128 v[32:35], v11 offset:1280
  ds_read_b128 v[36:39], v11 offset:1920
  s_mov_b64 exec, -1
  v_exp_f32 v162, v162
  v_smfmac_f32_32x32x32_bf16 v[56:71], v[44:47], v[144:151], v6
  v_exp_f32 v163, v163
  v_exp_f32 v164, v164
  v_exp_f32 v165, v165
  v_smfmac_f32_32x32x32_bf16 v[56:71], v[48:51], v[152:159], v6
  v_exp_f32 v166, v166
  v_exp_f32 v167, v167
  s_waitcnt lgkmcnt(0)
  v_exp_f32 v104, v104
  v_exp_f32 v105, v105
  v_exp_f32 v106, v106
  v_smfmac_f32_32x32x32_bf16 v[56:71], v[52:55], v[160:167], v6
  v_exp_f32 v107, v107
  v_exp_f32 v108, v108
  v_exp_f32 v109, v109
  v_mfma_f32_32x32x16_bf16 v[136:151], v[88:91], v[72:75], v[168:183]
  v_exp_f32 v110, v110
  v_exp_f32 v111, v111
  v_exp_f32 v112, v112
  v_exp_f32 v113, v113
  v_mfma_f32_32x32x16_bf16 v[152:167], v[92:95], v[72:75], v[168:183]
  v_exp_f32 v114, v114
  v_exp_f32 v115, v115
  v_exp_f32 v116, v116
  ds_read_b128 v[96:99], v8 offset:10240
  ds_read_b128 v[100:103], v8 offset:11264
  ds_read2st64_b64 v[84:87], v13 offset0:148 offset1:149
  v_exp_f32 v117, v117
  v_smfmac_f32_32x32x32_bf16 v[56:71], v[24:27], v[104:111], v6
  v_exp_f32 v118, v118
  v_exp_f32 v119, v119
  v_exp_f32 v120, v120
  v_exp_f32 v121, v121
  v_exp_f32 v122, v122
  v_mfma_f32_32x32x4_2b_bf16 v[136:167], v[82:83], v[76:77], v[136:167]
  v_exp_f32 v123, v123
  v_exp_f32 v124, v124
  v_exp_f32 v125, v125
  v_exp_f32 v126, v126
  v_exp_f32 v127, v127
  v_exp_f32 v128, v128
  v_exp_f32 v129, v129
  s_mov_b64 exec, s[54:55]
  ds_read_b128 v[40:43], v11 offset:2560
  ds_read_b128 v[44:47], v11 offset:3200
  ds_read_b128 v[48:51], v11 offset:3840
  ds_read_b128 v[52:55], v11 offset:4480
  s_mov_b64 exec, -1
  v_exp_f32 v130, v130
  v_smfmac_f32_32x32x32_bf16 v[56:71], v[28:31], v[112:119], v6
  v_exp_f32 v131, v131
  v_exp_f32 v132, v132
  v_exp_f32 v133, v133
  v_smfmac_f32_32x32x32_bf16 v[56:71], v[32:35], v[120:127], v6
  v_exp_f32 v134, v134
  v_exp_f32 v135, v135
  s_waitcnt lgkmcnt(0)
  v_exp_f32 v136, v136
  v_exp_f32 v137, v137
  v_exp_f32 v138, v138
  v_smfmac_f32_32x32x32_bf16 v[56:71], v[36:39], v[128:135], v6
  v_exp_f32 v139, v139
  v_exp_f32 v140, v140
  v_exp_f32 v141, v141
  v_mfma_f32_32x32x16_bf16 v[104:119], v[96:99], v[72:75], v[168:183]
  v_exp_f32 v142, v142
  v_exp_f32 v143, v143
  v_exp_f32 v144, v144
  v_exp_f32 v145, v145
  v_mfma_f32_32x32x16_bf16 v[120:135], v[100:103], v[72:75], v[168:183]
  v_exp_f32 v146, v146
  v_exp_f32 v147, v147
  v_exp_f32 v148, v148
  ds_read_b128 v[88:91], v8 offset:12288
  ds_read_b128 v[92:95], v8 offset:13312
  v_exp_f32 v149, v149
  v_smfmac_f32_32x32x32_bf16 v[56:71], v[40:43], v[136:143], v6
  v_exp_f32 v150, v150
L_pad8:
  s_cbranch_execz L_pad10
  v_exp_f32 v151, v151
  s_waitcnt vmcnt(15)
  v_mfma_f32_32x32x16_bf16 v[184:199], v[204:207], v[200:203], 0
  s_add_u32 s63, s63, 4096
  buffer_load_dwordx4 v[200:203], v7, s[44:47], s63 offen offset:0 sc1
  s_add_u32 s62, s62, 10240
  buffer_load_dword v204, v16, s[44:47], s62 offen offset:0 sc1
  buffer_load_dword v205, v16, s[44:47], s62 offen offset:1280 sc1
  buffer_load_dword v206, v16, s[44:47], s62 offen offset:2560 sc1
  buffer_load_dword v207, v16, s[44:47], s62 offen offset:3840 sc1
  v_exp_f32 v152, v152
  v_exp_f32 v153, v153
  v_exp_f32 v154, v154
  v_mfma_f32_32x32x4_2b_bf16 v[104:135], v[84:85], v[76:77], v[104:135]
  v_exp_f32 v155, v155
  v_exp_f32 v156, v156
  v_exp_f32 v157, v157
  v_exp_f32 v158, v158
  v_exp_f32 v159, v159
  v_exp_f32 v160, v160
  v_exp_f32 v161, v161
  s_mov_b64 exec, s[54:55]
  ds_read_b128 v[24:27], v11 offset:10240
  ds_read_b128 v[28:31], v11 offset:10880
  ds_read_b128 v[32:35], v11 offset:11520
  ds_read_b128 v[36:39], v11 offset:12160
  s_mov_b64 exec, -1
  v_exp_f32 v162, v162
  v_smfmac_f32_32x32x32_bf16 v[56:71], v[44:47], v[144:151], v6
  v_exp_f32 v163, v163
  v_exp_f32 v164, v164
  v_exp_f32 v165, v165
  v_smfmac_f32_32x32x32_bf16 v[56:71], v[48:51], v[152:159], v6
  v_exp_f32 v166, v166
  v_exp_f32 v167, v167
  s_waitcnt lgkmcnt(0)
  v_exp_f32 v104, v104
  v_exp_f32 v105, v105
  v_exp_f32 v106, v106
  v_smfmac_f32_32x32x32_bf16 v[56:71], v[52:55], v[160:167], v6
  v_exp_f32 v107, v107
  v_exp_f32 v108, v108
  v_exp_f32 v109, v109
  v_mfma_f32_32x32x16_bf16 v[136:151], v[88:91], v[72:75], v[168:183]
  v_exp_f32 v110, v110
  v_exp_f32 v111, v111
  v_exp_f32 v112, v112
  v_exp_f32 v113, v113
  v_mfma_f32_32x32x16_bf16 v[152:167], v[92:95], v[72:75], v[168:183]
  v_exp_f32 v114, v114
  v_exp_f32 v115, v115
  v_exp_f32 v116, v116
  ds_read_b128 v[96:99], v8 offset:20480
  ds_read_b128 v[100:103], v8 offset:21504
  ds_read2st64_b64 v[80:83], v14 offset0:8 offset1:9
  v_exp_f32 v117, v117
  v_smfmac_f32_32x32x32_bf16 v[56:71], v[24:27], v[104:111], v6
  v_exp_f32 v118, v118
  v_exp_f32 v119, v119
  s_waitcnt vmcnt(15)
  v_mfma_f32_32x32x16_bf16 v[184:199], v[212:215], v[208:211], v[184:199]
  buffer_load_dwordx4 v[208:211], v7, s[44:47], s63 offen offset:1024 sc1
  s_add_u32 s62, s62, 10240
  buffer_load_dword v212, v16, s[44:47], s62 offen offset:0 sc1
  buffer_load_dword v213, v16, s[44:47], s62 offen offset:1280 sc1
  buffer_load_dword v214, v16, s[44:47], s62 offen offset:2560 sc1
  buffer_load_dword v215, v16, s[44:47], s62 offen offset:3840 sc1
  v_exp_f32 v120, v120
  v_exp_f32 v121, v121
  v_exp_f32 v122, v122
  v_mfma_f32_32x32x4_2b_bf16 v[136:167], v[86:87], v[76:77], v[136:167]
  v_exp_f32 v123, v123
  v_exp_f32 v124, v124
  v_exp_f32 v125, v125
  v_exp_f32 v126, v126
  v_exp_f32 v127, v127
  v_exp_f32 v128, v128
  v_exp_f32 v129, v129
  s_mov_b64 exec, s[54:55]
  ds_read_b128 v[40:43], v11 offset:12800
  ds_read_b128 v[44:47], v11 offset:13440
  ds_read_b128 v[48:51], v11 offset:14080
  ds_read_b128 v[52:55], v11 offset:14720
  s_mov_b64 exec, -1
  v_exp_f32 v130, v130
  v_smfmac_f32_32x32x32_bf16 v[56:71], v[28:31], v[112:119], v6
  v_exp_f32 v131, v131
  v_exp_f32 v132, v132
  v_exp_f32 v133, v133
  v_smfmac_f32_32x32x32_bf16 v[56:71], v[32:35], v[120:127], v6
  v_exp_f32 v134, v134
  v_exp_f32 v135, v135
  s_waitcnt lgkmcnt(0)
  v_exp_f32 v136, v136
  v_exp_f32 v137, v137
  v_exp_f32 v138, v138
  v_smfmac_f32_32x32x32_bf16 v[56:71], v[36:39], v[128:135], v6
  v_exp_f32 v139, v139
  v_exp_f32 v140, v140
  v_exp_f32 v141, v141
  v_mfma_f32_32x32x16_bf16 v[104:119], v[96:99], v[72:75], v[168:183]
  v_exp_f32 v142, v142
  v_exp_f32 v143, v143
  v_exp_f32 v144, v144
  v_exp_f32 v145, v145
  v_mfma_f32_32x32x16_bf16 v[120:135], v[100:103], v[72:75], v[168:183]
  v_exp_f32 v146, v146
  v_exp_f32 v147, v147
  v_exp_f32 v148, v148
  ds_read_b128 v[88:91], v8 offset:22528
  ds_read_b128 v[92:95], v8 offset:23552
  v_exp_f32 v149, v149
  v_smfmac_f32_32x32x32_bf16 v[56:71], v[40:43], v[136:143], v6
  v_exp_f32 v150, v150
  v_exp_f32 v151, v151
  s_waitcnt vmcnt(15)
  v_mfma_f32_32x32x16_bf16 v[184:199], v[220:223], v[216:219], v[184:199]
  buffer_load_dwordx4 v[216:219], v7, s[44:47], s63 offen offset:2048 sc1
  s_add_u32 s62, s62, 10240
  buffer_load_dword v220, v16, s[44:47], s62 offen offset:0 sc1
  buffer_load_dword v221, v16, s[44:47], s62 offen offset:1280 sc1
  buffer_load_dword v222, v16, s[44:47], s62 offen offset:2560 sc1
  buffer_load_dword v223, v16, s[44:47], s62 offen offset:3840 sc1
  v_exp_f32 v152, v152
  v_exp_f32 v153, v153
  v_exp_f32 v154, v154
  v_mfma_f32_32x32x4_2b_bf16 v[104:135], v[80:81], v[76:77], v[104:135]
  v_exp_f32 v155, v155
  v_exp_f32 v156, v156
  v_exp_f32 v157, v157
  v_exp_f32 v158, v158
  v_exp_f32 v159, v159
  v_exp_f32 v160, v160
  v_exp_f32 v161, v161
  s_mov_b64 exec, s[54:55]
  ds_read_b128 v[24:27], v11 offset:20480
  ds_read_b128 v[28:31], v11 offset:21120
  ds_read_b128 v[32:35], v11 offset:21760
  ds_read_b128 v[36:39], v11 offset:22400
  s_mov_b64 exec, -1
  v_exp_f32 v162, v162
  v_smfmac_f32_32x32x32_bf16 v[56:71], v[44:47], v[144:151], v6
  v_exp_f32 v163, v163
  v_exp_f32 v164, v164
  v_exp_f32 v165, v165
  v_smfmac_f32_32x32x32_bf16 v[56:71], v[48:51], v[152:159], v6
  v_exp_f32 v166, v166
  v_exp_f32 v167, v167
  s_waitcnt lgkmcnt(0)
  v_exp_f32 v104, v104
  v_exp_f32 v105, v105
  v_exp_f32 v106, v106
  v_smfmac_f32_32x32x32_bf16 v[56:71], v[52:55], v[160:167], v6
  v_exp_f32 v107, v107
  v_exp_f32 v108, v108
  v_exp_f32 v109, v109
  v_mfma_f32_32x32x16_bf16 v[136:151], v[88:91], v[72:75], v[168:183]
  v_exp_f32 v110, v110
  v_exp_f32 v111, v111
  v_exp_f32 v112, v112
  v_exp_f32 v113, v113
  v_mfma_f32_32x32x16_bf16 v[152:167], v[92:95], v[72:75], v[168:183]
  v_exp_f32 v114, v114
  v_exp_f32 v115, v115
  v_exp_f32 v116, v116
  ds_read_b128 v[96:99], v8 offset:30720
  ds_read_b128 v[100:103], v8 offset:31744
  ds_read2st64_b64 v[84:87], v14 offset0:28 offset1:29
  v_exp_f32 v117, v117
  v_smfmac_f32_32x32x32_bf16 v[56:71], v[24:27], v[104:111], v6
  v_exp_f32 v118, v118
  v_exp_f32 v119, v119
  s_waitcnt vmcnt(15)
  v_mfma_f32_32x32x16_bf16 v[184:199], v[228:231], v[224:227], v[184:199]
  buffer_load_dwordx4 v[224:227], v7, s[44:47], s63 offen offset:3072 sc1
  s_add_u32 s62, s62, 10240
  buffer_load_dword v228, v16, s[44:47], s62 offen offset:0 sc1
  buffer_load_dword v229, v16, s[44:47], s62 offen offset:1280 sc1
  buffer_load_dword v230, v16, s[44:47], s62 offen offset:2560 sc1
  buffer_load_dword v231, v16, s[44:47], s62 offen offset:3840 sc1
  v_exp_f32 v120, v120
  v_exp_f32 v121, v121
  v_exp_f32 v122, v122
  v_mfma_f32_32x32x4_2b_bf16 v[136:167], v[82:83], v[76:77], v[136:167]
  v_exp_f32 v123, v123
  v_exp_f32 v124, v124
  v_exp_f32 v125, v125
  v_exp_f32 v126, v126
  v_exp_f32 v127, v127
  v_exp_f32 v128, v128
  v_exp_f32 v129, v129
  s_mov_b64 exec, s[54:55]
  ds_read_b128 v[40:43], v11 offset:23040
  ds_read_b128 v[44:47], v11 offset:23680
  ds_read_b128 v[48:51], v11 offset:24320
  ds_read_b128 v[52:55], v11 offset:24960
  s_mov_b64 exec, -1
  v_exp_f32 v130, v130
  v_smfmac_f32_32x32x32_bf16 v[56:71], v[28:31], v[112:119], v6
  v_exp_f32 v131, v131
  v_exp_f32 v132, v132
  v_exp_f32 v133, v133
  v_smfmac_f32_32x32x32_bf16 v[56:71], v[32:35], v[120:127], v6
  v_exp_f32 v134, v134
  v_exp_f32 v135, v135
  s_setprio 2
  s_waitcnt lgkmcnt(0)
  v_exp_f32 v136, v136
  v_exp_f32 v137, v137
  v_exp_f32 v138, v138
  v_smfmac_f32_32x32x32_bf16 v[56:71], v[36:39], v[128:135], v6
  v_exp_f32 v139, v139
  v_exp_f32 v140, v140
  v_exp_f32 v141, v141
  v_mfma_f32_32x32x16_bf16 v[104:119], v[96:99], v[72:75], v[168:183]
  v_exp_f32 v142, v142
  v_exp_f32 v143, v143
  v_exp_f32 v144, v144
  v_exp_f32 v145, v145
  v_mfma_f32_32x32x16_bf16 v[120:135], v[100:103], v[72:75], v[168:183]
  v_exp_f32 v146, v146
  v_exp_f32 v147, v147
  v_exp_f32 v148, v148
  ds_read_b128 v[88:91], v8 offset:32768
  ds_read_b128 v[92:95], v8 offset:33792
  v_exp_f32 v149, v149
  v_smfmac_f32_32x32x32_bf16 v[56:71], v[40:43], v[136:143], v6
  v_exp_f32 v150, v150
  v_exp_f32 v151, v151
  s_waitcnt vmcnt(15)
  v_mfma_f32_32x32x16_bf16 v[184:199], v[204:207], v[200:203], v[184:199]
  v_exp_f32 v152, v152
  v_exp_f32 v153, v153
  v_exp_f32 v154, v154
  v_mfma_f32_32x32x4_2b_bf16 v[104:135], v[84:85], v[76:77], v[104:135]
  v_exp_f32 v155, v155
  v_exp_f32 v156, v156
  v_exp_f32 v157, v157
  v_exp_f32 v158, v158
  v_exp_f32 v159, v159
  v_exp_f32 v160, v160
  v_exp_f32 v161, v161
  s_mov_b64 exec, s[54:55]
  ds_read_b128 v[24:27], v11 offset:30720
  ds_read_b128 v[28:31], v11 offset:31360
  ds_read_b128 v[32:35], v11 offset:32000
  ds_read_b128 v[36:39], v11 offset:32640
  s_mov_b64 exec, -1
  v_exp_f32 v162, v162
  v_smfmac_f32_32x32x32_bf16 v[56:71], v[44:47], v[144:151], v6
  v_exp_f32 v163, v163
  v_exp_f32 v164, v164
  v_exp_f32 v165, v165
  v_smfmac_f32_32x32x32_bf16 v[56:71], v[48:51], v[152:159], v6
  v_exp_f32 v166, v166
  v_exp_f32 v167, v167
  s_waitcnt lgkmcnt(0)
  v_exp_f32 v104, v104
  v_exp_f32 v105, v105
  v_exp_f32 v106, v106
  v_smfmac_f32_32x32x32_bf16 v[56:71], v[52:55], v[160:167], v6
  v_exp_f32 v107, v107
  v_exp_f32 v108, v108
  v_exp_f32 v109, v109
  v_mfma_f32_32x32x16_bf16 v[136:151], v[88:91], v[72:75], v[168:183]
  v_exp_f32 v110, v110
  v_exp_f32 v111, v111
  v_exp_f32 v112, v112
  v_exp_f32 v113, v113
  v_mfma_f32_32x32x16_bf16 v[152:167], v[92:95], v[72:75], v[168:183]
  v_exp_f32 v114, v114
  v_exp_f32 v115, v115
  v_exp_f32 v116, v116
  ds_read_b128 v[96:99], v8 offset:40960
  ds_read_b128 v[100:103], v8 offset:41984
  ds_read2st64_b64 v[80:83], v14 offset0:48 offset1:49
  v_exp_f32 v117, v117
  v_smfmac_f32_32x32x32_bf16 v[56:71], v[24:27], v[104:111], v6
  v_exp_f32 v118, v118
  v_exp_f32 v119, v119
  s_waitcnt vmcnt(10)
  v_mfma_f32_32x32x16_bf16 v[184:199], v[212:215], v[208:211], v[184:199]
  v_exp_f32 v120, v120
  v_exp_f32 v121, v121
  v_exp_f32 v122, v122
  v_mfma_f32_32x32x4_2b_bf16 v[136:167], v[86:87], v[76:77], v[136:167]
  v_exp_f32 v123, v123
  v_exp_f32 v124, v124
  v_exp_f32 v125, v125
  v_exp_f32 v126, v126
  v_exp_f32 v127, v127
  v_exp_f32 v128, v128
  v_exp_f32 v129, v129
  s_mov_b64 exec, s[54:55]
  ds_read_b128 v[40:43], v11 offset:33280
  ds_read_b128 v[44:47], v11 offset:33920
  ds_read_b128 v[48:51], v11 offset:34560
  ds_read_b128 v[52:55], v11 offset:35200
  s_mov_b64 exec, -1
  v_exp_f32 v130, v130
  v_smfmac_f32_32x32x32_bf16 v[56:71], v[28:31], v[112:119], v6
  v_exp_f32 v131, v131
  v_exp_f32 v132, v132
  v_exp_f32 v133, v133
  v_smfmac_f32_32x32x32_bf16 v[56:71], v[32:35], v[120:127], v6
  v_exp_f32 v134, v134
  v_exp_f32 v135, v135
  s_setprio 1
  s_waitcnt lgkmcnt(0)
  v_exp_f32 v136, v136
  v_exp_f32 v137, v137
  v_exp_f32 v138, v138
  v_smfmac_f32_32x32x32_bf16 v[56:71], v[36:39], v[128:135], v6
  v_exp_f32 v139, v139
  v_exp_f32 v140, v140
  v_exp_f32 v141, v141
  v_mfma_f32_32x32x16_bf16 v[104:119], v[96:99], v[72:75], v[168:183]
  v_exp_f32 v142, v142
  v_exp_f32 v143, v143
  v_exp_f32 v144, v144
  v_exp_f32 v145, v145
  v_mfma_f32_32x32x16_bf16 v[120:135], v[100:103], v[72:75], v[168:183]
  v_exp_f32 v146, v146
  v_exp_f32 v147, v147
  v_exp_f32 v148, v148
  ds_read_b128 v[88:91], v8 offset:43008
  ds_read_b128 v[92:95], v8 offset:44032
  v_exp_f32 v149, v149
  v_smfmac_f32_32x32x32_bf16 v[56:71], v[40:43], v[136:143], v6
  v_exp_f32 v150, v150
  v_exp_f32 v151, v151
  s_waitcnt vmcnt(5)
  v_mfma_f32_32x32x16_bf16 v[184:199], v[220:223], v[216:219], v[184:199]
  v_exp_f32 v152, v152
  v_exp_f32 v153, v153
  v_exp_f32 v154, v154
  v_mfma_f32_32x32x4_2b_bf16 v[104:135], v[80:81], v[76:77], v[104:135]
  v_exp_f32 v155, v155
  v_exp_f32 v156, v156
  v_exp_f32 v157, v157
  v_exp_f32 v158, v158
  v_exp_f32 v159, v159
  v_exp_f32 v160, v160
  v_exp_f32 v161, v161
  s_mov_b64 exec, s[54:55]
  ds_read_b128 v[24:27], v11 offset:40960
  ds_read_b128 v[28:31], v11 offset:41600
  ds_read_b128 v[32:35], v11 offset:42240
  ds_read_b128 v[36:39], v11 offset:42880
  s_mov_b64 exec, -1
  v_exp_f32 v162, v162
  v_smfmac_f32_32x32x32_bf16 v[56:71], v[44:47], v[144:151], v6
  v_exp_f32 v163, v163
  v_exp_f32 v164, v164
  v_exp_f32 v165, v165
  v_smfmac_f32_32x32x32_bf16 v[56:71], v[48:51], v[152:159], v6
  v_exp_f32 v166, v166
  v_exp_f32 v167, v167
  s_setprio 0
  s_waitcnt lgkmcnt(0)
  v_exp_f32 v104, v104
  v_exp_f32 v105, v105
  v_exp_f32 v106, v106
  v_smfmac_f32_32x32x32_bf16 v[56:71], v[52:55], v[160:167], v6
  v_exp_f32 v107, v107
  v_exp_f32 v108, v108
  v_exp_f32 v109, v109
  v_mfma_f32_32x32x16_bf16 v[136:151], v[88:91], v[72:75], v[168:183]
  v_exp_f32 v110, v110
  v_exp_f32 v111, v111
  v_exp_f32 v112, v112
  v_exp_f32 v113, v113
  v_mfma_f32_32x32x16_bf16 v[152:167], v[92:95], v[72:75], v[168:183]
  v_exp_f32 v114, v114
  v_exp_f32 v115, v115
  v_exp_f32 v116, v116
  ds_read_b128 v[96:99], v8 offset:51200
  ds_read_b128 v[100:103], v8 offset:52224
  ds_read2st64_b64 v[84:87], v14 offset0:68 offset1:69
  v_exp_f32 v117, v117
  v_smfmac_f32_32x32x32_bf16 v[56:71], v[24:27], v[104:111], v6
  v_exp_f32 v118, v118
  v_exp_f32 v119, v119
  s_waitcnt vmcnt(0)
  v_mfma_f32_32x32x16_bf16 v[184:199], v[228:231], v[224:227], v[184:199]
  v_exp_f32 v120, v120
  v_exp_f32 v121, v121
  v_exp_f32 v122, v122
  v_mfma_f32_32x32x4_2b_bf16 v[136:167], v[82:83], v[76:77], v[136:167]
  v_exp_f32 v123, v123
  v_exp_f32 v124, v124
  v_exp_f32 v125, v125
  v_exp_f32 v126, v126
  v_exp_f32 v127, v127
  v_exp_f32 v128, v128
  v_exp_f32 v129, v129
  s_mov_b64 exec, s[54:55]
  ds_read_b128 v[40:43], v11 offset:43520
  ds_read_b128 v[44:47], v11 offset:44160
  ds_read_b128 v[48:51], v11 offset:44800
  ds_read_b128 v[52:55], v11 offset:45440
  s_mov_b64 exec, -1
  v_exp_f32 v130, v130
  v_smfmac_f32_32x32x32_bf16 v[56:71], v[28:31], v[112:119], v6
  v_exp_f32 v131, v131
  v_exp_f32 v132, v132
  v_exp_f32 v133, v133
  v_smfmac_f32_32x32x32_bf16 v[56:71], v[32:35], v[120:127], v6
  v_exp_f32 v134, v134
  v_exp_f32 v135, v135
  s_setprio 3
  s_waitcnt lgkmcnt(0)
  s_barrier
  v_exp_f32 v136, v136
  v_exp_f32 v137, v137
  v_exp_f32 v138, v138
  v_smfmac_f32_32x32x32_bf16 v[56:71], v[36:39], v[128:135], v6
  v_exp_f32 v139, v139
  v_exp_f32 v140, v140
  v_exp_f32 v141, v141
  v_mfma_f32_32x32x16_bf16 v[104:119], v[96:99], v[72:75], v[168:183]
  v_exp_f32 v142, v142
  v_exp_f32 v143, v143
  v_exp_f32 v144, v144
  v_exp_f32 v145, v145
  v_mfma_f32_32x32x16_bf16 v[120:135], v[100:103], v[72:75], v[168:183]
  v_exp_f32 v146, v146
  v_exp_f32 v147, v147
  v_exp_f32 v148, v148
  ds_read_b128 v[88:91], v8 offset:53248
  ds_read_b128 v[92:95], v8 offset:54272
  v_exp_f32 v149, v149
  v_smfmac_f32_32x32x32_bf16 v[56:71], v[40:43], v[136:143], v6
  v_exp_f32 v150, v150
  v_exp_f32 v151, v151
  v_exp_f32 v152, v152
  v_exp_f32 v153, v153
  s_waitcnt vmcnt(0)
  v_and_b32 v23, 15, v23
  v_cmp_ne_u32 vcc, s81, v23
  s_and_b32 s80, vcc_lo, 0xff
  v_cvt_pk_bf16_f32 v200, v184, v185
  v_cvt_pk_bf16_f32 v201, v186, v187
  v_cvt_pk_bf16_f32 v202, v188, v189
  v_cvt_pk_bf16_f32 v203, v190, v191
  v_cvt_pk_bf16_f32 v204, v192, v193
  v_cvt_pk_bf16_f32 v205, v194, v195
  v_cvt_pk_bf16_f32 v206, v196, v197
  v_cvt_pk_bf16_f32 v207, v198, v199
  v_cvt_pk_bf16_f32 v208, v198, v197
  v_cvt_pk_bf16_f32 v209, v196, v195
  v_cvt_pk_bf16_f32 v210, v194, v193
  v_cvt_pk_bf16_f32 v211, v192, v191
  v_cvt_pk_bf16_f32 v212, v190, v189
  v_cvt_pk_bf16_f32 v213, v188, v187
  v_cvt_pk_bf16_f32 v214, v186, v185
  v_exp_f32 v154, v154
  v_mfma_f32_32x32x4_2b_bf16 v[104:135], v[84:85], v[76:77], v[104:135]
  v_exp_f32 v155, v155
  v_exp_f32 v156, v156
  v_exp_f32 v157, v157
  v_exp_f32 v158, v158
  v_exp_f32 v159, v159
  v_exp_f32 v160, v160
  v_exp_f32 v161, v161
  s_mov_b64 exec, s[54:55]
  ds_read_b128 v[24:27], v11 offset:51200
  ds_read_b128 v[28:31], v11 offset:51840
  ds_read_b128 v[32:35], v11 offset:52480
  ds_read_b128 v[36:39], v11 offset:53120
  s_mov_b64 exec, -1
  v_exp_f32 v162, v162
  v_smfmac_f32_32x32x32_bf16 v[56:71], v[44:47], v[144:151], v6
  v_exp_f32 v163, v163
  v_exp_f32 v164, v164
  v_exp_f32 v165, v165
  v_smfmac_f32_32x32x32_bf16 v[56:71], v[48:51], v[152:159], v6
  v_exp_f32 v166, v166
  v_exp_f32 v167, v167
  s_waitcnt lgkmcnt(0)
  v_exp_f32 v104, v104
  v_exp_f32 v105, v105
  v_exp_f32 v106, v106
  v_smfmac_f32_32x32x32_bf16 v[56:71], v[52:55], v[160:167], v6
  v_exp_f32 v107, v107
  v_exp_f32 v108, v108
  v_exp_f32 v109, v109
  v_mfma_f32_32x32x16_bf16 v[136:151], v[88:91], v[72:75], v[168:183]
  v_exp_f32 v110, v110
  v_exp_f32 v111, v111
  v_exp_f32 v112, v112
  v_exp_f32 v113, v113
  v_mfma_f32_32x32x16_bf16 v[152:167], v[92:95], v[72:75], v[168:183]
  v_exp_f32 v114, v114
  v_exp_f32 v115, v115
  v_exp_f32 v116, v116
  ds_read_b128 v[96:99], v9 offset:0
  ds_read_b128 v[100:103], v9 offset:1024
  ds_read2st64_b64 v[80:83], v14 offset0:88 offset1:89
  v_exp_f32 v117, v117
  v_smfmac_f32_32x32x32_bf16 v[56:71], v[24:27], v[104:111], v6
  v_exp_f32 v118, v118
  v_exp_f32 v119, v119
  v_exp_f32 v120, v120
  v_exp_f32 v121, v121
  v_exp_f32 v122, v122
  v_mfma_f32_32x32x4_2b_bf16 v[136:167], v[86:87], v[76:77], v[136:167]
  v_exp_f32 v123, v123
  v_exp_f32 v124, v124
  v_exp_f32 v125, v125
  v_exp_f32 v126, v126
  v_exp_f32 v127, v127
  v_exp_f32 v128, v128
  v_exp_f32 v129, v129
  s_mov_b64 exec, s[54:55]
  ds_read_b128 v[40:43], v11 offset:53760
  ds_read_b128 v[44:47], v11 offset:54400
  ds_read_b128 v[48:51], v11 offset:55040
  ds_read_b128 v[52:55], v11 offset:55680
  s_mov_b64 exec, -1
  v_exp_f32 v130, v130
  v_smfmac_f32_32x32x32_bf16 v[56:71], v[28:31], v[112:119], v6
  v_exp_f32 v131, v131
  v_exp_f32 v132, v132
  v_exp_f32 v133, v133
  v_smfmac_f32_32x32x32_bf16 v[56:71], v[32:35], v[120:127], v6
  v_exp_f32 v134, v134
  v_exp_f32 v135, v135
  s_waitcnt lgkmcnt(0)
  v_exp_f32 v136, v136
  v_exp_f32 v137, v137
  v_exp_f32 v138, v138
  v_smfmac_f32_32x32x32_bf16 v[56:71], v[36:39], v[128:135], v6
  v_exp_f32 v139, v139
  v_exp_f32 v140, v140
  v_exp_f32 v141, v141
  v_mfma_f32_32x32x16_bf16 v[104:119], v[96:99], v[72:75], v[168:183]
  v_exp_f32 v142, v142
  v_exp_f32 v143, v143
  v_exp_f32 v144, v144
  v_exp_f32 v145, v145
  v_mfma_f32_32x32x16_bf16 v[120:135], v[100:103], v[72:75], v[168:183]
  v_exp_f32 v146, v146
  v_exp_f32 v147, v147
  v_exp_f32 v148, v148
  ds_read_b128 v[88:91], v9 offset:2048
  ds_read_b128 v[92:95], v9 offset:3072
  v_exp_f32 v149, v149
  v_smfmac_f32_32x32x32_bf16 v[56:71], v[40:43], v[136:143], v6
  v_exp_f32 v150, v150
  v_exp_f32 v151, v151
  v_exp_f32 v152, v152
  v_exp_f32 v153, v153
  v_exp_f32 v154, v154
  v_mfma_f32_32x32x4_2b_bf16 v[104:135], v[80:81], v[76:77], v[104:135]
  v_exp_f32 v155, v155
  v_exp_f32 v156, v156
  v_exp_f32 v157, v157
  v_exp_f32 v158, v158
  v_exp_f32 v159, v159
  v_exp_f32 v160, v160
  v_exp_f32 v161, v161
  s_mov_b64 exec, s[54:55]
  ds_read_b128 v[24:27], v12 offset:0
  ds_read_b128 v[28:31], v12 offset:640
  ds_read_b128 v[32:35], v12 offset:1280
  ds_read_b128 v[36:39], v12 offset:1920
  s_mov_b64 exec, -1
  v_exp_f32 v162, v162
  v_smfmac_f32_32x32x32_bf16 v[56:71], v[44:47], v[144:151], v6
  v_exp_f32 v163, v163
  v_exp_f32 v164, v164
  v_exp_f32 v165, v165
  v_smfmac_f32_32x32x32_bf16 v[56:71], v[48:51], v[152:159], v6
  v_exp_f32 v166, v166
  v_exp_f32 v167, v167
  s_waitcnt lgkmcnt(0)
  v_exp_f32 v104, v104
  v_exp_f32 v105, v105
  v_exp_f32 v106, v106
  v_smfmac_f32_32x32x32_bf16 v[56:71], v[52:55], v[160:167], v6
  v_exp_f32 v107, v107
  v_exp_f32 v108, v108
  v_exp_f32 v109, v109
  v_mfma_f32_32x32x16_bf16 v[136:151], v[88:91], v[72:75], v[168:183]
  v_exp_f32 v110, v110
  v_exp_f32 v111, v111
  v_exp_f32 v112, v112
  v_exp_f32 v113, v113
  v_mfma_f32_32x32x16_bf16 v[152:167], v[92:95], v[72:75], v[168:183]
  v_exp_f32 v114, v114
  v_exp_f32 v115, v115
  v_exp_f32 v116, v116
  ds_read_b128 v[96:99], v9 offset:10240
  ds_read_b128 v[100:103], v9 offset:11264
  ds_read2st64_b64 v[84:87], v14 offset0:108 offset1:109
  v_exp_f32 v117, v117
  v_smfmac_f32_32x32x32_bf16 v[56:71], v[24:27], v[104:111], v6
  v_exp_f32 v118, v118
  v_exp_f32 v119, v119
  v_exp_f32 v120, v120
  v_exp_f32 v121, v121
  v_exp_f32 v122, v122
  v_mfma_f32_32x32x4_2b_bf16 v[136:167], v[82:83], v[76:77], v[136:167]
  v_exp_f32 v123, v123
  v_exp_f32 v124, v124
  v_exp_f32 v125, v125
  v_exp_f32 v126, v126
  v_exp_f32 v127, v127
  v_exp_f32 v128, v128
  v_exp_f32 v129, v129
  s_mov_b64 exec, s[54:55]
  ds_read_b128 v[40:43], v12 offset:2560
  ds_read_b128 v[44:47], v12 offset:3200
  ds_read_b128 v[48:51], v12 offset:3840
  ds_read_b128 v[52:55], v12 offset:4480
  s_mov_b64 exec, -1
  v_exp_f32 v130, v130
  v_smfmac_f32_32x32x32_bf16 v[56:71], v[28:31], v[112:119], v6
  v_exp_f32 v131, v131
  v_exp_f32 v132, v132
  v_exp_f32 v133, v133
  v_smfmac_f32_32x32x32_bf16 v[56:71], v[32:35], v[120:127], v6
  v_exp_f32 v134, v134
  v_exp_f32 v135, v135
  buffer_store_dwordx4 v[200:203], v15, s[40:43], 0 offen offset:0 nt
  buffer_store_dwordx4 v[204:207], v15, s[40:43], 0 offen offset:16 nt
  s_waitcnt lgkmcnt(0)
  v_exp_f32 v136, v136
  v_exp_f32 v137, v137
  v_exp_f32 v138, v138
  v_smfmac_f32_32x32x32_bf16 v[56:71], v[36:39], v[128:135], v6
  v_exp_f32 v139, v139
  v_exp_f32 v140, v140
  v_exp_f32 v141, v141
  v_mfma_f32_32x32x16_bf16 v[104:119], v[96:99], v[72:75], v[168:183]
  v_exp_f32 v142, v142
  v_exp_f32 v143, v143
  v_exp_f32 v144, v144
  v_exp_f32 v145, v145
  v_mfma_f32_32x32x16_bf16 v[120:135], v[100:103], v[72:75], v[168:183]
  v_exp_f32 v146, v146
  v_exp_f32 v147, v147
  v_exp_f32 v148, v148
  ds_read_b128 v[88:91], v9 offset:12288
  ds_read_b128 v[92:95], v9 offset:13312
  v_exp_f32 v149, v149
  v_smfmac_f32_32x32x32_bf16 v[56:71], v[40:43], v[136:143], v6
  v_exp_f32 v150, v150
  v_exp_f32 v151, v151
  v_exp_f32 v152, v152
  v_exp_f32 v153, v153
  v_exp_f32 v154, v154
  v_mfma_f32_32x32x4_2b_bf16 v[104:135], v[84:85], v[76:77], v[104:135]
  v_exp_f32 v155, v155
  v_exp_f32 v156, v156
  v_exp_f32 v157, v157
  v_exp_f32 v158, v158
  v_exp_f32 v159, v159
  v_exp_f32 v160, v160
  v_exp_f32 v161, v161
  s_mov_b64 exec, s[54:55]
  ds_read_b128 v[24:27], v12 offset:10240
  ds_read_b128 v[28:31], v12 offset:10880
  ds_read_b128 v[32:35], v12 offset:11520
  ds_read_b128 v[36:39], v12 offset:12160
  s_mov_b64 exec, -1
  v_exp_f32 v162, v162
  v_smfmac_f32_32x32x32_bf16 v[56:71], v[44:47], v[144:151], v6
  v_exp_f32 v163, v163
  v_exp_f32 v164, v164
  v_exp_f32 v165, v165
  v_smfmac_f32_32x32x32_bf16 v[56:71], v[48:51], v[152:159], v6
  v_exp_f32 v166, v166
  v_exp_f32 v167, v167
  buffer_store_dwordx4 v[208:211], v17, s[40:43], 0 offen offset:4 nt
  buffer_store_dwordx3 v[212:214], v17, s[40:43], 0 offen offset:20 nt
  s_waitcnt lgkmcnt(0)
  v_exp_f32 v104, v104
  v_exp_f32 v105, v105
  v_exp_f32 v106, v106
  v_smfmac_f32_32x32x32_bf16 v[56:71], v[52:55], v[160:167], v6
  v_exp_f32 v107, v107
  v_exp_f32 v108, v108
  v_exp_f32 v109, v109
  v_mfma_f32_32x32x16_bf16 v[136:151], v[88:91], v[72:75], v[168:183]
  v_exp_f32 v110, v110
  v_exp_f32 v111, v111
  v_exp_f32 v112, v112
  v_exp_f32 v113, v113
  v_mfma_f32_32x32x16_bf16 v[152:167], v[92:95], v[72:75], v[168:183]
  v_exp_f32 v114, v114
  v_exp_f32 v115, v115
  v_exp_f32 v116, v116
  ds_read_b128 v[96:99], v9 offset:20480
  ds_read_b128 v[100:103], v9 offset:21504
  ds_read2st64_b64 v[80:83], v14 offset0:128 offset1:129
  v_exp_f32 v117, v117
  v_smfmac_f32_32x32x32_bf16 v[56:71], v[24:27], v[104:111], v6
  v_exp_f32 v118, v118
  v_exp_f32 v119, v119
  v_exp_f32 v120, v120
  v_exp_f32 v121, v121
  v_exp_f32 v122, v122
  v_mfma_f32_32x32x4_2b_bf16 v[136:167], v[86:87], v[76:77], v[136:167]
  v_exp_f32 v123, v123
  v_exp_f32 v124, v124
  v_exp_f32 v125, v125
  v_exp_f32 v126, v126
  v_exp_f32 v127, v127
  v_exp_f32 v128, v128
  v_exp_f32 v129, v129
  s_mov_b64 exec, s[54:55]
  ds_read_b128 v[40:43], v12 offset:12800
  ds_read_b128 v[44:47], v12 offset:13440
  ds_read_b128 v[48:51], v12 offset:14080
  ds_read_b128 v[52:55], v12 offset:14720
  s_mov_b64 exec, -1
  v_exp_f32 v130, v130
  v_smfmac_f32_32x32x32_bf16 v[56:71], v[28:31], v[112:119], v6
  v_exp_f32 v131, v131
  v_exp_f32 v132, v132
  v_exp_f32 v133, v133
  v_smfmac_f32_32x32x32_bf16 v[56:71], v[32:35], v[120:127], v6
  v_exp_f32 v134, v134
  v_exp_f32 v135, v135
  buffer_store_short_d16_hi v207, v17, s[40:43], 0 offen offset:2 nt
  buffer_store_short v200, v18, s[40:43], 0 offen offset:32 nt
  s_setprio 2
  s_waitcnt lgkmcnt(0)
  v_exp_f32 v136, v136
  v_exp_f32 v137, v137
  v_exp_f32 v138, v138
  v_smfmac_f32_32x32x32_bf16 v[56:71], v[36:39], v[128:135], v6
  v_exp_f32 v139, v139
  v_exp_f32 v140, v140
  v_exp_f32 v141, v141
  v_mfma_f32_32x32x16_bf16 v[104:119], v[96:99], v[72:75], v[168:183]
  v_exp_f32 v142, v142
  v_exp_f32 v143, v143
  v_exp_f32 v144, v144
  v_exp_f32 v145, v145
  v_mfma_f32_32x32x16_bf16 v[120:135], v[100:103], v[72:75], v[168:183]
  v_exp_f32 v146, v146
  v_exp_f32 v147, v147
  v_exp_f32 v148, v148
  ds_read_b128 v[88:91], v9 offset:22528
  ds_read_b128 v[92:95], v9 offset:23552
  v_exp_f32 v149, v149
  v_smfmac_f32_32x32x32_bf16 v[56:71], v[40:43], v[136:143], v6
  v_exp_f32 v150, v150
  v_exp_f32 v151, v151
  v_exp_f32 v152, v152
  v_exp_f32 v153, v153
  v_exp_f32 v154, v154
  v_mfma_f32_32x32x4_2b_bf16 v[104:135], v[80:81], v[76:77], v[104:135]
  v_exp_f32 v155, v155
  v_exp_f32 v156, v156
  v_exp_f32 v157, v157
  v_exp_f32 v158, v158
  v_exp_f32 v159, v159
  v_exp_f32 v160, v160
  v_exp_f32 v161, v161
  s_mov_b64 exec, s[54:55]
  ds_read_b128 v[24:27], v12 offset:20480
  ds_read_b128 v[28:31], v12 offset:21120
  ds_read_b128 v[32:35], v12 offset:21760
  ds_read_b128 v[36:39], v12 offset:22400
  s_mov_b64 exec, -1
  v_exp_f32 v162, v162
  v_smfmac_f32_32x32x32_bf16 v[56:71], v[44:47], v[144:151], v6
  v_exp_f32 v163, v163
  v_exp_f32 v164, v164
L_pad9:
  s_cbranch_execz L_pad11
  v_exp_f32 v165, v165
  v_smfmac_f32_32x32x32_bf16 v[56:71], v[48:51], v[152:159], v6
  v_exp_f32 v166, v166
  v_exp_f32 v167, v167
  s_waitcnt lgkmcnt(0)
  v_exp_f32 v104, v104
  v_exp_f32 v105, v105
  v_exp_f32 v106, v106
  v_smfmac_f32_32x32x32_bf16 v[56:71], v[52:55], v[160:167], v6
  v_exp_f32 v107, v107
  v_exp_f32 v108, v108
  v_exp_f32 v109, v109
  v_mfma_f32_32x32x16_bf16 v[136:151], v[88:91], v[72:75], v[168:183]
  v_exp_f32 v110, v110
  v_exp_f32 v111, v111
  v_exp_f32 v112, v112
  v_exp_f32 v113, v113
  v_mfma_f32_32x32x16_bf16 v[152:167], v[92:95], v[72:75], v[168:183]
  v_exp_f32 v114, v114
  v_exp_f32 v115, v115
  v_exp_f32 v116, v116
  ds_read_b128 v[96:99], v9 offset:30720
  ds_read_b128 v[100:103], v9 offset:31744
  ds_read2st64_b64 v[84:87], v14 offset0:148 offset1:149
  v_exp_f32 v117, v117
  v_smfmac_f32_32x32x32_bf16 v[56:71], v[24:27], v[104:111], v6
  v_exp_f32 v118, v118
  v_exp_f32 v119, v119
  v_exp_f32 v120, v120
  v_exp_f32 v121, v121
  v_exp_f32 v122, v122
  v_mfma_f32_32x32x4_2b_bf16 v[136:167], v[82:83], v[76:77], v[136:167]
  v_exp_f32 v123, v123
  v_exp_f32 v124, v124
  v_exp_f32 v125, v125
  v_exp_f32 v126, v126
  v_exp_f32 v127, v127
  v_exp_f32 v128, v128
  v_exp_f32 v129, v129
  s_mov_b64 exec, s[54:55]
  ds_read_b128 v[40:43], v12 offset:23040
  ds_read_b128 v[44:47], v12 offset:23680
  ds_read_b128 v[48:51], v12 offset:24320
  ds_read_b128 v[52:55], v12 offset:24960
  s_mov_b64 exec, -1
  v_exp_f32 v130, v130
  v_smfmac_f32_32x32x32_bf16 v[56:71], v[28:31], v[112:119], v6
  v_exp_f32 v131, v131
  v_exp_f32 v132, v132
  v_exp_f32 v133, v133
  v_smfmac_f32_32x32x32_bf16 v[56:71], v[32:35], v[120:127], v6
  v_exp_f32 v134, v134
  v_exp_f32 v135, v135
  s_setprio 1
  s_waitcnt lgkmcnt(0)
  v_exp_f32 v136, v136
  v_exp_f32 v137, v137
  v_exp_f32 v138, v138
  v_smfmac_f32_32x32x32_bf16 v[56:71], v[36:39], v[128:135], v6
  v_exp_f32 v139, v139
  v_exp_f32 v140, v140
  v_exp_f32 v141, v141
  v_mfma_f32_32x32x16_bf16 v[104:119], v[96:99], v[72:75], v[168:183]
  v_exp_f32 v142, v142
  v_exp_f32 v143, v143
  v_exp_f32 v144, v144
  v_exp_f32 v145, v145
  v_mfma_f32_32x32x16_bf16 v[120:135], v[100:103], v[72:75], v[168:183]
  v_exp_f32 v146, v146
  v_exp_f32 v147, v147
  v_exp_f32 v148, v148
  ds_read_b128 v[88:91], v9 offset:32768
  ds_read_b128 v[92:95], v9 offset:33792
  v_exp_f32 v149, v149
  v_smfmac_f32_32x32x32_bf16 v[56:71], v[40:43], v[136:143], v6
  v_exp_f32 v150, v150
  v_exp_f32 v151, v151
  v_exp_f32 v152, v152
  v_exp_f32 v153, v153
  v_exp_f32 v154, v154
  v_mfma_f32_32x32x4_2b_bf16 v[104:135], v[84:85], v[76:77], v[104:135]
  v_exp_f32 v155, v155
  v_exp_f32 v156, v156
  v_exp_f32 v157, v157
  v_exp_f32 v158, v158
  v_exp_f32 v159, v159
  v_exp_f32 v160, v160
  v_exp_f32 v161, v161
  s_mov_b64 exec, s[54:55]
  ds_read_b128 v[24:27], v12 offset:30720
  ds_read_b128 v[28:31], v12 offset:31360
  ds_read_b128 v[32:35], v12 offset:32000
  ds_read_b128 v[36:39], v12 offset:32640
  s_mov_b64 exec, -1
  v_exp_f32 v162, v162
  v_smfmac_f32_32x32x32_bf16 v[56:71], v[44:47], v[144:151], v6
  v_exp_f32 v163, v163
  v_exp_f32 v164, v164
  v_exp_f32 v165, v165
  v_smfmac_f32_32x32x32_bf16 v[56:71], v[48:51], v[152:159], v6
  v_exp_f32 v166, v166
  v_exp_f32 v167, v167
  s_waitcnt lgkmcnt(0)
  v_exp_f32 v104, v104
  v_exp_f32 v105, v105
  v_exp_f32 v106, v106
  v_smfmac_f32_32x32x32_bf16 v[56:71], v[52:55], v[160:167], v6
  v_exp_f32 v107, v107
  v_exp_f32 v108, v108
  v_exp_f32 v109, v109
  v_mfma_f32_32x32x16_bf16 v[136:151], v[88:91], v[72:75], v[168:183]
  v_exp_f32 v110, v110
  v_exp_f32 v111, v111
  v_exp_f32 v112, v112
  v_exp_f32 v113, v113
  v_mfma_f32_32x32x16_bf16 v[152:167], v[92:95], v[72:75], v[168:183]
  v_exp_f32 v114, v114
  v_exp_f32 v115, v115
  v_exp_f32 v116, v116
  v_exp_f32 v117, v117
  v_smfmac_f32_32x32x32_bf16 v[56:71], v[24:27], v[104:111], v6
  v_exp_f32 v118, v118
  v_exp_f32 v119, v119
  v_exp_f32 v120, v120
  v_exp_f32 v121, v121
  v_exp_f32 v122, v122
  v_mfma_f32_32x32x4_2b_bf16 v[136:167], v[86:87], v[76:77], v[136:167]
  v_exp_f32 v123, v123
  v_exp_f32 v124, v124
  v_exp_f32 v125, v125
  v_exp_f32 v126, v126
  v_exp_f32 v127, v127
  v_exp_f32 v128, v128
  v_exp_f32 v129, v129
  s_mov_b64 exec, s[54:55]
  ds_read_b128 v[40:43], v12 offset:33280
  ds_read_b128 v[44:47], v12 offset:33920
  ds_read_b128 v[48:51], v12 offset:34560
  ds_read_b128 v[52:55], v12 offset:35200
  s_mov_b64 exec, -1
  v_exp_f32 v130, v130
  v_smfmac_f32_32x32x32_bf16 v[56:71], v[28:31], v[112:119], v6
  v_exp_f32 v131, v131
  v_exp_f32 v132, v132
  v_exp_f32 v133, v133
  v_smfmac_f32_32x32x32_bf16 v[56:71], v[32:35], v[120:127], v6
  v_exp_f32 v134, v134
  v_exp_f32 v135, v135
  s_waitcnt lgkmcnt(0)
  v_exp_f32 v136, v136
  v_exp_f32 v137, v137
  v_exp_f32 v138, v138
  v_smfmac_f32_32x32x32_bf16 v[56:71], v[36:39], v[128:135], v6
  v_exp_f32 v139, v139
  v_exp_f32 v140, v140
  v_exp_f32 v141, v141
  v_exp_f32 v142, v142
  v_exp_f32 v143, v143
  v_exp_f32 v144, v144
  v_exp_f32 v145, v145
  v_exp_f32 v146, v146
  v_exp_f32 v147, v147
  v_exp_f32 v148, v148
  v_exp_f32 v149, v149
  v_smfmac_f32_32x32x32_bf16 v[56:71], v[40:43], v[136:143], v6
  v_exp_f32 v150, v150
  v_exp_f32 v151, v151
  v_exp_f32 v152, v152
  v_exp_f32 v153, v153
  v_exp_f32 v154, v154
  v_exp_f32 v155, v155
  v_exp_f32 v156, v156
  v_exp_f32 v157, v157
  v_exp_f32 v158, v158
  v_exp_f32 v159, v159
  v_exp_f32 v160, v160
  v_exp_f32 v161, v161
  v_exp_f32 v162, v162
  v_smfmac_f32_32x32x32_bf16 v[56:71], v[44:47], v[144:151], v6
  v_exp_f32 v163, v163
  v_exp_f32 v164, v164
  v_exp_f32 v165, v165
  v_smfmac_f32_32x32x32_bf16 v[56:71], v[48:51], v[152:159], v6
  v_exp_f32 v166, v166
  v_exp_f32 v167, v167
L_lend:
L_pad10:
  s_cbranch_execz L_pad12
  s_nop 1
  v_smfmac_f32_32x32x32_bf16 v[56:71], v[52:55], v[160:167], v6
  s_or_b32 s49, s81, 0x100
  v_mov_b32 v23, s49
  s_mov_b64 s[74:75], -1
  s_nop 8
L_fin:
  v_rcp_f32 v4, v68
  s_nop 0
  v_pk_mul_f32 v[112:113], v[56:57], v[4:5] op_sel_hi:[1,0]
  v_pk_mul_f32 v[114:115], v[58:59], v[4:5] op_sel_hi:[1,0]
  v_pk_mul_f32 v[116:117], v[60:61], v[4:5] op_sel_hi:[1,0]
  v_pk_mul_f32 v[118:119], v[62:63], v[4:5] op_sel_hi:[1,0]
  v_pk_mul_f32 v[120:121], v[64:65], v[4:5] op_sel_hi:[1,0]
  v_pk_mul_f32 v[122:123], v[66:67], v[4:5] op_sel_hi:[1,0]
  v_cvt_pk_bf16_f32 v104, v112, v113
  v_cvt_pk_bf16_f32 v105, v114, v115
  v_cvt_pk_bf16_f32 v106, v116, v117
  v_cvt_pk_bf16_f32 v107, v118, v119
  v_cvt_pk_bf16_f32 v108, v120, v121
  v_cvt_pk_bf16_f32 v109, v122, v123
  s_cmp_eq_u32 s80, 0
  s_cbranch_scc1 L_ostf
  buffer_store_dwordx4 v[104:107], v7, s[44:47], s66 offen sc1
  s_mov_b64 exec, s[56:57]
  buffer_store_dwordx2 v[108:109], v13, s[44:47], s67 offen sc1
  s_mov_b64 exec, -1
  s_branch L_ostj
L_ostf:
  buffer_store_dwordx4 v[104:107], v7, s[44:47], s66 offen nt
  s_mov_b64 exec, s[56:57]
  buffer_store_dwordx2 v[108:109], v13, s[44:47], s67 offen nt
  s_mov_b64 exec, -1
L_ostj:
  v_mul_f32 v2, 0x48000000, v4
  v_pk_mul_f32 v[4:5], v[56:57], 0 op_sel_hi:[1,0]
  v_max3_f32 v3, abs(v56), abs(v57), abs(v58)
  v_pk_fma_f32 v[4:5], v[58:59], 0, v[4:5] op_sel_hi:[1,0,1]
  v_pk_fma_f32 v[4:5], v[60:61], 0, v[4:5] op_sel_hi:[1,0,1]
  v_pk_fma_f32 v[4:5], v[62:63], 0, v[4:5] op_sel_hi:[1,0,1]
  v_pk_fma_f32 v[4:5], v[64:65], 0, v[4:5] op_sel_hi:[1,0,1]
  v_pk_fma_f32 v[4:5], v[66:67], 0, v[4:5] op_sel_hi:[1,0,1]
  v_pk_fma_f32 v[4:5], v[68:69], 0, v[4:5] op_sel_hi:[1,0,1]
  v_max3_f32 v3, v3, abs(v59), abs(v60)
  v_max3_f32 v3, v3, abs(v61), abs(v62)
  v_max3_f32 v3, v3, abs(v63), abs(v63)
  v_min_f32 v3, v3, v2
  v_add_f32 v4, v4, v5
  v_add_f32 v4, v4, v3
  v_cmp_nle_f32 vcc, 0x0c000000, v4
  s_and_b64 vcc, vcc, s[74:75]
  s_cbranch_vccnz L_slow
  s_cmp_ge_u32 s3, 4
  s_cbranch_scc0 L_oproj
  s_mov_b64 exec, 1
  s_waitcnt vmcnt(0)
  s_cmp_eq_u32 s80, 0
  s_cbranch_scc1 L_fl1f
  buffer_store_dword v23, v7, s[44:47], s48 offen sc1
  s_branch L_fl1j
L_fl1f:
  buffer_store_dword v23, v7, s[44:47], s48 offen
L_fl1j:
  s_mov_b64 exec, -1
  s_branch L_done
L_oproj:
  s_lshl_b32 s51, s6, 9
  s_add_u32 s51, s51, 0x40000
  s_lshr_b32 s50, s3, 1
  s_lshl1_add_u32 s68, s6, s50
  s_mul_i32 s68, s68, 40960
  s_add_u32 s68, s68, 0x100000
  s_lshl2_add_u32 s69, s6, s3
  s_mul_i32 s69, s69, 40960
  s_mul_i32 s50, s7, 160
  s_add_u32 s69, s69, s50
  s_add_u32 s69, s69, 1280
  v_mov_b32 v254, 0
  s_mov_b32 s53, 0x400000
L_wov:
  ds_read_b128 v[250:253], v254
  s_sub_u32 s53, s53, 1
  s_cbranch_scc1 L_wovx
  s_waitcnt lgkmcnt(0)
  v_min3_u32 v250, v250, v251, v252
  v_min_u32 v250, v250, v253
  v_cmp_eq_u32 vcc, 0, v250
  s_cbranch_vccnz L_wov
L_wovx:
  s_mov_b64 exec, 1
  s_waitcnt vmcnt(0)
  s_cmp_eq_u32 s80, 0
  s_cbranch_scc1 L_fl0f
  buffer_store_dword v23, v7, s[44:47], s48 offen sc1
  s_branch L_fl0j
L_fl0f:
  buffer_store_dword v23, v7, s[44:47], s48 offen
L_fl0j:
  s_mov_b64 exec, -1
  s_setprio 0
  buffer_load_dword v248, v243, s[44:47], s51 offen offset:0 sc1
  ds_read_b128 v[0:3], v240 offset:0
  ds_read_b128 v[4:7], v240 offset:1024
  ds_read_b128 v[8:11], v240 offset:2048
  ds_read_b128 v[12:15], v240 offset:3072
  ds_read_b128 v[16:19], v240 offset:4096
  ds_read_b128 v[20:23], v240 offset:5120
  ds_read_b128 v[24:27], v240 offset:6144
  ds_read_b128 v[28:31], v240 offset:7168
  ds_read_b128 v[32:35], v240 offset:8192
  ds_read_b128 v[36:39], v240 offset:9216
  ds_read_b128 v[40:43], v240 offset:10240
  ds_read_b128 v[44:47], v240 offset:11264
  ds_read_b128 v[48:51], v240 offset:12288
  ds_read_b128 v[52:55], v240 offset:13312
  ds_read_b128 v[56:59], v240 offset:14336
  s_waitcnt vmcnt(0)
  v_cmp_gt_u32 vcc, 0x100, v248
  s_cbranch_vccz L_op0x
  s_mov_b32 s53, 0x40000
L_op0:
  buffer_load_dword v248, v243, s[44:47], s51 offen offset:0 sc1
  s_sub_u32 s53, s53, 1
  s_cbranch_scc1 L_op0x
  s_waitcnt vmcnt(0)
  v_cmp_gt_u32 vcc, 0x100, v248
  s_cbranch_vccnz L_op0
L_op0x:
  s_add_u32 s50, s68, 0
  buffer_load_dwordx4 v[200:203], v244, s[44:47], s50 offen offset:0 sc1
  s_add_u32 s50, s68, 5120
  buffer_load_dwordx4 v[204:207], v244, s[44:47], s50 offen offset:0 sc1
  s_add_u32 s50, s68, 10240
  buffer_load_dwordx4 v[208:211], v244, s[44:47], s50 offen offset:0 sc1
  s_add_u32 s50, s68, 15360
  buffer_load_dwordx4 v[212:215], v244, s[44:47], s50 offen offset:0 sc1
  s_add_u32 s50, s68, 20480
  buffer_load_dwordx4 v[216:219], v244, s[44:47], s50 offen offset:0 sc1
  ds_read_b128 v[60:63], v240 offset:15360
  ds_read_b128 v[64:67], v240 offset:16384
  ds_read_b128 v[68:71], v240 offset:17408
  ds_read_b128 v[72:75], v240 offset:18432
  ds_read_b128 v[76:79], v240 offset:19456
  ds_read_b128 v[80:83], v240 offset:20480
  ds_read_b128 v[84:87], v240 offset:21504
  ds_read_b128 v[88:91], v240 offset:22528
  ds_read_b128 v[92:95], v240 offset:23552
  ds_read_b128 v[96:99], v240 offset:24576
  ds_read_b128 v[100:103], v240 offset:25600
  ds_read_b128 v[104:107], v240 offset:26624
  ds_read_b128 v[108:111], v240 offset:27648
  ds_read_b128 v[112:115], v240 offset:28672
  ds_read_b128 v[116:119], v240 offset:29696
  ds_read_b128 v[120:123], v240 offset:30720
  ds_read_b128 v[124:127], v240 offset:31744
  ds_read_b128 v[128:131], v240 offset:32768
  ds_read_b128 v[132:135], v240 offset:33792
  ds_read_b128 v[136:139], v240 offset:34816
  ds_read_b128 v[140:143], v240 offset:35840
  ds_read_b128 v[144:147], v240 offset:36864
  ds_read_b128 v[148:151], v240 offset:37888
  ds_read_b128 v[152:155], v240 offset:38912
  ds_read_b128 v[156:159], v240 offset:39936
  s_add_u32 s50, s68, 25600
  buffer_load_dwordx4 v[220:223], v244, s[44:47], s50 offen offset:0 sc1
  s_waitcnt vmcnt(5) lgkmcnt(15)
  v_mfma_f32_16x16x32_bf16 v[180:183], v[200:203], v[0:3], 0
  ds_read_b128 v[160:163], v240 offset:40960
  v_mfma_f32_16x16x32_bf16 v[184:187], v[200:203], v[4:7], 0
  ds_read_b128 v[164:167], v240 offset:41984
  v_mfma_f32_16x16x32_bf16 v[188:191], v[200:203], v[8:11], 0
  ds_read_b128 v[168:171], v240 offset:43008
  v_mfma_f32_16x16x32_bf16 v[192:195], v[200:203], v[12:15], 0
  ds_read_b128 v[172:175], v240 offset:44032
  v_mfma_f32_16x16x32_bf16 v[196:199], v[200:203], v[16:19], 0
  ds_read_b128 v[176:179], v240 offset:45056
  s_add_u32 s50, s68, 30720
  buffer_load_dwordx4 v[224:227], v244, s[44:47], s50 offen offset:0 sc1
  buffer_load_dword v248, v243, s[44:47], s51 offen offset:256 sc1
  s_waitcnt vmcnt(6) lgkmcnt(15)
  v_mfma_f32_16x16x32_bf16 v[180:183], v[204:207], v[20:23], v[180:183]
  ds_read_b128 v[0:3], v240 offset:46080
  v_mfma_f32_16x16x32_bf16 v[184:187], v[204:207], v[24:27], v[184:187]
  ds_read_b128 v[4:7], v240 offset:47104
  v_mfma_f32_16x16x32_bf16 v[188:191], v[204:207], v[28:31], v[188:191]
  ds_read_b128 v[8:11], v240 offset:48128
  v_mfma_f32_16x16x32_bf16 v[192:195], v[204:207], v[32:35], v[192:195]
  ds_read_b128 v[12:15], v240 offset:49152
  v_mfma_f32_16x16x32_bf16 v[196:199], v[204:207], v[36:39], v[196:199]
  ds_read_b128 v[16:19], v240 offset:50176
  s_add_u32 s50, s68, 35840
  buffer_load_dwordx4 v[228:231], v244, s[44:47], s50 offen offset:0 sc1
  s_waitcnt vmcnt(6) lgkmcnt(15)
  v_mfma_f32_16x16x32_bf16 v[180:183], v[208:211], v[40:43], v[180:183]
  ds_read_b128 v[20:23], v241 offset:0
  v_mfma_f32_16x16x32_bf16 v[184:187], v[208:211], v[44:47], v[184:187]
  ds_read_b128 v[24:27], v241 offset:1024
  v_mfma_f32_16x16x32_bf16 v[188:191], v[208:211], v[48:51], v[188:191]
  ds_read_b128 v[28:31], v241 offset:2048
  v_mfma_f32_16x16x32_bf16 v[192:195], v[208:211], v[52:55], v[192:195]
  ds_read_b128 v[32:35], v241 offset:3072
  v_mfma_f32_16x16x32_bf16 v[196:199], v[208:211], v[56:59], v[196:199]
  ds_read_b128 v[36:39], v241 offset:4096
  s_add_u32 s50, s68, 4096
  buffer_load_dwordx2 v[232:233], v245, s[44:47], s50 offen offset:0 sc1
  buffer_load_dwordx2 v[234:235], v245, s[44:47], s50 offen offset:256 sc1
  s_waitcnt vmcnt(7) lgkmcnt(15)
  v_mfma_f32_16x16x32_bf16 v[180:183], v[212:215], v[60:63], v[180:183]
  ds_read_b128 v[40:43], v241 offset:5120
  v_mfma_f32_16x16x32_bf16 v[184:187], v[212:215], v[64:67], v[184:187]
  ds_read_b128 v[44:47], v241 offset:6144
  v_mfma_f32_16x16x32_bf16 v[188:191], v[212:215], v[68:71], v[188:191]
  ds_read_b128 v[48:51], v241 offset:7168
  v_mfma_f32_16x16x32_bf16 v[192:195], v[212:215], v[72:75], v[192:195]
  ds_read_b128 v[52:55], v241 offset:8192
  v_mfma_f32_16x16x32_bf16 v[196:199], v[212:215], v[76:79], v[196:199]
  ds_read_b128 v[56:59], v241 offset:9216
  s_add_u32 s50, s68, 24576
  buffer_load_dwordx2 v[236:237], v245, s[44:47], s50 offen offset:0 sc1
  buffer_load_dwordx2 v[238:239], v245, s[44:47], s50 offen offset:256 sc1
  s_waitcnt vmcnt(8) lgkmcnt(15)
  v_mfma_f32_16x16x32_bf16 v[180:183], v[216:219], v[80:83], v[180:183]
  ds_read_b128 v[60:63], v241 offset:10240
  v_mfma_f32_16x16x32_bf16 v[184:187], v[216:219], v[84:87], v[184:187]
  ds_read_b128 v[64:67], v241 offset:11264
  v_mfma_f32_16x16x32_bf16 v[188:191], v[216:219], v[88:91], v[188:191]
  ds_read_b128 v[68:71], v241 offset:12288
  v_mfma_f32_16x16x32_bf16 v[192:195], v[216:219], v[92:95], v[192:195]
  ds_read_b128 v[72:75], v241 offset:13312
  v_mfma_f32_16x16x32_bf16 v[196:199], v[216:219], v[96:99], v[196:199]
  ds_read_b128 v[76:79], v241 offset:14336
  s_waitcnt vmcnt(5)
  v_cmp_gt_u32 vcc, 0x100, v248
  s_cbranch_vccz L_opB
  s_waitcnt vmcnt(7) lgkmcnt(15)
  v_mfma_f32_16x16x32_bf16 v[180:183], v[220:223], v[100:103], v[180:183]
  ds_read_b128 v[80:83], v241 offset:15360
  v_mfma_f32_16x16x32_bf16 v[184:187], v[220:223], v[104:107], v[184:187]
  ds_read_b128 v[84:87], v241 offset:16384
  v_mfma_f32_16x16x32_bf16 v[188:191], v[220:223], v[108:111], v[188:191]
  ds_read_b128 v[88:91], v241 offset:17408
  v_mfma_f32_16x16x32_bf16 v[192:195], v[220:223], v[112:115], v[192:195]
  ds_read_b128 v[92:95], v241 offset:18432
  v_mfma_f32_16x16x32_bf16 v[196:199], v[220:223], v[116:119], v[196:199]
  ds_read_b128 v[96:99], v241 offset:19456
  s_waitcnt vmcnt(6) lgkmcnt(15)
  v_mfma_f32_16x16x32_bf16 v[180:183], v[224:227], v[120:123], v[180:183]
  ds_read_b128 v[100:103], v241 offset:20480
  v_mfma_f32_16x16x32_bf16 v[184:187], v[224:227], v[124:127], v[184:187]
  ds_read_b128 v[104:107], v241 offset:21504
  v_mfma_f32_16x16x32_bf16 v[188:191], v[224:227], v[128:131], v[188:191]
  ds_read_b128 v[108:111], v241 offset:22528
  v_mfma_f32_16x16x32_bf16 v[192:195], v[224:227], v[132:135], v[192:195]
  ds_read_b128 v[112:115], v241 offset:23552
  v_mfma_f32_16x16x32_bf16 v[196:199], v[224:227], v[136:139], v[196:199]
  ds_read_b128 v[116:119], v241 offset:24576
  s_waitcnt vmcnt(4) lgkmcnt(15)
  v_mfma_f32_16x16x32_bf16 v[180:183], v[228:231], v[140:143], v[180:183]
  ds_read_b128 v[120:123], v241 offset:25600
  v_mfma_f32_16x16x32_bf16 v[184:187], v[228:231], v[144:147], v[184:187]
  ds_read_b128 v[124:127], v241 offset:26624
  v_mfma_f32_16x16x32_bf16 v[188:191], v[228:231], v[148:151], v[188:191]
  ds_read_b128 v[128:131], v241 offset:27648
  v_mfma_f32_16x16x32_bf16 v[192:195], v[228:231], v[152:155], v[192:195]
  ds_read_b128 v[132:135], v241 offset:28672
  v_mfma_f32_16x16x32_bf16 v[196:199], v[228:231], v[156:159], v[196:199]
  ds_read_b128 v[136:139], v241 offset:29696
  buffer_load_dword v248, v243, s[44:47], s51 offen offset:256 sc1
  s_waitcnt vmcnt(3) lgkmcnt(15)
  v_mfma_f32_16x16x32_bf16 v[180:183], v[232:235], v[160:163], v[180:183]
  ds_read_b128 v[140:143], v241 offset:30720
  v_mfma_f32_16x16x32_bf16 v[184:187], v[232:235], v[164:167], v[184:187]
  ds_read_b128 v[144:147], v241 offset:31744
  v_mfma_f32_16x16x32_bf16 v[188:191], v[232:235], v[168:171], v[188:191]
  ds_read_b128 v[148:151], v241 offset:32768
  v_mfma_f32_16x16x32_bf16 v[192:195], v[232:235], v[172:175], v[192:195]
  ds_read_b128 v[152:155], v241 offset:33792
  v_mfma_f32_16x16x32_bf16 v[196:199], v[232:235], v[176:179], v[196:199]
  ds_read_b128 v[156:159], v241 offset:34816
  s_waitcnt vmcnt(1) lgkmcnt(15)
  v_mfma_f32_16x16x32_bf16 v[180:183], v[236:239], v[0:3], v[180:183]
  ds_read_b128 v[160:163], v241 offset:35840
  v_mfma_f32_16x16x32_bf16 v[184:187], v[236:239], v[4:7], v[184:187]
  ds_read_b128 v[164:167], v241 offset:36864
  v_mfma_f32_16x16x32_bf16 v[188:191], v[236:239], v[8:11], v[188:191]
  ds_read_b128 v[168:171], v241 offset:37888
  v_mfma_f32_16x16x32_bf16 v[192:195], v[236:239], v[12:15], v[192:195]
  ds_read_b128 v[172:175], v241 offset:38912
  v_mfma_f32_16x16x32_bf16 v[196:199], v[236:239], v[16:19], v[196:199]
  ds_read_b128 v[176:179], v241 offset:39936
  s_waitcnt vmcnt(0)
  v_cmp_gt_u32 vcc, 0x100, v248
  s_cbranch_vccz L_op1x
  s_mov_b32 s53, 0x40000
L_op1:
  buffer_load_dword v248, v243, s[44:47], s51 offen offset:256 sc1
  s_sub_u32 s53, s53, 1
  s_cbranch_scc1 L_op1x
  s_waitcnt vmcnt(0)
  v_cmp_gt_u32 vcc, 0x100, v248
  s_cbranch_vccnz L_op1
L_op1x:
  s_add_u32 s50, s68, 0
  buffer_load_dwordx4 v[200:203], v244, s[44:47], s50 offen offset:2048 sc1
  s_add_u32 s50, s68, 5120
  buffer_load_dwordx4 v[204:207], v244, s[44:47], s50 offen offset:2048 sc1
  s_add_u32 s50, s68, 10240
  buffer_load_dwordx4 v[208:211], v244, s[44:47], s50 offen offset:2048 sc1
  s_add_u32 s50, s68, 15360
  buffer_load_dwordx4 v[212:215], v244, s[44:47], s50 offen offset:2048 sc1
  s_add_u32 s50, s68, 20480
  buffer_load_dwordx4 v[216:219], v244, s[44:47], s50 offen offset:2048 sc1
  s_branch L_opJ
L_opB:
L_pad11:
  s_cbranch_execz L_padend
  s_add_u32 s50, s68, 0
  buffer_load_dwordx4 v[200:203], v244, s[44:47], s50 offen offset:2048 sc1
  s_waitcnt vmcnt(8) lgkmcnt(15)
  v_mfma_f32_16x16x32_bf16 v[180:183], v[220:223], v[100:103], v[180:183]
  ds_read_b128 v[80:83], v241 offset:15360
  v_mfma_f32_16x16x32_bf16 v[184:187], v[220:223], v[104:107], v[184:187]
  ds_read_b128 v[84:87], v241 offset:16384
  v_mfma_f32_16x16x32_bf16 v[188:191], v[220:223], v[108:111], v[188:191]
  ds_read_b128 v[88:91], v241 offset:17408
  v_mfma_f32_16x16x32_bf16 v[192:195], v[220:223], v[112:115], v[192:195]
  ds_read_b128 v[92:95], v241 offset:18432
  v_mfma_f32_16x16x32_bf16 v[196:199], v[220:223], v[116:119], v[196:199]
  ds_read_b128 v[96:99], v241 offset:19456
  s_add_u32 s50, s68, 5120
  buffer_load_dwordx4 v[204:207], v244, s[44:47], s50 offen offset:2048 sc1
  s_waitcnt vmcnt(8) lgkmcnt(15)
  v_mfma_f32_16x16x32_bf16 v[180:183], v[224:227], v[120:123], v[180:183]
  ds_read_b128 v[100:103], v241 offset:20480
  v_mfma_f32_16x16x32_bf16 v[184:187], v[224:227], v[124:127], v[184:187]
  ds_read_b128 v[104:107], v241 offset:21504
  v_mfma_f32_16x16x32_bf16 v[188:191], v[224:227], v[128:131], v[188:191]
  ds_read_b128 v[108:111], v241 offset:22528
  v_mfma_f32_16x16x32_bf16 v[192:195], v[224:227], v[132:135], v[192:195]
  ds_read_b128 v[112:115], v241 offset:23552
  v_mfma_f32_16x16x32_bf16 v[196:199], v[224:227], v[136:139], v[196:199]
  ds_read_b128 v[116:119], v241 offset:24576
  s_add_u32 s50, s68, 10240
  buffer_load_dwordx4 v[208:211], v244, s[44:47], s50 offen offset:2048 sc1
  s_waitcnt vmcnt(7) lgkmcnt(15)
  v_mfma_f32_16x16x32_bf16 v[180:183], v[228:231], v[140:143], v[180:183]
  ds_read_b128 v[120:123], v241 offset:25600
  v_mfma_f32_16x16x32_bf16 v[184:187], v[228:231], v[144:147], v[184:187]
  ds_read_b128 v[124:127], v241 offset:26624
  v_mfma_f32_16x16x32_bf16 v[188:191], v[228:231], v[148:151], v[188:191]
  ds_read_b128 v[128:131], v241 offset:27648
  v_mfma_f32_16x16x32_bf16 v[192:195], v[228:231], v[152:155], v[192:195]
  ds_read_b128 v[132:135], v241 offset:28672
  v_mfma_f32_16x16x32_bf16 v[196:199], v[228:231], v[156:159], v[196:199]
  ds_read_b128 v[136:139], v241 offset:29696
  s_add_u32 s50, s68, 15360
  buffer_load_dwordx4 v[212:215], v244, s[44:47], s50 offen offset:2048 sc1
  s_waitcnt vmcnt(6) lgkmcnt(15)
  v_mfma_f32_16x16x32_bf16 v[180:183], v[232:235], v[160:163], v[180:183]
  ds_read_b128 v[140:143], v241 offset:30720
  v_mfma_f32_16x16x32_bf16 v[184:187], v[232:235], v[164:167], v[184:187]
  ds_read_b128 v[144:147], v241 offset:31744
  v_mfma_f32_16x16x32_bf16 v[188:191], v[232:235], v[168:171], v[188:191]
  ds_read_b128 v[148:151], v241 offset:32768
  v_mfma_f32_16x16x32_bf16 v[192:195], v[232:235], v[172:175], v[192:195]
  ds_read_b128 v[152:155], v241 offset:33792
  v_mfma_f32_16x16x32_bf16 v[196:199], v[232:235], v[176:179], v[196:199]
  ds_read_b128 v[156:159], v241 offset:34816
  s_add_u32 s50, s68, 20480
  buffer_load_dwordx4 v[216:219], v244, s[44:47], s50 offen offset:2048 sc1
  s_waitcnt vmcnt(5) lgkmcnt(15)
  v_mfma_f32_16x16x32_bf16 v[180:183], v[236:239], v[0:3], v[180:183]
  ds_read_b128 v[160:163], v241 offset:35840
  v_mfma_f32_16x16x32_bf16 v[184:187], v[236:239], v[4:7], v[184:187]
  ds_read_b128 v[164:167], v241 offset:36864
  v_mfma_f32_16x16x32_bf16 v[188:191], v[236:239], v[8:11], v[188:191]
  ds_read_b128 v[168:171], v241 offset:37888
  v_mfma_f32_16x16x32_bf16 v[192:195], v[236:239], v[12:15], v[192:195]
  ds_read_b128 v[172:175], v241 offset:38912
  v_mfma_f32_16x16x32_bf16 v[196:199], v[236:239], v[16:19], v[196:199]
  ds_read_b128 v[176:179], v241 offset:39936
L_opJ:
  s_add_u32 s50, s68, 25600
  buffer_load_dwordx4 v[220:223], v244, s[44:47], s50 offen offset:2048 sc1
  s_waitcnt vmcnt(5) lgkmcnt(15)
  v_mfma_f32_16x16x32_bf16 v[180:183], v[200:203], v[20:23], v[180:183]
  ds_read_b128 v[0:3], v241 offset:40960
  v_mfma_f32_16x16x32_bf16 v[184:187], v[200:203], v[24:27], v[184:187]
  ds_read_b128 v[4:7], v241 offset:41984
  v_mfma_f32_16x16x32_bf16 v[188:191], v[200:203], v[28:31], v[188:191]
  ds_read_b128 v[8:11], v241 offset:43008
  v_mfma_f32_16x16x32_bf16 v[192:195], v[200:203], v[32:35], v[192:195]
  ds_read_b128 v[12:15], v241 offset:44032
  v_mfma_f32_16x16x32_bf16 v[196:199], v[200:203], v[36:39], v[196:199]
  ds_read_b128 v[16:19], v241 offset:45056
  s_add_u32 s50, s68, 30720
  buffer_load_dwordx4 v[224:227], v244, s[44:47], s50 offen offset:2048 sc1
  s_waitcnt vmcnt(5) lgkmcnt(15)
  v_mfma_f32_16x16x32_bf16 v[180:183], v[204:207], v[40:43], v[180:183]
  ds_read_b128 v[20:23], v241 offset:46080
  v_mfma_f32_16x16x32_bf16 v[184:187], v[204:207], v[44:47], v[184:187]
  ds_read_b128 v[24:27], v241 offset:47104
  v_mfma_f32_16x16x32_bf16 v[188:191], v[204:207], v[48:51], v[188:191]
  ds_read_b128 v[28:31], v241 offset:48128
  v_mfma_f32_16x16x32_bf16 v[192:195], v[204:207], v[52:55], v[192:195]
  ds_read_b128 v[32:35], v241 offset:49152
  v_mfma_f32_16x16x32_bf16 v[196:199], v[204:207], v[56:59], v[196:199]
  ds_read_b128 v[36:39], v241 offset:50176
  s_add_u32 s50, s68, 35840
  buffer_load_dwordx4 v[228:231], v244, s[44:47], s50 offen offset:2048 sc1
  s_waitcnt vmcnt(5) lgkmcnt(15)
  v_mfma_f32_16x16x32_bf16 v[180:183], v[208:211], v[60:63], v[180:183]
  v_mfma_f32_16x16x32_bf16 v[184:187], v[208:211], v[64:67], v[184:187]
  v_mfma_f32_16x16x32_bf16 v[188:191], v[208:211], v[68:71], v[188:191]
  v_mfma_f32_16x16x32_bf16 v[192:195], v[208:211], v[72:75], v[192:195]
  v_mfma_f32_16x16x32_bf16 v[196:199], v[208:211], v[76:79], v[196:199]
  s_add_u32 s50, s68, 4096
  buffer_load_dwordx2 v[232:233], v245, s[44:47], s50 offen offset:512 sc1
  buffer_load_dwordx2 v[234:235], v245, s[44:47], s50 offen offset:768 sc1
  s_waitcnt vmcnt(6) lgkmcnt(15)
  v_mfma_f32_16x16x32_bf16 v[180:183], v[212:215], v[80:83], v[180:183]
  v_mfma_f32_16x16x32_bf16 v[184:187], v[212:215], v[84:87], v[184:187]
  v_mfma_f32_16x16x32_bf16 v[188:191], v[212:215], v[88:91], v[188:191]
  v_mfma_f32_16x16x32_bf16 v[192:195], v[212:215], v[92:95], v[192:195]
  v_mfma_f32_16x16x32_bf16 v[196:199], v[212:215], v[96:99], v[196:199]
  s_add_u32 s50, s68, 24576
  buffer_load_dwordx2 v[236:237], v245, s[44:47], s50 offen offset:512 sc1
  buffer_load_dwordx2 v[238:239], v245, s[44:47], s50 offen offset:768 sc1
  s_waitcnt vmcnt(7) lgkmcnt(15)
  v_mfma_f32_16x16x32_bf16 v[180:183], v[216:219], v[100:103], v[180:183]
  v_mfma_f32_16x16x32_bf16 v[184:187], v[216:219], v[104:107], v[184:187]
  v_mfma_f32_16x16x32_bf16 v[188:191], v[216:219], v[108:111], v[188:191]
  v_mfma_f32_16x16x32_bf16 v[192:195], v[216:219], v[112:115], v[192:195]
  v_mfma_f32_16x16x32_bf16 v[196:199], v[216:219], v[116:119], v[196:199]
  s_waitcnt vmcnt(6) lgkmcnt(15)
  v_mfma_f32_16x16x32_bf16 v[180:183], v[220:223], v[120:123], v[180:183]
  v_mfma_f32_16x16x32_bf16 v[184:187], v[220:223], v[124:127], v[184:187]
  v_mfma_f32_16x16x32_bf16 v[188:191], v[220:223], v[128:131], v[188:191]
  v_mfma_f32_16x16x32_bf16 v[192:195], v[220:223], v[132:135], v[192:195]
  v_mfma_f32_16x16x32_bf16 v[196:199], v[220:223], v[136:139], v[196:199]
  s_waitcnt vmcnt(5) lgkmcnt(15)
  v_mfma_f32_16x16x32_bf16 v[180:183], v[224:227], v[140:143], v[180:183]
  v_mfma_f32_16x16x32_bf16 v[184:187], v[224:227], v[144:147], v[184:187]
  v_mfma_f32_16x16x32_bf16 v[188:191], v[224:227], v[148:151], v[188:191]
  v_mfma_f32_16x16x32_bf16 v[192:195], v[224:227], v[152:155], v[192:195]
  v_mfma_f32_16x16x32_bf16 v[196:199], v[224:227], v[156:159], v[196:199]
  s_waitcnt vmcnt(4) lgkmcnt(10)
  v_mfma_f32_16x16x32_bf16 v[180:183], v[228:231], v[160:163], v[180:183]
  v_mfma_f32_16x16x32_bf16 v[184:187], v[228:231], v[164:167], v[184:187]
  v_mfma_f32_16x16x32_bf16 v[188:191], v[228:231], v[168:171], v[188:191]
  v_mfma_f32_16x16x32_bf16 v[192:195], v[228:231], v[172:175], v[192:195]
  v_mfma_f32_16x16x32_bf16 v[196:199], v[228:231], v[176:179], v[196:199]
  s_waitcnt vmcnt(2) lgkmcnt(5)
  v_mfma_f32_16x16x32_bf16 v[180:183], v[232:235], v[0:3], v[180:183]
  v_mfma_f32_16x16x32_bf16 v[184:187], v[232:235], v[4:7], v[184:187]
  v_mfma_f32_16x16x32_bf16 v[188:191], v[232:235], v[8:11], v[188:191]
  v_mfma_f32_16x16x32_bf16 v[192:195], v[232:235], v[12:15], v[192:195]
  v_mfma_f32_16x16x32_bf16 v[196:199], v[232:235], v[16:19], v[196:199]
  s_waitcnt vmcnt(0) lgkmcnt(0)
L_pad12:
  s_cbranch_execz L_padend
  v_mfma_f32_16x16x32_bf16 v[180:183], v[236:239], v[20:23], v[180:183]
  v_mfma_f32_16x16x32_bf16 v[184:187], v[236:239], v[24:27], v[184:187]
  v_mfma_f32_16x16x32_bf16 v[188:191], v[236:239], v[28:31], v[188:191]
  v_mfma_f32_16x16x32_bf16 v[192:195], v[236:239], v[32:35], v[192:195]
  v_mfma_f32_16x16x32_bf16 v[196:199], v[236:239], v[36:39], v[196:199]
  s_add_u32 s70, s69, 5120
  s_nop 4
  v_cvt_pk_bf16_f32 v40, v180, v184
  v_cvt_pk_bf16_f32 v41, v188, v192
  buffer_store_dwordx2 v[40:41], v246, s[40:43], s69 offen offset:0
  v_cvt_pk_bf16_f32 v42, v181, v185
  v_cvt_pk_bf16_f32 v43, v189, v193
  buffer_store_dwordx2 v[42:43], v246, s[40:43], s69 offen offset:2560
  v_cvt_pk_bf16_f32 v44, v182, v186
  v_cvt_pk_bf16_f32 v45, v190, v194
  buffer_store_dwordx2 v[44:45], v246, s[40:43], s70 offen offset:0
  v_cvt_pk_bf16_f32 v46, v183, v187
  v_cvt_pk_bf16_f32 v47, v191, v195
  buffer_store_dwordx2 v[46:47], v246, s[40:43], s70 offen offset:2560
  v_cvt_pk_bf16_f32 v48, v196, v197
  buffer_store_short v48, v247, s[40:43], s69 offen offset:128
  buffer_store_short_d16_hi v48, v247, s[40:43], s69 offen offset:2688
  v_cvt_pk_bf16_f32 v49, v198, v199
  buffer_store_short v49, v247, s[40:43], s70 offen offset:128
  buffer_store_short_d16_hi v49, v247, s[40:43], s70 offen offset:2688
L_done:
L_end:
  s_endpgm
L_slow:
  v_mov_b32 v168, 0xff800000
  s_mov_b64 s[74:75], 0
  s_mov_b32 s53, 0
L_slow0:
  s_add_u32 s50, s53, 4096
  buffer_load_dwordx2 v[80:81], v13, s[44:47], s50 offen offset:0 sc1
  buffer_load_dwordx4 v[88:91], v7, s[44:47], s53 offen offset:0 sc1
  buffer_load_dwordx4 v[92:95], v7, s[44:47], s53 offen offset:1024 sc1
  s_waitcnt vmcnt(0)
  v_mfma_f32_32x32x4_2b_bf16 v[104:135], v[80:81], v[76:77], 0
  s_nop 15
  s_nop 3
  v_mfma_f32_32x32x16_bf16 v[104:119], v[88:91], v[72:75], v[104:119]
  v_mfma_f32_32x32x16_bf16 v[120:135], v[92:95], v[72:75], v[120:135]
  s_nop 15
  v_max3_f32 v168, v168, v104, v105
  v_max3_f32 v168, v168, v106, v107
  v_max3_f32 v168, v168, v108, v109
  v_max3_f32 v168, v168, v110, v111
  v_max3_f32 v168, v168, v112, v113
  v_max3_f32 v168, v168, v114, v115
  v_max3_f32 v168, v168, v116, v117
  v_max3_f32 v168, v168, v118, v119
  v_max3_f32 v168, v168, v120, v121
  v_max3_f32 v168, v168, v122, v123
  v_max3_f32 v168, v168, v124, v125
  v_max3_f32 v168, v168, v126, v127
  v_max3_f32 v168, v168, v128, v129
  v_max3_f32 v168, v168, v130, v131
  v_max3_f32 v168, v168, v132, v133
  v_max3_f32 v168, v168, v134, v135
  s_add_u32 s50, s53, 4096
  buffer_load_dwordx2 v[80:81], v13, s[44:47], s50 offen offset:512 sc1
  buffer_load_dwordx4 v[88:91], v7, s[44:47], s53 offen offset:2048 sc1
  buffer_load_dwordx4 v[92:95], v7, s[44:47], s53 offen offset:3072 sc1
  s_waitcnt vmcnt(0)
  v_mfma_f32_32x32x4_2b_bf16 v[104:135], v[80:81], v[76:77], 0
  s_nop 15
  s_nop 3
  v_mfma_f32_32x32x16_bf16 v[104:119], v[88:91], v[72:75], v[104:119]
  v_mfma_f32_32x32x16_bf16 v[120:135], v[92:95], v[72:75], v[120:135]
  s_nop 15
  v_max3_f32 v168, v168, v104, v105
  v_max3_f32 v168, v168, v106, v107
  v_max3_f32 v168, v168, v108, v109
  v_max3_f32 v168, v168, v110, v111
  v_max3_f32 v168, v168, v112, v113
  v_max3_f32 v168, v168, v114, v115
  v_max3_f32 v168, v168, v116, v117
  v_max3_f32 v168, v168, v118, v119
  v_max3_f32 v168, v168, v120, v121
  v_max3_f32 v168, v168, v122, v123
  v_max3_f32 v168, v168, v124, v125
  v_max3_f32 v168, v168, v126, v127
  v_max3_f32 v168, v168, v128, v129
  v_max3_f32 v168, v168, v130, v131
  v_max3_f32 v168, v168, v132, v133
  v_max3_f32 v168, v168, v134, v135
  s_add_u32 s53, s53, 10240
  s_cmp_lt_u32 s53, 163840
  s_cbranch_scc1 L_slow0
  v_mov_b32 v3, v168
  s_nop 1
  v_permlane32_swap_b32 v168, v3
  s_nop 1
  v_max_f32 v168, v168, v3
  v_mov_b32 v56, 0
  v_mov_b32 v57, 0
  v_mov_b32 v58, 0
  v_mov_b32 v59, 0
  v_mov_b32 v60, 0
  v_mov_b32 v61, 0
  v_mov_b32 v62, 0
  v_mov_b32 v63, 0
  v_mov_b32 v64, 0
  v_mov_b32 v65, 0
  v_mov_b32 v66, 0
  v_mov_b32 v67, 0
  v_mov_b32 v68, 0
  v_mov_b32 v69, 0
  v_mov_b32 v70, 0
  v_mov_b32 v71, 0
  s_mov_b32 s53, 0
L_slow1:
  s_add_u32 s50, s53, 4096
  buffer_load_dwordx2 v[80:81], v13, s[44:47], s50 offen offset:0 sc1
  buffer_load_dwordx4 v[88:91], v7, s[44:47], s53 offen offset:0 sc1
  buffer_load_dwordx4 v[92:95], v7, s[44:47], s53 offen offset:1024 sc1
  s_add_u32 s50, s53, 0
  s_mov_b64 exec, s[54:55]
  buffer_load_dwordx4 v[24:27], v10, s[44:47], s50 offen offset:0 sc1
  buffer_load_dwordx4 v[28:31], v10, s[44:47], s50 offen offset:640 sc1
  buffer_load_dwordx4 v[32:35], v10, s[44:47], s50 offen offset:1280 sc1
  buffer_load_dwordx4 v[36:39], v10, s[44:47], s50 offen offset:1920 sc1
  s_mov_b64 exec, -1
  s_waitcnt vmcnt(0)
  v_mfma_f32_32x32x4_2b_bf16 v[104:135], v[80:81], v[76:77], 0
  s_nop 15
  s_nop 3
  v_mfma_f32_32x32x16_bf16 v[104:119], v[88:91], v[72:75], v[104:119]
  v_mfma_f32_32x32x16_bf16 v[120:135], v[92:95], v[72:75], v[120:135]
  s_nop 15
  v_sub_f32 v104, v104, v168
  v_sub_f32 v105, v105, v168
  v_sub_f32 v106, v106, v168
  v_sub_f32 v107, v107, v168
  v_sub_f32 v108, v108, v168
  v_sub_f32 v109, v109, v168
  v_sub_f32 v110, v110, v168
  v_sub_f32 v111, v111, v168
  v_sub_f32 v112, v112, v168
  v_sub_f32 v113, v113, v168
  v_sub_f32 v114, v114, v168
  v_sub_f32 v115, v115, v168
  v_sub_f32 v116, v116, v168
  v_sub_f32 v117, v117, v168
  v_sub_f32 v118, v118, v168
  v_sub_f32 v119, v119, v168
  v_sub_f32 v120, v120, v168
  v_sub_f32 v121, v121, v168
  v_sub_f32 v122, v122, v168
  v_sub_f32 v123, v123, v168
  v_sub_f32 v124, v124, v168
  v_sub_f32 v125, v125, v168
  v_sub_f32 v126, v126, v168
  v_sub_f32 v127, v127, v168
  v_sub_f32 v128, v128, v168
  v_sub_f32 v129, v129, v168
  v_sub_f32 v130, v130, v168
  v_sub_f32 v131, v131, v168
  v_sub_f32 v132, v132, v168
  v_sub_f32 v133, v133, v168
  v_sub_f32 v134, v134, v168
  v_sub_f32 v135, v135, v168
  v_exp_f32 v104, v104
  v_exp_f32 v105, v105
  v_exp_f32 v106, v106
  v_exp_f32 v107, v107
  v_exp_f32 v108, v108
  v_exp_f32 v109, v109
  v_exp_f32 v110, v110
  v_exp_f32 v111, v111
  v_exp_f32 v112, v112
  v_exp_f32 v113, v113
  v_exp_f32 v114, v114
  v_exp_f32 v115, v115
  v_exp_f32 v116, v116
  v_exp_f32 v117, v117
  v_exp_f32 v118, v118
  v_exp_f32 v119, v119
  v_exp_f32 v120, v120
  v_exp_f32 v121, v121
  v_exp_f32 v122, v122
  v_exp_f32 v123, v123
  v_exp_f32 v124, v124
  v_exp_f32 v125, v125
  v_exp_f32 v126, v126
  v_exp_f32 v127, v127
  v_exp_f32 v128, v128
  v_exp_f32 v129, v129
  v_exp_f32 v130, v130
  v_exp_f32 v131, v131
  v_exp_f32 v132, v132
  v_exp_f32 v133, v133
  v_exp_f32 v134, v134
  v_exp_f32 v135, v135
  s_nop 1
  v_smfmac_f32_32x32x32_bf16 v[56:71], v[24:27], v[104:111], v6
  v_smfmac_f32_32x32x32_bf16 v[56:71], v[28:31], v[112:119], v6
  v_smfmac_f32_32x32x32_bf16 v[56:71], v[32:35], v[120:127], v6
  v_smfmac_f32_32x32x32_bf16 v[56:71], v[36:39], v[128:135], v6
  s_nop 7
  s_add_u32 s50, s53, 4096
  buffer_load_dwordx2 v[80:81], v13, s[44:47], s50 offen offset:512 sc1
  buffer_load_dwordx4 v[88:91], v7, s[44:47], s53 offen offset:2048 sc1
  buffer_load_dwordx4 v[92:95], v7, s[44:47], s53 offen offset:3072 sc1
  s_add_u32 s50, s53, 2560
  s_mov_b64 exec, s[54:55]
  buffer_load_dwordx4 v[24:27], v10, s[44:47], s50 offen offset:0 sc1
  buffer_load_dwordx4 v[28:31], v10, s[44:47], s50 offen offset:640 sc1
  buffer_load_dwordx4 v[32:35], v10, s[44:47], s50 offen offset:1280 sc1
  buffer_load_dwordx4 v[36:39], v10, s[44:47], s50 offen offset:1920 sc1
  s_mov_b64 exec, -1
  s_waitcnt vmcnt(0)
  v_mfma_f32_32x32x4_2b_bf16 v[104:135], v[80:81], v[76:77], 0
  s_nop 15
  s_nop 3
  v_mfma_f32_32x32x16_bf16 v[104:119], v[88:91], v[72:75], v[104:119]
  v_mfma_f32_32x32x16_bf16 v[120:135], v[92:95], v[72:75], v[120:135]
  s_nop 15
  v_sub_f32 v104, v104, v168
  v_sub_f32 v105, v105, v168
  v_sub_f32 v106, v106, v168
  v_sub_f32 v107, v107, v168
  v_sub_f32 v108, v108, v168
  v_sub_f32 v109, v109, v168
  v_sub_f32 v110, v110, v168
  v_sub_f32 v111, v111, v168
  v_sub_f32 v112, v112, v168
  v_sub_f32 v113, v113, v168
  v_sub_f32 v114, v114, v168
  v_sub_f32 v115, v115, v168
  v_sub_f32 v116, v116, v168
  v_sub_f32 v117, v117, v168
  v_sub_f32 v118, v118, v168
  v_sub_f32 v119, v119, v168
  v_sub_f32 v120, v120, v168
  v_sub_f32 v121, v121, v168
  v_sub_f32 v122, v122, v168
  v_sub_f32 v123, v123, v168
  v_sub_f32 v124, v124, v168
  v_sub_f32 v125, v125, v168
  v_sub_f32 v126, v126, v168
  v_sub_f32 v127, v127, v168
  v_sub_f32 v128, v128, v168
  v_sub_f32 v129, v129, v168
  v_sub_f32 v130, v130, v168
  v_sub_f32 v131, v131, v168
  v_sub_f32 v132, v132, v168
  v_sub_f32 v133, v133, v168
  v_sub_f32 v134, v134, v168
  v_sub_f32 v135, v135, v168
  v_exp_f32 v104, v104
  v_exp_f32 v105, v105
  v_exp_f32 v106, v106
  v_exp_f32 v107, v107
  v_exp_f32 v108, v108
  v_exp_f32 v109, v109
  v_exp_f32 v110, v110
  v_exp_f32 v111, v111
  v_exp_f32 v112, v112
  v_exp_f32 v113, v113
  v_exp_f32 v114, v114
  v_exp_f32 v115, v115
  v_exp_f32 v116, v116
  v_exp_f32 v117, v117
  v_exp_f32 v118, v118
  v_exp_f32 v119, v119
  v_exp_f32 v120, v120
  v_exp_f32 v121, v121
  v_exp_f32 v122, v122
  v_exp_f32 v123, v123
  v_exp_f32 v124, v124
  v_exp_f32 v125, v125
  v_exp_f32 v126, v126
  v_exp_f32 v127, v127
  v_exp_f32 v128, v128
  v_exp_f32 v129, v129
  v_exp_f32 v130, v130
  v_exp_f32 v131, v131
  v_exp_f32 v132, v132
  v_exp_f32 v133, v133
  v_exp_f32 v134, v134
  v_exp_f32 v135, v135
  s_nop 1
  v_smfmac_f32_32x32x32_bf16 v[56:71], v[24:27], v[104:111], v6
  v_smfmac_f32_32x32x32_bf16 v[56:71], v[28:31], v[112:119], v6
  v_smfmac_f32_32x32x32_bf16 v[56:71], v[32:35], v[120:127], v6
  v_smfmac_f32_32x32x32_bf16 v[56:71], v[36:39], v[128:135], v6
  s_nop 7
  s_add_u32 s53, s53, 10240
  s_cmp_lt_u32 s53, 163840
  s_cbranch_scc1 L_slow1
  s_nop 15
  s_branch L_fin
L_codeend:

.section .rodata,"a"
.p2align 6
.amdhsa_kernel concat_heads__spectral_fnet__grouped_kv_mqa__prompt_kernel
  .amdhsa_next_free_vgpr 256
  .amdhsa_next_free_sgpr 102
  .amdhsa_accum_offset 256
  .amdhsa_group_segment_fixed_size 0
  .amdhsa_kernarg_size 104
  .amdhsa_user_sgpr_count 2
  .amdhsa_user_sgpr_kernarg_segment_ptr 1
  .amdhsa_system_sgpr_workgroup_id_x 1
.end_amdhsa_kernel
```
